```python
import torch

def _softmax(x, axis=-1):
    return torch.softmax(x, dim=axis)
def _gelu(x):
    return torch.nn.functional.gelu(x, approximate="tanh")
def _silu(x):
    return torch.nn.functional.silu(x)
def _sigmoid(x):
    return torch.sigmoid(x)
def _layernorm(x, axis=-1, eps=1e-5):
    m = x.mean(dim=axis, keepdim=True)
    v = x.var(dim=axis, keepdim=True, unbiased=False)
    return (x - m) / torch.sqrt(v + eps)
def _scatter_add(tgt, idx, src, axis=0):
    return tgt.clone().index_add_(axis, idx, src)
def _segment_sum(src, seg, n):
    out = torch.zeros((n,) + src.shape[1:], dtype=src.dtype)
    return out.index_add_(0, seg, src)
def _pad(x, pw):
    flat = tuple(v for pair in reversed(pw) for v in pair)
    return torch.nn.functional.pad(x, flat)

kernel_name = 'sequential_preLN__linear_kernel_hedgehog__glu_gated_reglu__prompt'

def setup_inputs():

    _w = (lambda a: (lambda t: t.to(torch.bfloat16) if t.is_floating_point() else t)(torch.as_tensor(a)))
    def _A_setup():
        B, S, D, H = 1, 2048, 576, 32
        Dh = D // H
        return {
            "x": _w((lambda *s: torch.randn(*s, dtype=torch.bfloat16) * 0.05)(B, S, D)),
            "wqkv": _w((lambda *s: torch.randn(*s, dtype=torch.bfloat16) * 0.2)(D, 3 * D)),
            "w_phi": _w((lambda *s: torch.randn(*s, dtype=torch.bfloat16) * 0.2)(H, Dh, Dh) * (Dh ** -0.5)),
            "wo": _w((lambda *s: torch.randn(*s, dtype=torch.bfloat16) * 0.05)(D, D)),
        }
    _A_in = _A_setup()

    def _B_setup():
        B, S, D, F = 1, 2048, 576, 4608
        return {
            "x": _w((lambda *s: torch.randn(*s, dtype=torch.bfloat16) * 0.05)(B, S, D)),
            "W_gate": _w((lambda *s: torch.randn(*s, dtype=torch.bfloat16) * 0.4)(D, F) * (2.0 / D) ** 0.5),
            "W_up": _w((lambda *s: torch.randn(*s, dtype=torch.bfloat16) * 0.4)(D, F) * (2.0 / D) ** 0.5),
            "W_down": _w((lambda *s: torch.randn(*s, dtype=torch.bfloat16) * 0.4)(F, D) * (1.0 / F) ** 0.5),
        }
    _B_in = _B_setup()

    return {
        "A_x": _A_in["x"],
        "A_wqkv": _A_in["wqkv"],
        "A_w_phi": _A_in["w_phi"],
        "A_wo": _A_in["wo"],
        "B_x": _B_in["x"],
        "B_W_gate": _B_in["W_gate"],
        "B_W_up": _B_in["W_up"],
        "B_W_down": _B_in["W_down"],
    }

def reference(A_x, A_wqkv, A_w_phi, A_wo, B_x, B_W_gate, B_W_up, B_W_down):
    def _A_ref(x, wqkv, w_phi, wo):
        B, S, D = x.shape
        H = 32; Dh = D // H
        qkv = (lambda x, *d: x.permute(*d))((x @ wqkv).reshape(B, S, 3, H, Dh), 2, 0, 3, 1, 4)
        q, k, v = qkv[0], qkv[1], qkv[2]
        pq = torch.einsum("bhsd,hdf->bhsf", q, w_phi)
        pk = torch.einsum("bhsd,hdf->bhsf", k, w_phi)
        phi_q = torch.concatenate([_softmax(pq, axis=-1), _softmax(-pq, axis=-1)], axis=-1)
        phi_k = torch.concatenate([_softmax(pk, axis=-1), _softmax(-pk, axis=-1)], axis=-1)
        kv = torch.einsum("bhsf,bhsd->bhfd", phi_k, v)
        z  = torch.einsum("bhsf->bhf", phi_k)
        num = torch.einsum("bhqf,bhfd->bhqd", phi_q, kv)
        den = torch.einsum("bhqf,bhf->bhq", phi_q, z)[..., None] + 1e-6
        o = num / den
        return (lambda x, *d: x.permute(*d))(o, 0, 2, 1, 3).reshape(B, S, D) @ wo

    def _B_ref(x, W_gate, W_up, W_down):
        gate = torch.einsum("bsd,df->bsf", x, W_gate)
        up = torch.einsum("bsd,df->bsf", x, W_up)
        gate = gate * (lambda x, dt: x.to(dt))(gate > 0, gate.dtype)
        h = gate * up
        return torch.einsum("bsf,fd->bsd", h, W_down)

    x = A_x
    h = x + _A_ref(_layernorm(x, axis=-1), A_wqkv, A_w_phi, A_wo)
    h2 = h + _B_ref(_layernorm(h, axis=-1), B_W_gate, B_W_up, B_W_down)
    return h2
```

```asm
; @launch grid=(256,1,1) block=(256,1,1) lds=163840
.amdgcn_target "amdgcn-amd-amdhsa--gfx950"
.text
.globl sequential_preLN__linear_kernel_hedgehog__glu_gated_reglu__prompt_kernel
.p2align 8
.type sequential_preLN__linear_kernel_hedgehog__glu_gated_reglu__prompt_kernel,@function
sequential_preLN__linear_kernel_hedgehog__glu_gated_reglu__prompt_kernel:
    s_cmp_ge_u32 s2, 256
    s_cbranch_scc1 K_end
    s_load_dwordx4 s[4:7], s[0:1], 0
    s_load_dwordx4 s[8:11], s[0:1], 16
    s_load_dwordx4 s[88:91], s[0:1], 72
    s_getpc_b64 s[92:93]
Kpc_1:
    s_add_u32 s92, s92, K_start-Kpc_1
    s_addc_u32 s93, s93, 0
    s_mov_b32 s94, K_tab_end-K_start
    s_mov_b32 s95, 0x20000
    s_lshr_b32 s96, s2, 3
    s_mul_i32 s96, s96, 3072
    v_mul_u32_u24 v16, 12, v0
    buffer_load_dwordx3 a[0:2], v16, s[92:95], s96 offen
K_start:
    v_lshrrev_b32 v16, 6, v0
    v_and_b32 v15, 63, v0
    v_mov_b32 v14, v0
    v_readfirstlane_b32 s30, v16
    s_and_b32 s31, s2, 3
    s_lshl_b32 s31, s31, 2
    s_bfe_u32 s33, s2, 0x20003
    s_add_u32 s32, s31, s33
    s_bfe_u32 s31, s2, 0x10002
    s_lshl_b32 s31, s31, 3
    s_lshr_b32 s33, s2, 5
    s_add_u32 s31, s31, s33
    s_lshr_b32 s28, s2, 3
    s_and_b32 s29, s2, 7
    v_and_b32 v16, 7, v15
    v_lshrrev_b32 v17, 3, v15
    v_mul_u32_u24 v13, 1152, v16
    v_lshl_add_u32 v13, v17, 4, v13
    v_lshlrev_b32 v5, 4, v15
    s_lshl_b32 s36, s32, 4
    s_add_u32 s36, s36, s31
    s_mul_i32 s36, s36, 9216
    s_lshl_b32 s37, s30, 7
    s_add_u32 s36, s36, s37
    s_cmp_eq_u32 s30, 0
    s_cselect_b32 s37, 0, 2147483392
    s_add_u32 s37, s37, s36
    s_mul_i32 s34, s30, 25344
    s_add_u32 s34, s34, 46080
    s_lshl_b32 s35, s32, 2
    s_add_u32 s35, s35, s30
    s_waitcnt lgkmcnt(0)
    s_mov_b32 s12, s4
    s_mov_b32 s13, s5
    s_mov_b32 s14, 2359296
    s_mov_b32 s15, 0x20000
    s_mov_b32 s20, s90
    s_mov_b32 s21, s91
    s_mov_b32 s22, 268435456
    s_mov_b32 s23, 0x20000
    s_lshl_b32 s33, s2, 2
    s_add_u32 s33, s33, s30
    s_cmp_lg_u32 s33, 515
    s_cbranch_scc1 Knoinit_2
    v_lshlrev_b32 v16, 8, v15
    v_mov_b32 v17, 0
    s_mov_b32 s38, 46137344
    s_mov_b32 exec_hi, 0
    buffer_store_dword v17, v16, s[20:23], s38 offen sc1
    s_mov_b32 exec_hi, -1
Knoinit_2:
    buffer_load_dwordx4 v[160:163], v13, s[12:15], s36 offen
    buffer_load_dwordx4 v[164:167], v13, s[12:15], s36 offen offset:512
    buffer_load_dwordx4 v[168:171], v13, s[12:15], s37 offen offset:1024
    s_mov_b32 s24, s88
    s_mov_b32 s25, s89
    s_mov_b32 s26, 256
    s_mov_b32 s27, 0x20000
    v_add_u32 v16, 0, v15
    v_mul_u32_u24 v17, 5958, v16
    v_lshrrev_b32 v17, 16, v17
    v_mul_u32_u24 v18, 11, v17
    v_sub_u32 v18, v16, v18
    v_and_b32 v19, 8, v17
    v_and_b32 v20, 1, v17
    v_lshl_add_u32 v19, v20, 2, v19
    v_bfe_u32 v17, v17, 1, 2
    v_add_u32 v17, v17, v19
    v_mul_u32_u24 v17, 3456, v17
    v_lshl_add_u32 v17, v18, 4, v17
    v_mov_b32 v19, 3200
    v_mov_b32 v16, 4272
    v_cmp_lt_u32 vcc, 4, v18
    v_mov_b32 v20, 4260
    v_cmp_lt_u32 s[38:39], 7, v18
    v_cndmask_b32 v19, v19, v16, vcc
    v_cmp_eq_u32 vcc, 4, v18
    v_cndmask_b32_e64 v19, v19, v20, s[38:39]
    v_cmp_eq_u32 s[38:39], 7, v18
    v_cndmask_b32_e64 v16, 0, 8, vcc
    v_cmp_eq_u32 vcc, 10, v18
    v_cndmask_b32_e64 v16, v16, 12, s[38:39]
    v_add_u32 v0, v17, v19
    v_cndmask_b32_e64 v16, v16, 12, vcc
    v_sub_u32 v0, v0, v16
    v_add_u32 v16, 64, v15
    v_mul_u32_u24 v17, 5958, v16
    v_lshrrev_b32 v17, 16, v17
    v_mul_u32_u24 v18, 11, v17
    v_sub_u32 v18, v16, v18
    v_and_b32 v19, 8, v17
    v_and_b32 v20, 1, v17
    v_lshl_add_u32 v19, v20, 2, v19
    v_bfe_u32 v17, v17, 1, 2
    v_add_u32 v17, v17, v19
    v_mul_u32_u24 v17, 3456, v17
    v_lshl_add_u32 v17, v18, 4, v17
    v_mov_b32 v19, 2176
    v_mov_b32 v16, 3248
    v_cmp_lt_u32 vcc, 4, v18
    v_mov_b32 v20, 3236
    v_cmp_lt_u32 s[38:39], 7, v18
    v_cndmask_b32 v19, v19, v16, vcc
    v_cmp_eq_u32 vcc, 4, v18
    v_cndmask_b32_e64 v19, v19, v20, s[38:39]
    v_cmp_eq_u32 s[38:39], 7, v18
    v_cndmask_b32_e64 v16, 0, 8, vcc
    v_cmp_eq_u32 vcc, 10, v18
    v_cndmask_b32_e64 v16, v16, 12, s[38:39]
    v_add_u32 v1, v17, v19
    v_cndmask_b32_e64 v16, v16, 12, vcc
    v_sub_u32 v1, v1, v16
    v_add_u32 v16, 128, v15
    v_mul_u32_u24 v17, 5958, v16
    v_lshrrev_b32 v17, 16, v17
    v_mul_u32_u24 v18, 11, v17
    v_sub_u32 v18, v16, v18
    v_and_b32 v19, 8, v17
    v_and_b32 v20, 1, v17
    v_lshl_add_u32 v19, v20, 2, v19
    v_bfe_u32 v17, v17, 1, 2
    v_add_u32 v17, v17, v19
    v_mul_u32_u24 v17, 3456, v17
    v_lshl_add_u32 v17, v18, 4, v17
    v_mov_b32 v19, 1152
    v_mov_b32 v16, 2224
    v_cmp_lt_u32 vcc, 4, v18
    v_mov_b32 v20, 2212
    v_cmp_lt_u32 s[38:39], 7, v18
    v_cndmask_b32 v19, v19, v16, vcc
    v_cmp_eq_u32 vcc, 4, v18
    v_cndmask_b32_e64 v19, v19, v20, s[38:39]
    v_cmp_eq_u32 s[38:39], 7, v18
    v_cndmask_b32_e64 v16, 0, 8, vcc
    v_cmp_eq_u32 vcc, 10, v18
    v_cndmask_b32_e64 v16, v16, 12, s[38:39]
    v_add_u32 v2, v17, v19
    v_cndmask_b32_e64 v16, v16, 12, vcc
    v_sub_u32 v2, v2, v16
    s_sub_u32 s16, s6, 2048
    s_subb_u32 s17, s7, 0
    s_mov_b32 s18, 1992704
    s_mov_b32 s19, 0x20000
    s_mov_b32 s40, s8
    s_mov_b32 s41, s9
    s_mov_b32 s42, 20736
    s_mov_b32 s43, 0x20000
    v_bfe_u32 v16, v15, 3, 2
    v_bfe_u32 v17, v15, 1, 1
    v_and_b32 v18, 1, v15
    v_mul_u32_u24 v19, 5, v17
    v_lshl_add_u32 v19, v16, 1, v19
    v_add_u32 v19, v19, v18
    v_lshlrev_b32 v20, 2, v17
    v_add_u32 v20, 4, v20
    v_cmp_eq_u32 vcc, 2, v16
    v_lshl_add_u32 v16, v16, 1, v18
    v_lshrrev_b32 v21, 5, v15
    v_cndmask_b32 v19, v19, v20, vcc
    v_mul_u32_u24 v21, 9, v21
    v_add_lshl_u32 v19, v19, v21, 2
    v_mov_b32 v22, 2147483392
    v_cmp_gt_u32 vcc, 5, v16
    v_bfe_u32 v17, v15, 2, 1
    s_mul_i32 s38, s30, 6
    v_cndmask_b32 v19, v22, v19, vcc
    v_cmp_eq_u32 vcc, 0, v17
    s_mul_i32 s39, s31, 1296
    s_nop 0
    v_cndmask_b32 v20, v22, v19, vcc
    v_cndmask_b32 v21, v19, v22, vcc
    s_add_u32 s37, s38, 0
    s_lshl_b32 s96, s37, 8
    s_add_u32 m0, s96, 147456
    s_cmp_lt_u32 s37, 9
    s_cselect_b64 vcc, -1, 0
    s_mul_i32 s96, s37, 72
    s_add_u32 s96, s96, s39
    v_cndmask_b32 v16, v21, v20, vcc
    s_cmp_ge_u32 s37, 18
    s_cselect_b32 s96, 0x100000, s96
    buffer_load_dword v16, s[40:43], s96 offen lds
    s_add_u32 s37, s38, 1
    s_lshl_b32 s96, s37, 8
    s_add_u32 m0, s96, 147456
    s_cmp_lt_u32 s37, 9
    s_cselect_b64 vcc, -1, 0
    s_mul_i32 s96, s37, 72
    s_add_u32 s96, s96, s39
    v_cndmask_b32 v16, v21, v20, vcc
    s_cmp_ge_u32 s37, 18
    s_cselect_b32 s96, 0x100000, s96
    buffer_load_dword v16, s[40:43], s96 offen lds
    s_add_u32 s37, s38, 2
    s_lshl_b32 s96, s37, 8
    s_add_u32 m0, s96, 147456
    s_cmp_lt_u32 s37, 9
    s_cselect_b64 vcc, -1, 0
    s_mul_i32 s96, s37, 72
    s_add_u32 s96, s96, s39
    v_cndmask_b32 v16, v21, v20, vcc
    s_cmp_ge_u32 s37, 18
    s_cselect_b32 s96, 0x100000, s96
    buffer_load_dword v16, s[40:43], s96 offen lds
    s_add_u32 s37, s38, 3
    s_lshl_b32 s96, s37, 8
    s_add_u32 m0, s96, 147456
    s_cmp_lt_u32 s37, 9
    s_cselect_b64 vcc, -1, 0
    s_mul_i32 s96, s37, 72
    s_add_u32 s96, s96, s39
    v_cndmask_b32 v16, v21, v20, vcc
    s_cmp_ge_u32 s37, 18
    s_cselect_b32 s96, 0x100000, s96
    buffer_load_dword v16, s[40:43], s96 offen lds
    s_add_u32 s37, s38, 4
    s_lshl_b32 s96, s37, 8
    s_add_u32 m0, s96, 147456
    s_cmp_lt_u32 s37, 9
    s_cselect_b64 vcc, -1, 0
    s_mul_i32 s96, s37, 72
    s_add_u32 s96, s96, s39
    v_cndmask_b32 v16, v21, v20, vcc
    s_cmp_ge_u32 s37, 18
    s_cselect_b32 s96, 0x100000, s96
    buffer_load_dword v16, s[40:43], s96 offen lds
    s_add_u32 s37, s38, 5
    s_lshl_b32 s96, s37, 8
    s_add_u32 m0, s96, 147456
    s_cmp_lt_u32 s37, 9
    s_cselect_b64 vcc, -1, 0
    s_mul_i32 s96, s37, 72
    s_add_u32 s96, s96, s39
    v_cndmask_b32 v16, v21, v20, vcc
    s_cmp_ge_u32 s37, 18
    s_cselect_b32 s96, 0x100000, s96
    buffer_load_dword v16, s[40:43], s96 offen lds
    s_sub_u32 s44, s10, 2048
    s_subb_u32 s45, s11, 0
    s_mov_b32 s46, 665600
    s_mov_b32 s47, 0x20000
    s_mul_i32 s38, s31, 36
    s_add_u32 s38, s38, s35
    s_lshl_b32 s54, s38, 2
    s_add_u32 s54, s54, 46923776
    s_mul_i32 s38, s38, 1152
    s_add_u32 s38, s38, 2048
    s_cmp_lt_u32 s32, 9
    s_cselect_b32 s39, 0, 2147483392
    s_add_u32 s38, s38, s39
    s_add_u32 s54, s54, s39
    s_mov_b32 s55, s38
    buffer_load_dwordx4 v[220:223], v5, s[44:47], s38 offen
    v_mov_b32 v224, 0
    v_mov_b32 v225, 0
    v_mov_b32 v226, 0
    v_mov_b32 v227, 0
    s_mov_b64 exec, 0xff
    buffer_load_dwordx4 v[224:227], v5, s[44:47], s38 offen offset:1024
    s_mov_b64 exec, -1
    s_lshr_b32 s38, 0xaa55, s31
    s_and_b32 s38, s38, 1
    s_cbranch_scc0 K_not4
    s_and_b32 s38, s28, 3
    s_lshr_b32 s39, s28, 3
    s_lshl_b32 s39, s39, 2
    s_add_u32 s38, s38, s39
    s_lshl_b32 s38, s38, 2
    s_add_u32 s38, s38, s30
    s_mul_i32 s38, s38, 31104
    s_add_u32 s38, s38, 3712
    v_mul_u32_u24 v16, 32769, v15
    v_lshrrev_b32 v16, 16, v16
    v_mul_u32_u24 v17, 2, v16
    v_sub_u32 v17, v15, v17
    v_mul_u32_u24 v16, 3456, v16
    v_mul_u32_u24 v17, 1152, v17
    v_add_u32 v16, v16, v17
    s_mov_b64 exec, 262143
    buffer_load_dword a4, v16, s[16:19], s38 offen
    s_mov_b64 exec, -1
K_not4:
    s_load_dwordx8 s[4:11], s[0:1], 40
    s_getpc_b64 s[88:89]
Ktpc_3:
    s_add_u32 s88, s88, K_tab-Ktpc_3
    s_addc_u32 s89, s89, 0
    s_mov_b32 s90, K_tab_end-K_tab
    s_mov_b32 s91, 0x20000
    s_and_b32 s37, s32, 3
    s_lshl_b32 s37, s37, 1
    s_and_b32 s99, s31, 7
    s_add_u32 s99, s99, s37
    s_cmp_ge_u32 s99, 9
    s_cselect_b32 s37, 9, 0
    s_sub_u32 s99, s99, s37
    s_mul_i32 s101, s30, 55296
    s_mul_i32 s37, s31, 72
    s_add_u32 s101, s101, s37
    s_add_u32 s100, s101, 1990656
    s_mul_i32 s37, s99, 221184
    s_add_u32 s101, s101, s37
    s_mov_b32 s51, s101
    s_barrier
    s_add_u32 m0, s34, 0
    s_nop 0
    buffer_load_dwordx4 v0, s[16:19], s101 offen offset:0 lds
    buffer_load_dwordx4 v1, s[16:19], s101 offen offset:1024 lds
    s_mov_b32 exec_hi, 0xffff
    buffer_load_dwordx4 v2, s[16:19], s101 offen offset:2048 lds
    s_mov_b32 exec_hi, -1
    s_add_u32 m0, s34, 2816
    s_add_u32 s101, s101, 221184
    s_cmp_ge_u32 s101, s100
    s_cselect_b32 s37, 1990656, 0
    s_sub_u32 s101, s101, s37
    buffer_load_dwordx4 v0, s[16:19], s101 offen offset:0 lds
    buffer_load_dwordx4 v1, s[16:19], s101 offen offset:1024 lds
    s_mov_b32 exec_hi, 0xffff
    buffer_load_dwordx4 v2, s[16:19], s101 offen offset:2048 lds
    s_mov_b32 exec_hi, -1
    s_mov_b32 s50, 0x3f803f80
    v_and_b32 v16, 7, v15
    v_lshrrev_b32 v17, 5, v15
    v_lshlrev_b32 v18, 4, v16
    v_lshl_add_u32 v19, v17, 7, v18
    v_lshl_add_u32 v6, v17, 11, v18
    v_bfe_u32 v17, v15, 3, 2
    v_lshl_add_u32 v6, v17, 8, v6
    s_lshl_b32 s37, s30, 2
    s_add_u32 s37, s37, 157696
    v_add_u32 v19, s37, v19
    v_add_u32 v18, 157696, v18
    s_lshr_b32 s36, s31, 2
    s_lshl_b32 s37, s32, 2
    s_add_u32 s36, s36, s37
    s_mul_i32 s36, s36, 36864
    s_bfe_u32 s37, s31, 0x10001
    s_lshl_b32 s37, s37, 10
    s_add_u32 s36, s36, s37
    s_and_b32 s37, s31, 1
    s_lshl_b32 s37, s37, 7
    s_add_u32 s36, s36, s37
    s_lshl_b32 s37, s30, 12
    s_add_u32 s36, s36, s37
    s_add_u32 s36, s36, 47185920
    s_add_u32 s38, s36, 16384
    s_cmp_eq_u32 s30, 0
    s_cselect_b32 s39, 0, 2147483392
    s_add_u32 s39, s39, s38
    s_add_u32 s39, s39, 16384
    s_lshl_b32 s53, s32, 8
    s_add_u32 s53, s53, 46141440
    s_waitcnt vmcnt(14)
    s_cmp_lg_u32 s33, 515
    s_cbranch_scc1 Knoflag_4
    v_mov_b32 v16, 1
    v_mov_b32 v17, 0
    s_mov_b64 exec, 1
    buffer_store_dword v16, v17, s[24:27], 0 offen sc1
    s_mov_b64 exec, -1
Knoflag_4:
    v_dot2_f32_bf16 v24, v160, s50, 0
    v_dot2_f32_bf16 v26, v160, v160, 0
    v_dot2_f32_bf16 v25, v161, s50, 0
    v_dot2_f32_bf16 v27, v161, v161, 0
    v_dot2_f32_bf16 v24, v162, s50, v24
    v_dot2_f32_bf16 v26, v162, v162, v26
    v_dot2_f32_bf16 v25, v163, s50, v25
    v_dot2_f32_bf16 v27, v163, v163, v27
    v_dot2_f32_bf16 v24, v164, s50, v24
    v_dot2_f32_bf16 v26, v164, v164, v26
    v_dot2_f32_bf16 v25, v165, s50, v25
    v_dot2_f32_bf16 v27, v165, v165, v27
    v_dot2_f32_bf16 v24, v166, s50, v24
    v_dot2_f32_bf16 v26, v166, v166, v26
    v_dot2_f32_bf16 v25, v167, s50, v25
    v_dot2_f32_bf16 v27, v167, v167, v27
    v_dot2_f32_bf16 v24, v168, s50, v24
    v_dot2_f32_bf16 v26, v168, v168, v26
    v_dot2_f32_bf16 v25, v169, s50, v25
    v_dot2_f32_bf16 v27, v169, v169, v27
    v_dot2_f32_bf16 v24, v170, s50, v24
    v_dot2_f32_bf16 v26, v170, v170, v26
    v_dot2_f32_bf16 v25, v171, s50, v25
    v_dot2_f32_bf16 v27, v171, v171, v27
    s_nop 1
    v_add_f32 v24, v24, v25
    v_add_f32 v26, v26, v27
    s_nop 1
    v_permlane32_swap_b32 v24, v26
    v_add_f32 v24, v24, v26
    v_mov_b32 v25, v24
    s_nop 1
    v_permlane16_swap_b32 v24, v25
    v_add_f32 v24, v24, v25
    s_nop 1
    v_add_f32_dpp v24, v24, v24 row_ror:8 row_mask:0xf bank_mask:0xf
    s_mov_b32 s50, 0xffff0000
    ds_write_b32 v19, v24
    v_lshlrev_b32_e32 v176, 16, v160
    v_and_b32_e32 v177, s50, v160
    v_lshlrev_b32_e32 v178, 16, v161
    v_and_b32_e32 v179, s50, v161
    v_lshlrev_b32_e32 v180, 16, v162
    v_and_b32_e32 v181, s50, v162
    v_lshlrev_b32_e32 v182, 16, v163
    v_and_b32_e32 v183, s50, v163
    v_lshlrev_b32_e32 v184, 16, v164
    v_and_b32_e32 v185, s50, v164
    v_lshlrev_b32_e32 v186, 16, v165
    v_and_b32_e32 v187, s50, v165
    v_lshlrev_b32_e32 v188, 16, v166
    v_and_b32_e32 v189, s50, v166
    v_lshlrev_b32_e32 v190, 16, v167
    v_and_b32_e32 v191, s50, v167
    v_lshlrev_b32_e32 v192, 16, v168
    v_and_b32_e32 v193, s50, v168
    v_lshlrev_b32_e32 v194, 16, v169
    v_and_b32_e32 v195, s50, v169
    v_lshlrev_b32_e32 v196, 16, v170
    v_and_b32_e32 v197, s50, v170
    v_lshlrev_b32_e32 v198, 16, v171
    v_and_b32_e32 v199, s50, v171
    s_waitcnt lgkmcnt(0)
    s_barrier
    ds_read_b128 v[24:27], v18
    ds_read_b128 v[28:31], v18 offset:128
    s_waitcnt lgkmcnt(0)
    v_pk_add_f32 v[24:25], v[24:25], v[26:27]
    v_pk_add_f32 v[28:29], v[28:29], v[30:31]
    v_add_f32 v24, v24, v25
    v_add_f32 v26, v28, v29
    v_mul_f32 v24, 0x3ae38e39, v24
    v_mul_f32 v26, 0x3ae38e39, v26
    v_fma_f32 v26, -v24, v24, v26
    v_max_f32 v26, 0, v26
    v_add_f32 v26, 0x3727c5ac, v26
    v_rsq_f32 v12, v26
    s_nop 0
    v_mul_f32_e64 v13, -v24, v12
    v_mov_b32 v228, v24
    v_pk_fma_f32 v[176:177], v[176:177], v[12:13], v[12:13] op_sel:[0,0,1] op_sel_hi:[1,0,1]
    v_pk_fma_f32 v[178:179], v[178:179], v[12:13], v[12:13] op_sel:[0,0,1] op_sel_hi:[1,0,1]
    v_pk_fma_f32 v[180:181], v[180:181], v[12:13], v[12:13] op_sel:[0,0,1] op_sel_hi:[1,0,1]
    v_pk_fma_f32 v[182:183], v[182:183], v[12:13], v[12:13] op_sel:[0,0,1] op_sel_hi:[1,0,1]
    v_cvt_pk_bf16_f32 v160, v176, v177
    v_cvt_pk_bf16_f32 v161, v178, v179
    v_cvt_pk_bf16_f32 v162, v180, v181
    v_cvt_pk_bf16_f32 v163, v182, v183
    buffer_store_dwordx4 v[160:163], v6, s[20:23], s36 offen sc1
    v_pk_fma_f32 v[184:185], v[184:185], v[12:13], v[12:13] op_sel:[0,0,1] op_sel_hi:[1,0,1]
    v_pk_fma_f32 v[186:187], v[186:187], v[12:13], v[12:13] op_sel:[0,0,1] op_sel_hi:[1,0,1]
    v_pk_fma_f32 v[188:189], v[188:189], v[12:13], v[12:13] op_sel:[0,0,1] op_sel_hi:[1,0,1]
    v_pk_fma_f32 v[190:191], v[190:191], v[12:13], v[12:13] op_sel:[0,0,1] op_sel_hi:[1,0,1]
    v_cvt_pk_bf16_f32 v164, v184, v185
    v_cvt_pk_bf16_f32 v165, v186, v187
    v_cvt_pk_bf16_f32 v166, v188, v189
    v_cvt_pk_bf16_f32 v167, v190, v191
    buffer_store_dwordx4 v[164:167], v6, s[20:23], s38 offen sc1
    v_pk_fma_f32 v[192:193], v[192:193], v[12:13], v[12:13] op_sel:[0,0,1] op_sel_hi:[1,0,1]
    v_pk_fma_f32 v[194:195], v[194:195], v[12:13], v[12:13] op_sel:[0,0,1] op_sel_hi:[1,0,1]
    v_pk_fma_f32 v[196:197], v[196:197], v[12:13], v[12:13] op_sel:[0,0,1] op_sel_hi:[1,0,1]
    v_pk_fma_f32 v[198:199], v[198:199], v[12:13], v[12:13] op_sel:[0,0,1] op_sel_hi:[1,0,1]
    v_cvt_pk_bf16_f32 v168, v192, v193
    v_cvt_pk_bf16_f32 v169, v194, v195
    v_cvt_pk_bf16_f32 v170, v196, v197
    v_cvt_pk_bf16_f32 v171, v198, v199
    buffer_store_dwordx4 v[168:171], v6, s[20:23], s39 offen sc1
    v_lshrrev_b32 v16, 3, v15
    v_lshlrev_b32 v16, 8, v16
    v_and_b32 v17, 7, v15
    v_lshl_add_u32 v16, v17, 4, v16
    v_mov_b32 v20, 0
    v_mov_b32 v21, 0
    v_mov_b32 v22, 0
    v_mov_b32 v23, 0
    s_lshl_b32 s37, s32, 4
    s_add_u32 s37, s37, s31
    s_lshl_b32 s37, s37, 9
    s_add_u32 s37, s37, 46145536
    s_cmp_eq_u32 s30, 1
    s_cselect_b32 exec_lo, 0xffff, 0
    s_cbranch_scc0 K_nozero
    s_mov_b32 exec_hi, 0
    buffer_store_dwordx4 v[20:23], v16, s[20:23], s37 offen sc1
K_nozero:
    s_mov_b64 exec, -1
    v_mov_b32 v16, 0
    buffer_load_dword v31, v16, s[24:27], 0 offen sc1
    v_mov_b32 v24, 0
    v_mov_b32 v25, 0
    v_mov_b32 v26, 0
    v_mov_b32 v27, 0
    v_lshlrev_b32 v16, 4, v14
    v_add_u32 v16, 153600, v16
    ds_write_b128 v16, v[24:27]
    s_mov_b32 s48, 1069066811
    s_mov_b32 s49, 1069066811
    s_lshl_b32 s38, s31, 6
    s_add_u32 s38, s38, s30
    s_mul_i32 s52, s38, 1024
    s_add_u32 s52, s52, 44040192
    v_accvgpr_write_b32 a246, 0
    v_accvgpr_write_b32 a247, 0
    v_accvgpr_write_b32 a250, 0
    v_accvgpr_write_b32 a251, 0
    v_accvgpr_write_b32 a254, 0
    v_accvgpr_write_b32 a255, 0
    v_mov_b32 v181, 0
    v_mov_b32 v193, 0
    v_mov_b32 v187, 0
    v_mov_b32 v199, 0
    v_mov_b32 v42, 0
    v_mov_b32 v43, 0
    v_mov_b32 v209, 0x3f80
    v_mov_b32 v46, 0
    v_mov_b32 v47, 0
    v_mov_b32 v211, 0x3f80
    buffer_load_dwordx4 v[112:115], v5, s[88:91], 0 offen offset:0
    buffer_load_dwordx4 v[116:119], v5, s[88:91], 0 offen offset:1024
    buffer_load_dwordx4 v[120:123], v5, s[88:91], 0 offen offset:2048
    buffer_load_dwordx4 v[124:127], v5, s[88:91], 0 offen offset:3072
    s_movk_i32 s3, 4096
    buffer_load_dwordx4 v[128:131], v5, s[88:91], s3 offen offset:0
    s_movk_i32 s3, 4096
    buffer_load_dwordx4 v[132:135], v5, s[88:91], s3 offen offset:1024
    s_movk_i32 s3, 4096
    buffer_load_dwordx4 v[136:139], v5, s[88:91], s3 offen offset:2048
    s_movk_i32 s3, 4096
    buffer_load_dwordx4 v[212:215], v5, s[88:91], s3 offen offset:3072
    s_movk_i32 s3, 8192
    buffer_load_dwordx4 v[8:11], v5, s[88:91], s3 offen offset:0
    s_movk_i32 s3, 8192
    buffer_load_dwordx4 v[216:219], v5, s[88:91], s3 offen offset:1024
    s_movk_i32 s3, 8192
    buffer_load_dwordx4 v[172:175], v5, s[88:91], s3 offen offset:2048
    s_movk_i32 s3, 8192
    buffer_load_dwordx4 a[224:227], v5, s[88:91], s3 offen offset:3072
    s_movk_i32 s3, 12288
    buffer_load_dwordx4 a[228:231], v5, s[88:91], s3 offen offset:0
    s_waitcnt vmcnt(13)
    s_barrier
    s_cmp_lg_u32 s30, 0
    s_cbranch_scc1 Ksig_5
    s_mov_b32 s97, 0
Kini_6:
    v_readfirstlane_b32 s98, v31
    s_nop 0
    s_cmp_eq_u32 s98, 1
    s_cbranch_scc1 Kinid_7
    v_mov_b32 v16, 0
    buffer_load_dword v31, v16, s[24:27], 0 offen sc1
    s_add_u32 s97, s97, 1
    s_cmp_lt_u32 s97, 0x100000
    s_waitcnt vmcnt(0)
    s_cbranch_scc1 Kini_6
Kinid_7:
    s_mov_b32 s98, 1
    s_atomic_add s98, s[20:21], s53
Ksig_5:
    s_mul_i32 s27, s28, 43
    s_lshr_b32 s27, s27, 8
    s_mul_i32 s26, s27, 6
    s_sub_u32 s26, s28, s26
    s_lshl_b32 s37, s29, 2
    s_add_u32 s27, s27, s37
    s_add_u32 m0, s34, 5632
    s_add_u32 s101, s101, 221184
    s_cmp_ge_u32 s101, s100
    s_cselect_b32 s37, 1990656, 0
    s_sub_u32 s101, s101, s37
    buffer_load_dwordx4 v0, s[16:19], s101 offen offset:0 lds
    buffer_load_dwordx4 v1, s[16:19], s101 offen offset:1024 lds
    s_mov_b32 exec_hi, 0xffff
    buffer_load_dwordx4 v2, s[16:19], s101 offen offset:2048 lds
    s_mov_b32 exec_hi, -1
    s_add_u32 m0, s34, 8448
    s_add_u32 s101, s101, 221184
    s_cmp_ge_u32 s101, s100
    s_cselect_b32 s37, 1990656, 0
    s_sub_u32 s101, s101, s37
    buffer_load_dwordx4 v0, s[16:19], s101 offen offset:0 lds
    buffer_load_dwordx4 v1, s[16:19], s101 offen offset:1024 lds
    s_mov_b32 exec_hi, 0xffff
    buffer_load_dwordx4 v2, s[16:19], s101 offen offset:2048 lds
    s_mov_b32 exec_hi, -1
    s_add_u32 m0, s34, 11264
    s_add_u32 s101, s101, 221184
    s_cmp_ge_u32 s101, s100
    s_cselect_b32 s37, 1990656, 0
    s_sub_u32 s101, s101, s37
    buffer_load_dwordx4 v0, s[16:19], s101 offen offset:0 lds
    buffer_load_dwordx4 v1, s[16:19], s101 offen offset:1024 lds
    s_mov_b32 exec_hi, 0xffff
    buffer_load_dwordx4 v2, s[16:19], s101 offen offset:2048 lds
    s_mov_b32 exec_hi, -1
    s_add_u32 m0, s34, 14080
    s_add_u32 s101, s101, 221184
    s_cmp_ge_u32 s101, s100
    s_cselect_b32 s37, 1990656, 0
    s_sub_u32 s101, s101, s37
    buffer_load_dwordx4 v0, s[16:19], s101 offen offset:0 lds
    buffer_load_dwordx4 v1, s[16:19], s101 offen offset:1024 lds
    s_mov_b32 exec_hi, 0xffff
    buffer_load_dwordx4 v2, s[16:19], s101 offen offset:2048 lds
    s_mov_b32 exec_hi, -1
    s_cmp_lg_u32 s30, 0
    s_cbranch_scc1 Kps_8
    s_mov_b32 s96, 0
    s_atomic_add s96, s[20:21], s53 glc
Kps_8:
    s_add_u32 m0, s34, 16896
    s_add_u32 s101, s101, 221184
    s_cmp_ge_u32 s101, s100
    s_cselect_b32 s37, 1990656, 0
    s_sub_u32 s101, s101, s37
    buffer_load_dwordx4 v0, s[16:19], s101 offen offset:0 lds
    buffer_load_dwordx4 v1, s[16:19], s101 offen offset:1024 lds
    s_mov_b32 exec_hi, 0xffff
    buffer_load_dwordx4 v2, s[16:19], s101 offen offset:2048 lds
    s_mov_b32 exec_hi, -1
    s_add_u32 m0, s34, 19712
    s_add_u32 s101, s101, 221184
    s_cmp_ge_u32 s101, s100
    s_cselect_b32 s37, 1990656, 0
    s_sub_u32 s101, s101, s37
    buffer_load_dwordx4 v0, s[16:19], s101 offen offset:0 lds
    buffer_load_dwordx4 v1, s[16:19], s101 offen offset:1024 lds
    s_mov_b32 exec_hi, 0xffff
    buffer_load_dwordx4 v2, s[16:19], s101 offen offset:2048 lds
    s_mov_b32 exec_hi, -1
    s_mul_i32 s36, s35, 36864
    s_add_u32 s36, s36, 47185920
    s_add_u32 s33, s36, 36864
    s_lshl_b32 s37, s99, 12
    s_add_u32 s36, s36, s37
    s_cmp_lg_u32 s30, 0
    s_cbranch_scc1 Kpf_9
    s_mov_b32 s97, 0
Kpfl_10:
    s_waitcnt lgkmcnt(0)
    s_cmp_ge_u32 s96, 16
    s_cbranch_scc1 Kpf_9
    s_mov_b32 s96, 0
    s_atomic_add s96, s[20:21], s53 glc
    s_add_u32 s97, s97, 1
    s_cmp_lt_u32 s97, 0x100000
    s_cbranch_scc1 Kpfl_10
    s_waitcnt lgkmcnt(0)
Kpf_9:
    s_barrier
    buffer_load_dwordx4 a[64:67], v5, s[20:23], s36 offen offset:0 sc1
    buffer_load_dwordx4 a[68:71], v5, s[20:23], s36 offen offset:1024 sc1
    buffer_load_dwordx4 a[72:75], v5, s[20:23], s36 offen offset:2048 sc1
    buffer_load_dwordx4 a[76:79], v5, s[20:23], s36 offen offset:3072 sc1
    s_add_u32 s36, s36, 4096
    s_cmp_ge_u32 s36, s33
    s_cselect_b32 s37, 36864, 0
    s_sub_u32 s36, s36, s37
    buffer_load_dwordx4 a[80:83], v5, s[20:23], s36 offen offset:0 sc1
    buffer_load_dwordx4 a[84:87], v5, s[20:23], s36 offen offset:1024 sc1
    buffer_load_dwordx4 a[88:91], v5, s[20:23], s36 offen offset:2048 sc1
    buffer_load_dwordx4 a[92:95], v5, s[20:23], s36 offen offset:3072 sc1
    s_waitcnt vmcnt(26)
    v_mov_b32 v164, v212
    v_mov_b32 v165, v213
    v_mov_b32 v166, v214
    v_mov_b32 v167, v215
    v_mov_b32 v168, v216
    v_mov_b32 v169, v217
    v_mov_b32 v170, v218
    v_mov_b32 v171, v219
    s_waitcnt vmcnt(23)
    s_barrier
    ds_read_b64_tr_b16 a[0:1], v112 offset:0
    ds_read_b64_tr_b16 a[2:3], v112 offset:176
    ds_read_b64_tr_b16 a[4:5], v112 offset:32
    ds_read_b64_tr_b16 a[6:7], v112 offset:208
    ds_read_b64_tr_b16 a[8:9], v114 offset:0
    ds_read_b64_tr_b16 a[10:11], v114 offset:176
    ds_read_b64_tr_b16 a[12:13], v112 offset:80
    ds_read_b64_tr_b16 a[14:15], v112 offset:256
    ds_read_b64_tr_b16 a[16:17], v112 offset:128
    ds_read_b64_tr_b16 a[18:19], v112 offset:304
    ds_read_b64_tr_b16 a[20:21], v113 offset:0
    ds_read_b64_tr_b16 a[22:23], v113 offset:176
    s_waitcnt vmcnt(6)
    s_waitcnt lgkmcnt(10)
    v_mfma_f32_16x16x32_bf16 v[48:51], a[0:3], a[64:67], 0
    ds_read_b64_tr_b16 a[24:25], v113 offset:32
    v_mfma_f32_16x16x32_bf16 v[52:55], a[0:3], a[68:71], 0
    s_waitcnt lgkmcnt(9)
    ds_read_b64_tr_b16 a[26:27], v113 offset:208
    s_add_u32 s36, s36, 4096
    s_cmp_ge_u32 s36, s33
    s_cselect_b32 s37, 36864, 0
    s_sub_u32 s36, s36, s37
    buffer_load_dwordx4 a[96:99], v5, s[20:23], s36 offen offset:0 sc1
    v_mfma_f32_16x16x32_bf16 v[56:59], a[4:7], a[64:67], 0
    ds_read_b64_tr_b16 a[28:29], v115 offset:0
    v_mfma_f32_16x16x32_bf16 v[60:63], a[4:7], a[68:71], 0
    s_waitcnt lgkmcnt(9)
    ds_read_b64_tr_b16 a[30:31], v115 offset:176
    v_mfma_f32_16x16x32_bf16 v[80:83], a[8:11], a[64:67], 0
    ds_read_b64_tr_b16 a[0:1], v113 offset:80
    v_mfma_f32_16x16x32_bf16 v[84:87], a[8:11], a[68:71], 0
    s_waitcnt lgkmcnt(9)
    ds_read_b64_tr_b16 a[2:3], v113 offset:256
    buffer_load_dwordx4 a[100:103], v5, s[20:23], s36 offen offset:1024 sc1
    v_mfma_f32_16x16x32_bf16 v[64:67], a[12:15], a[64:67], 0
    ds_read_b64_tr_b16 a[4:5], v113 offset:128
    v_mfma_f32_16x16x32_bf16 v[68:71], a[12:15], a[68:71], 0
    s_waitcnt lgkmcnt(9)
    ds_read_b64_tr_b16 a[6:7], v113 offset:304
    v_mfma_f32_16x16x32_bf16 v[72:75], a[16:19], a[64:67], 0
    ds_read_b64_tr_b16 a[8:9], v112 offset:2816
    v_mfma_f32_16x16x32_bf16 v[76:79], a[16:19], a[68:71], 0
    s_waitcnt lgkmcnt(9)
    ds_read_b64_tr_b16 a[10:11], v112 offset:2992
    buffer_load_dwordx4 a[104:107], v5, s[20:23], s36 offen offset:2048 sc1
    s_waitcnt vmcnt(7)
    v_mfma_f32_16x16x32_bf16 v[48:51], a[20:23], a[72:75], v[48:51]
    ds_read_b64_tr_b16 a[12:13], v112 offset:2848
    v_mfma_f32_16x16x32_bf16 v[52:55], a[20:23], a[76:79], v[52:55]
    s_waitcnt lgkmcnt(9)
    ds_read_b64_tr_b16 a[14:15], v112 offset:3024
    v_mfma_f32_16x16x32_bf16 v[56:59], a[24:27], a[72:75], v[56:59]
    ds_read_b64_tr_b16 a[16:17], v114 offset:2816
    v_mfma_f32_16x16x32_bf16 v[60:63], a[24:27], a[76:79], v[60:63]
    s_waitcnt lgkmcnt(9)
    ds_read_b64_tr_b16 a[18:19], v114 offset:2992
    buffer_load_dwordx4 a[108:111], v5, s[20:23], s36 offen offset:3072 sc1
    v_mfma_f32_16x16x32_bf16 v[80:83], a[28:31], a[72:75], v[80:83]
    ds_read_b64_tr_b16 a[20:21], v112 offset:2896
    v_mfma_f32_16x16x32_bf16 v[84:87], a[28:31], a[76:79], v[84:87]
    s_waitcnt lgkmcnt(9)
    ds_read_b64_tr_b16 a[22:23], v112 offset:3072
    v_mfma_f32_16x16x32_bf16 v[64:67], a[0:3], a[72:75], v[64:67]
    ds_read_b64_tr_b16 a[24:25], v112 offset:2944
    v_mfma_f32_16x16x32_bf16 v[68:71], a[0:3], a[76:79], v[68:71]
    s_waitcnt lgkmcnt(9)
    ds_read_b64_tr_b16 a[26:27], v112 offset:3120
    s_add_u32 s36, s36, 4096
    s_cmp_ge_u32 s36, s33
    s_cselect_b32 s37, 36864, 0
    s_sub_u32 s36, s36, s37
    buffer_load_dwordx4 a[112:115], v5, s[20:23], s36 offen offset:0 sc1
    v_mfma_f32_16x16x32_bf16 v[72:75], a[4:7], a[72:75], v[72:75]
    ds_read_b64_tr_b16 a[28:29], v113 offset:2816
    v_mfma_f32_16x16x32_bf16 v[76:79], a[4:7], a[76:79], v[76:79]
    s_waitcnt lgkmcnt(9)
    ds_read_b64_tr_b16 a[30:31], v113 offset:2992
    s_waitcnt vmcnt(7)
    v_mfma_f32_16x16x32_bf16 v[48:51], a[8:11], a[80:83], v[48:51]
    ds_read_b64_tr_b16 a[0:1], v113 offset:2848
    v_mfma_f32_16x16x32_bf16 v[52:55], a[8:11], a[84:87], v[52:55]
    s_waitcnt lgkmcnt(9)
    ds_read_b64_tr_b16 a[2:3], v113 offset:3024
    buffer_load_dwordx4 a[116:119], v5, s[20:23], s36 offen offset:1024 sc1
    v_mfma_f32_16x16x32_bf16 v[56:59], a[12:15], a[80:83], v[56:59]
    ds_read_b64_tr_b16 a[4:5], v115 offset:2816
    v_mfma_f32_16x16x32_bf16 v[60:63], a[12:15], a[84:87], v[60:63]
    s_waitcnt lgkmcnt(9)
    ds_read_b64_tr_b16 a[6:7], v115 offset:2992
    v_mfma_f32_16x16x32_bf16 v[80:83], a[16:19], a[80:83], v[80:83]
    ds_read_b64_tr_b16 a[8:9], v113 offset:2896
    v_mfma_f32_16x16x32_bf16 v[84:87], a[16:19], a[84:87], v[84:87]
    s_waitcnt lgkmcnt(9)
    ds_read_b64_tr_b16 a[10:11], v113 offset:3072
    buffer_load_dwordx4 a[120:123], v5, s[20:23], s36 offen offset:2048 sc1
    v_mfma_f32_16x16x32_bf16 v[64:67], a[20:23], a[80:83], v[64:67]
    ds_read_b64_tr_b16 a[12:13], v113 offset:2944
    v_mfma_f32_16x16x32_bf16 v[68:71], a[20:23], a[84:87], v[68:71]
    s_waitcnt lgkmcnt(9)
    ds_read_b64_tr_b16 a[14:15], v113 offset:3120
    v_mfma_f32_16x16x32_bf16 v[72:75], a[24:27], a[80:83], v[72:75]
    ds_read_b64_tr_b16 a[16:17], v112 offset:5632
    v_mfma_f32_16x16x32_bf16 v[76:79], a[24:27], a[84:87], v[76:79]
    s_waitcnt lgkmcnt(9)
    ds_read_b64_tr_b16 a[18:19], v112 offset:5808
    buffer_load_dwordx4 a[124:127], v5, s[20:23], s36 offen offset:3072 sc1
    s_waitcnt vmcnt(8)
    v_mfma_f32_16x16x32_bf16 v[48:51], a[28:31], a[88:91], v[48:51]
    ds_read_b64_tr_b16 a[20:21], v112 offset:5664
    v_mfma_f32_16x16x32_bf16 v[52:55], a[28:31], a[92:95], v[52:55]
    s_waitcnt lgkmcnt(9)
    ds_read_b64_tr_b16 a[22:23], v112 offset:5840
    v_mfma_f32_16x16x32_bf16 v[56:59], a[0:3], a[88:91], v[56:59]
    ds_read_b64_tr_b16 a[24:25], v114 offset:5632
    v_mfma_f32_16x16x32_bf16 v[60:63], a[0:3], a[92:95], v[60:63]
    s_waitcnt lgkmcnt(9)
    ds_read_b64_tr_b16 a[26:27], v114 offset:5808
    s_add_u32 s36, s36, 4096
    s_cmp_ge_u32 s36, s33
    s_cselect_b32 s37, 36864, 0
    s_sub_u32 s36, s36, s37
    buffer_load_dwordx4 a[128:131], v5, s[20:23], s36 offen offset:0 sc1
    v_mfma_f32_16x16x32_bf16 v[80:83], a[4:7], a[88:91], v[80:83]
    ds_read_b64_tr_b16 a[28:29], v112 offset:5712
    v_mfma_f32_16x16x32_bf16 v[84:87], a[4:7], a[92:95], v[84:87]
    s_waitcnt lgkmcnt(9)
    ds_read_b64_tr_b16 a[30:31], v112 offset:5888
    v_mfma_f32_16x16x32_bf16 v[64:67], a[8:11], a[88:91], v[64:67]
    ds_read_b64_tr_b16 a[0:1], v112 offset:5760
    v_mfma_f32_16x16x32_bf16 v[68:71], a[8:11], a[92:95], v[68:71]
    s_waitcnt lgkmcnt(9)
    ds_read_b64_tr_b16 a[2:3], v112 offset:5936
    buffer_load_dwordx4 a[132:135], v5, s[20:23], s36 offen offset:1024 sc1
    v_mfma_f32_16x16x32_bf16 v[72:75], a[12:15], a[88:91], v[72:75]
    ds_read_b64_tr_b16 a[4:5], v113 offset:5632
    v_mfma_f32_16x16x32_bf16 v[76:79], a[12:15], a[92:95], v[76:79]
    s_waitcnt lgkmcnt(9)
    ds_read_b64_tr_b16 a[6:7], v113 offset:5808
    s_waitcnt vmcnt(8)
    v_mfma_f32_16x16x32_bf16 v[48:51], a[16:19], a[96:99], v[48:51]
    ds_read_b64_tr_b16 a[8:9], v113 offset:5664
    v_mfma_f32_16x16x32_bf16 v[52:55], a[16:19], a[100:103], v[52:55]
    s_waitcnt lgkmcnt(9)
    ds_read_b64_tr_b16 a[10:11], v113 offset:5840
    buffer_load_dwordx4 a[136:139], v5, s[20:23], s36 offen offset:2048 sc1
    v_mfma_f32_16x16x32_bf16 v[56:59], a[20:23], a[96:99], v[56:59]
    ds_read_b64_tr_b16 a[12:13], v115 offset:5632
    v_mfma_f32_16x16x32_bf16 v[60:63], a[20:23], a[100:103], v[60:63]
    s_waitcnt lgkmcnt(9)
    ds_read_b64_tr_b16 a[14:15], v115 offset:5808
    v_mfma_f32_16x16x32_bf16 v[80:83], a[24:27], a[96:99], v[80:83]
    ds_read_b64_tr_b16 a[16:17], v113 offset:5712
    v_mfma_f32_16x16x32_bf16 v[84:87], a[24:27], a[100:103], v[84:87]
    s_waitcnt lgkmcnt(9)
    ds_read_b64_tr_b16 a[18:19], v113 offset:5888
    buffer_load_dwordx4 a[140:143], v5, s[20:23], s36 offen offset:3072 sc1
    v_mfma_f32_16x16x32_bf16 v[64:67], a[28:31], a[96:99], v[64:67]
    ds_read_b64_tr_b16 a[20:21], v113 offset:5760
    v_mfma_f32_16x16x32_bf16 v[68:71], a[28:31], a[100:103], v[68:71]
    s_waitcnt lgkmcnt(9)
    ds_read_b64_tr_b16 a[22:23], v113 offset:5936
    v_mfma_f32_16x16x32_bf16 v[72:75], a[0:3], a[96:99], v[72:75]
    s_barrier
    ds_read_b64_tr_b16 a[24:25], v112 offset:8448
    v_mfma_f32_16x16x32_bf16 v[76:79], a[0:3], a[100:103], v[76:79]
    s_waitcnt lgkmcnt(9)
    ds_read_b64_tr_b16 a[26:27], v112 offset:8624
    s_add_u32 m0, s34, 22528
    s_add_u32 s101, s101, 221184
    s_cmp_ge_u32 s101, s100
    s_cselect_b32 s37, 1990656, 0
    s_sub_u32 s101, s101, s37
    buffer_load_dwordx4 v0, s[16:19], s101 offen offset:0 lds
    s_waitcnt vmcnt(9)
    v_mfma_f32_16x16x32_bf16 v[48:51], a[4:7], a[104:107], v[48:51]
    ds_read_b64_tr_b16 a[28:29], v112 offset:8480
    v_mfma_f32_16x16x32_bf16 v[52:55], a[4:7], a[108:111], v[52:55]
    s_waitcnt lgkmcnt(9)
    ds_read_b64_tr_b16 a[30:31], v112 offset:8656
    v_mfma_f32_16x16x32_bf16 v[56:59], a[8:11], a[104:107], v[56:59]
    ds_read_b64_tr_b16 a[0:1], v114 offset:8448
    v_mfma_f32_16x16x32_bf16 v[60:63], a[8:11], a[108:111], v[60:63]
    s_waitcnt lgkmcnt(9)
    ds_read_b64_tr_b16 a[2:3], v114 offset:8624
    buffer_load_dwordx4 v1, s[16:19], s101 offen offset:1024 lds
    v_mfma_f32_16x16x32_bf16 v[80:83], a[12:15], a[104:107], v[80:83]
    ds_read_b64_tr_b16 a[4:5], v112 offset:8528
    v_mfma_f32_16x16x32_bf16 v[84:87], a[12:15], a[108:111], v[84:87]
    s_waitcnt lgkmcnt(9)
    ds_read_b64_tr_b16 a[6:7], v112 offset:8704
    v_mfma_f32_16x16x32_bf16 v[64:67], a[16:19], a[104:107], v[64:67]
    ds_read_b64_tr_b16 a[8:9], v112 offset:8576
    v_mfma_f32_16x16x32_bf16 v[68:71], a[16:19], a[108:111], v[68:71]
    s_waitcnt lgkmcnt(9)
    ds_read_b64_tr_b16 a[10:11], v112 offset:8752
    s_mov_b32 exec_hi, 0xffff
    buffer_load_dwordx4 v2, s[16:19], s101 offen offset:2048 lds
    s_mov_b32 exec_hi, -1
    v_mfma_f32_16x16x32_bf16 v[72:75], a[20:23], a[104:107], v[72:75]
    ds_read_b64_tr_b16 a[12:13], v113 offset:8448
    v_mfma_f32_16x16x32_bf16 v[76:79], a[20:23], a[108:111], v[76:79]
    s_waitcnt lgkmcnt(9)
    ds_read_b64_tr_b16 a[14:15], v113 offset:8624
    s_waitcnt vmcnt(9)
    v_mfma_f32_16x16x32_bf16 v[48:51], a[24:27], a[112:115], v[48:51]
    ds_read_b64_tr_b16 a[16:17], v113 offset:8480
    v_mfma_f32_16x16x32_bf16 v[52:55], a[24:27], a[116:119], v[52:55]
    s_waitcnt lgkmcnt(9)
    ds_read_b64_tr_b16 a[18:19], v113 offset:8656
    s_add_u32 s36, s36, 4096
    s_cmp_ge_u32 s36, s33
    s_cselect_b32 s37, 36864, 0
    s_sub_u32 s36, s36, s37
    buffer_load_dwordx4 a[144:147], v5, s[20:23], s36 offen offset:0 sc1
    v_mfma_f32_16x16x32_bf16 v[56:59], a[28:31], a[112:115], v[56:59]
    ds_read_b64_tr_b16 a[20:21], v115 offset:8448
    v_mfma_f32_16x16x32_bf16 v[60:63], a[28:31], a[116:119], v[60:63]
    s_waitcnt lgkmcnt(9)
    ds_read_b64_tr_b16 a[22:23], v115 offset:8624
    v_mfma_f32_16x16x32_bf16 v[80:83], a[0:3], a[112:115], v[80:83]
    ds_read_b64_tr_b16 a[24:25], v113 offset:8528
    v_mfma_f32_16x16x32_bf16 v[84:87], a[0:3], a[116:119], v[84:87]
    s_waitcnt lgkmcnt(9)
    ds_read_b64_tr_b16 a[26:27], v113 offset:8704
    buffer_load_dwordx4 a[148:151], v5, s[20:23], s36 offen offset:1024 sc1
    v_mfma_f32_16x16x32_bf16 v[64:67], a[4:7], a[112:115], v[64:67]
    ds_read_b64_tr_b16 a[28:29], v113 offset:8576
    v_mfma_f32_16x16x32_bf16 v[68:71], a[4:7], a[116:119], v[68:71]
    s_waitcnt lgkmcnt(9)
    ds_read_b64_tr_b16 a[30:31], v113 offset:8752
    v_mfma_f32_16x16x32_bf16 v[72:75], a[8:11], a[112:115], v[72:75]
    ds_read_b64_tr_b16 a[0:1], v112 offset:11264
    v_mfma_f32_16x16x32_bf16 v[76:79], a[8:11], a[116:119], v[76:79]
    s_waitcnt lgkmcnt(9)
    ds_read_b64_tr_b16 a[2:3], v112 offset:11440
    buffer_load_dwordx4 a[152:155], v5, s[20:23], s36 offen offset:2048 sc1
    s_waitcnt vmcnt(10)
    v_mfma_f32_16x16x32_bf16 v[48:51], a[12:15], a[120:123], v[48:51]
    ds_read_b64_tr_b16 a[4:5], v112 offset:11296
    v_mfma_f32_16x16x32_bf16 v[52:55], a[12:15], a[124:127], v[52:55]
    s_waitcnt lgkmcnt(9)
    ds_read_b64_tr_b16 a[6:7], v112 offset:11472
    v_mfma_f32_16x16x32_bf16 v[56:59], a[16:19], a[120:123], v[56:59]
    ds_read_b64_tr_b16 a[8:9], v114 offset:11264
    v_mfma_f32_16x16x32_bf16 v[60:63], a[16:19], a[124:127], v[60:63]
    s_waitcnt lgkmcnt(9)
    ds_read_b64_tr_b16 a[10:11], v114 offset:11440
    buffer_load_dwordx4 a[156:159], v5, s[20:23], s36 offen offset:3072 sc1
    v_mfma_f32_16x16x32_bf16 v[80:83], a[20:23], a[120:123], v[80:83]
    ds_read_b64_tr_b16 a[12:13], v112 offset:11344
    v_mfma_f32_16x16x32_bf16 v[84:87], a[20:23], a[124:127], v[84:87]
    s_waitcnt lgkmcnt(9)
    ds_read_b64_tr_b16 a[14:15], v112 offset:11520
    v_mfma_f32_16x16x32_bf16 v[64:67], a[24:27], a[120:123], v[64:67]
    ds_read_b64_tr_b16 a[16:17], v112 offset:11392
    v_mfma_f32_16x16x32_bf16 v[68:71], a[24:27], a[124:127], v[68:71]
    s_waitcnt lgkmcnt(9)
    ds_read_b64_tr_b16 a[18:19], v112 offset:11568
    s_add_u32 s36, s36, 4096
    s_cmp_ge_u32 s36, s33
    s_cselect_b32 s37, 36864, 0
    s_sub_u32 s36, s36, s37
    buffer_load_dwordx4 a[160:163], v5, s[20:23], s36 offen offset:0 sc1
    v_mfma_f32_16x16x32_bf16 v[72:75], a[28:31], a[120:123], v[72:75]
    ds_read_b64_tr_b16 a[20:21], v113 offset:11264
    v_mfma_f32_16x16x32_bf16 v[76:79], a[28:31], a[124:127], v[76:79]
    s_waitcnt lgkmcnt(9)
    ds_read_b64_tr_b16 a[22:23], v113 offset:11440
    s_waitcnt vmcnt(10)
    v_mfma_f32_16x16x32_bf16 v[48:51], a[0:3], a[128:131], v[48:51]
    ds_read_b64_tr_b16 a[24:25], v113 offset:11296
    v_mfma_f32_16x16x32_bf16 v[52:55], a[0:3], a[132:135], v[52:55]
    s_waitcnt lgkmcnt(9)
    ds_read_b64_tr_b16 a[26:27], v113 offset:11472
    buffer_load_dwordx4 a[164:167], v5, s[20:23], s36 offen offset:1024 sc1
    v_mfma_f32_16x16x32_bf16 v[56:59], a[4:7], a[128:131], v[56:59]
    ds_read_b64_tr_b16 a[28:29], v115 offset:11264
    v_mfma_f32_16x16x32_bf16 v[60:63], a[4:7], a[132:135], v[60:63]
    s_waitcnt lgkmcnt(9)
    ds_read_b64_tr_b16 a[30:31], v115 offset:11440
    v_mfma_f32_16x16x32_bf16 v[80:83], a[8:11], a[128:131], v[80:83]
    ds_read_b64_tr_b16 a[0:1], v113 offset:11344
    v_mfma_f32_16x16x32_bf16 v[84:87], a[8:11], a[132:135], v[84:87]
    s_waitcnt lgkmcnt(9)
    ds_read_b64_tr_b16 a[2:3], v113 offset:11520
    buffer_load_dwordx4 a[168:171], v5, s[20:23], s36 offen offset:2048 sc1
    v_mfma_f32_16x16x32_bf16 v[64:67], a[12:15], a[128:131], v[64:67]
    ds_read_b64_tr_b16 a[4:5], v113 offset:11392
    v_mfma_f32_16x16x32_bf16 v[68:71], a[12:15], a[132:135], v[68:71]
    s_waitcnt lgkmcnt(9)
    ds_read_b64_tr_b16 a[6:7], v113 offset:11568
    v_mfma_f32_16x16x32_bf16 v[72:75], a[16:19], a[128:131], v[72:75]
    ds_read_b64_tr_b16 a[8:9], v112 offset:14080
    v_mfma_f32_16x16x32_bf16 v[76:79], a[16:19], a[132:135], v[76:79]
    s_waitcnt lgkmcnt(9)
    ds_read_b64_tr_b16 a[10:11], v112 offset:14256
    buffer_load_dwordx4 a[172:175], v5, s[20:23], s36 offen offset:3072 sc1
    s_waitcnt vmcnt(11)
    v_mfma_f32_16x16x32_bf16 v[48:51], a[20:23], a[136:139], v[48:51]
    ds_read_b64_tr_b16 a[12:13], v112 offset:14112
    v_mfma_f32_16x16x32_bf16 v[52:55], a[20:23], a[140:143], v[52:55]
    s_waitcnt lgkmcnt(9)
    ds_read_b64_tr_b16 a[14:15], v112 offset:14288
    v_mfma_f32_16x16x32_bf16 v[56:59], a[24:27], a[136:139], v[56:59]
    ds_read_b64_tr_b16 a[16:17], v114 offset:14080
    v_mfma_f32_16x16x32_bf16 v[60:63], a[24:27], a[140:143], v[60:63]
    s_waitcnt lgkmcnt(9)
    ds_read_b64_tr_b16 a[18:19], v114 offset:14256
    s_add_u32 s36, s36, 4096
    s_cmp_ge_u32 s36, s33
    s_cselect_b32 s37, 36864, 0
    s_sub_u32 s36, s36, s37
    buffer_load_dwordx4 a[176:179], v5, s[20:23], s36 offen offset:0 sc1
    v_mfma_f32_16x16x32_bf16 v[80:83], a[28:31], a[136:139], v[80:83]
    ds_read_b64_tr_b16 a[20:21], v112 offset:14160
    v_mfma_f32_16x16x32_bf16 v[84:87], a[28:31], a[140:143], v[84:87]
    s_waitcnt lgkmcnt(9)
    ds_read_b64_tr_b16 a[22:23], v112 offset:14336
    v_mfma_f32_16x16x32_bf16 v[64:67], a[0:3], a[136:139], v[64:67]
    ds_read_b64_tr_b16 a[24:25], v112 offset:14208
    v_mfma_f32_16x16x32_bf16 v[68:71], a[0:3], a[140:143], v[68:71]
    s_waitcnt lgkmcnt(9)
    ds_read_b64_tr_b16 a[26:27], v112 offset:14384
    buffer_load_dwordx4 a[180:183], v5, s[20:23], s36 offen offset:1024 sc1
    v_mfma_f32_16x16x32_bf16 v[72:75], a[4:7], a[136:139], v[72:75]
    ds_read_b64_tr_b16 a[28:29], v113 offset:14080
    v_mfma_f32_16x16x32_bf16 v[76:79], a[4:7], a[140:143], v[76:79]
    s_waitcnt lgkmcnt(9)
    ds_read_b64_tr_b16 a[30:31], v113 offset:14256
    s_waitcnt vmcnt(8)
    v_mfma_f32_16x16x32_bf16 v[48:51], a[8:11], a[144:147], v[48:51]
    ds_read_b64_tr_b16 a[0:1], v113 offset:14112
    v_mfma_f32_16x16x32_bf16 v[52:55], a[8:11], a[148:151], v[52:55]
    s_waitcnt lgkmcnt(9)
    ds_read_b64_tr_b16 a[2:3], v113 offset:14288
    buffer_load_dwordx4 a[184:187], v5, s[20:23], s36 offen offset:2048 sc1
    v_mfma_f32_16x16x32_bf16 v[56:59], a[12:15], a[144:147], v[56:59]
    ds_read_b64_tr_b16 a[4:5], v115 offset:14080
    v_mfma_f32_16x16x32_bf16 v[60:63], a[12:15], a[148:151], v[60:63]
    s_waitcnt lgkmcnt(9)
    ds_read_b64_tr_b16 a[6:7], v115 offset:14256
    v_mfma_f32_16x16x32_bf16 v[80:83], a[16:19], a[144:147], v[80:83]
    ds_read_b64_tr_b16 a[8:9], v113 offset:14160
    v_mfma_f32_16x16x32_bf16 v[84:87], a[16:19], a[148:151], v[84:87]
    s_waitcnt lgkmcnt(9)
    ds_read_b64_tr_b16 a[10:11], v113 offset:14336
    buffer_load_dwordx4 a[188:191], v5, s[20:23], s36 offen offset:3072 sc1
    v_mfma_f32_16x16x32_bf16 v[64:67], a[20:23], a[144:147], v[64:67]
    ds_read_b64_tr_b16 a[12:13], v113 offset:14208
    v_mfma_f32_16x16x32_bf16 v[68:71], a[20:23], a[148:151], v[68:71]
    s_waitcnt lgkmcnt(9)
    ds_read_b64_tr_b16 a[14:15], v113 offset:14384
    v_mfma_f32_16x16x32_bf16 v[72:75], a[24:27], a[144:147], v[72:75]
    ds_read_b64_tr_b16 a[16:17], v112 offset:16896
    v_mfma_f32_16x16x32_bf16 v[76:79], a[24:27], a[148:151], v[76:79]
    s_waitcnt lgkmcnt(9)
    ds_read_b64_tr_b16 a[18:19], v112 offset:17072
    s_add_u32 s36, s36, 4096
    s_cmp_ge_u32 s36, s33
    s_cselect_b32 s37, 36864, 0
    s_sub_u32 s36, s36, s37
    buffer_load_dwordx4 a[192:195], v5, s[20:23], s36 offen offset:0 sc1
    s_waitcnt vmcnt(9)
    v_mfma_f32_16x16x32_bf16 v[48:51], a[28:31], a[152:155], v[48:51]
    ds_read_b64_tr_b16 a[20:21], v112 offset:16928
    v_mfma_f32_16x16x32_bf16 v[52:55], a[28:31], a[156:159], v[52:55]
    s_waitcnt lgkmcnt(9)
    ds_read_b64_tr_b16 a[22:23], v112 offset:17104
    v_mfma_f32_16x16x32_bf16 v[56:59], a[0:3], a[152:155], v[56:59]
    ds_read_b64_tr_b16 a[24:25], v114 offset:16896
    v_mfma_f32_16x16x32_bf16 v[60:63], a[0:3], a[156:159], v[60:63]
    s_waitcnt lgkmcnt(9)
    ds_read_b64_tr_b16 a[26:27], v114 offset:17072
    buffer_load_dwordx4 a[196:199], v5, s[20:23], s36 offen offset:1024 sc1
    v_mfma_f32_16x16x32_bf16 v[80:83], a[4:7], a[152:155], v[80:83]
    ds_read_b64_tr_b16 a[28:29], v112 offset:16976
    v_mfma_f32_16x16x32_bf16 v[84:87], a[4:7], a[156:159], v[84:87]
    s_waitcnt lgkmcnt(9)
    ds_read_b64_tr_b16 a[30:31], v112 offset:17152
    v_mfma_f32_16x16x32_bf16 v[64:67], a[8:11], a[152:155], v[64:67]
    ds_read_b64_tr_b16 a[0:1], v112 offset:17024
    v_mfma_f32_16x16x32_bf16 v[68:71], a[8:11], a[156:159], v[68:71]
    s_waitcnt lgkmcnt(9)
    ds_read_b64_tr_b16 a[2:3], v112 offset:17200
    buffer_load_dwordx4 a[200:203], v5, s[20:23], s36 offen offset:2048 sc1
    v_mfma_f32_16x16x32_bf16 v[72:75], a[12:15], a[152:155], v[72:75]
    ds_read_b64_tr_b16 a[4:5], v113 offset:16896
    v_mfma_f32_16x16x32_bf16 v[76:79], a[12:15], a[156:159], v[76:79]
    s_waitcnt lgkmcnt(9)
    ds_read_b64_tr_b16 a[6:7], v113 offset:17072
    s_waitcnt vmcnt(9)
    v_mfma_f32_16x16x32_bf16 v[48:51], a[16:19], a[160:163], v[48:51]
    ds_read_b64_tr_b16 a[8:9], v113 offset:16928
    v_mfma_f32_16x16x32_bf16 v[52:55], a[16:19], a[164:167], v[52:55]
    s_waitcnt lgkmcnt(9)
    ds_read_b64_tr_b16 a[10:11], v113 offset:17104
    buffer_load_dwordx4 a[204:207], v5, s[20:23], s36 offen offset:3072 sc1
    v_mfma_f32_16x16x32_bf16 v[56:59], a[20:23], a[160:163], v[56:59]
    ds_read_b64_tr_b16 a[12:13], v115 offset:16896
    v_mfma_f32_16x16x32_bf16 v[60:63], a[20:23], a[164:167], v[60:63]
    s_waitcnt lgkmcnt(9)
    ds_read_b64_tr_b16 a[14:15], v115 offset:17072
    v_mfma_f32_16x16x32_bf16 v[80:83], a[24:27], a[160:163], v[80:83]
    ds_read_b64_tr_b16 a[16:17], v113 offset:16976
    v_mfma_f32_16x16x32_bf16 v[84:87], a[24:27], a[164:167], v[84:87]
    s_waitcnt lgkmcnt(9)
    ds_read_b64_tr_b16 a[18:19], v113 offset:17152
    v_mfma_f32_16x16x32_bf16 v[64:67], a[28:31], a[160:163], v[64:67]
    ds_read_b64_tr_b16 a[20:21], v113 offset:17024
    v_mfma_f32_16x16x32_bf16 v[68:71], a[28:31], a[164:167], v[68:71]
    s_waitcnt lgkmcnt(9)
    ds_read_b64_tr_b16 a[22:23], v113 offset:17200
    v_mfma_f32_16x16x32_bf16 v[72:75], a[0:3], a[160:163], v[72:75]
    ds_read_b64_tr_b16 a[24:25], v112 offset:19712
    v_mfma_f32_16x16x32_bf16 v[76:79], a[0:3], a[164:167], v[76:79]
    s_waitcnt lgkmcnt(9)
    ds_read_b64_tr_b16 a[26:27], v112 offset:19888
    s_mul_i32 s37, s30, 11520
    s_add_u32 m0, s37, 0
    s_nop 0
    buffer_load_dwordx4 v164, s[16:19], s51 offen lds
    s_waitcnt vmcnt(9)
    v_mfma_f32_16x16x32_bf16 v[48:51], a[4:7], a[168:171], v[48:51]
    ds_read_b64_tr_b16 a[28:29], v112 offset:19744
    v_mfma_f32_16x16x32_bf16 v[52:55], a[4:7], a[172:175], v[52:55]
    s_waitcnt lgkmcnt(9)
    ds_read_b64_tr_b16 a[30:31], v112 offset:19920
    v_mfma_f32_16x16x32_bf16 v[56:59], a[8:11], a[168:171], v[56:59]
    ds_read_b64_tr_b16 a[0:1], v114 offset:19712
    v_mfma_f32_16x16x32_bf16 v[60:63], a[8:11], a[172:175], v[60:63]
    s_waitcnt lgkmcnt(9)
    ds_read_b64_tr_b16 a[2:3], v114 offset:19888
    s_mov_b64 exec, 0xffff
    buffer_load_dwordx4 v165, s[16:19], s51 offen offset:1024 lds
    s_mov_b64 exec, -1
    v_mfma_f32_16x16x32_bf16 v[80:83], a[12:15], a[168:171], v[80:83]
    ds_read_b64_tr_b16 a[4:5], v112 offset:19792
    v_mfma_f32_16x16x32_bf16 v[84:87], a[12:15], a[172:175], v[84:87]
    s_waitcnt lgkmcnt(9)
    ds_read_b64_tr_b16 a[6:7], v112 offset:19968
    v_mfma_f32_16x16x32_bf16 v[64:67], a[16:19], a[168:171], v[64:67]
    ds_read_b64_tr_b16 a[8:9], v112 offset:19840
    v_mfma_f32_16x16x32_bf16 v[68:71], a[16:19], a[172:175], v[68:71]
    s_waitcnt lgkmcnt(9)
    ds_read_b64_tr_b16 a[10:11], v112 offset:20016
    s_mul_i32 s37, s30, 11520
    s_add_u32 m0, s37, 1280
    s_add_u32 s51, s51, 221184
    s_cmp_ge_u32 s51, s100
    s_cselect_b32 s37, 1990656, 0
    s_sub_u32 s51, s51, s37
    buffer_load_dwordx4 v164, s[16:19], s51 offen lds
    v_mfma_f32_16x16x32_bf16 v[72:75], a[20:23], a[168:171], v[72:75]
    ds_read_b64_tr_b16 a[12:13], v113 offset:19712
    v_mfma_f32_16x16x32_bf16 v[76:79], a[20:23], a[172:175], v[76:79]
    s_waitcnt lgkmcnt(9)
    ds_read_b64_tr_b16 a[14:15], v113 offset:19888
    s_waitcnt vmcnt(9)
    v_mfma_f32_16x16x32_bf16 v[48:51], a[24:27], a[176:179], v[48:51]
    ds_read_b64_tr_b16 a[16:17], v113 offset:19744
    v_mfma_f32_16x16x32_bf16 v[52:55], a[24:27], a[180:183], v[52:55]
    s_waitcnt lgkmcnt(9)
    ds_read_b64_tr_b16 a[18:19], v113 offset:19920
    s_mov_b64 exec, 0xffff
    buffer_load_dwordx4 v165, s[16:19], s51 offen offset:1024 lds
    s_mov_b64 exec, -1
    v_mfma_f32_16x16x32_bf16 v[56:59], a[28:31], a[176:179], v[56:59]
    ds_read_b64_tr_b16 a[20:21], v115 offset:19712
    v_mfma_f32_16x16x32_bf16 v[60:63], a[28:31], a[180:183], v[60:63]
    s_waitcnt lgkmcnt(9)
    ds_read_b64_tr_b16 a[22:23], v115 offset:19888
    v_mfma_f32_16x16x32_bf16 v[80:83], a[0:3], a[176:179], v[80:83]
    ds_read_b64_tr_b16 a[24:25], v113 offset:19792
    v_mfma_f32_16x16x32_bf16 v[84:87], a[0:3], a[180:183], v[84:87]
    s_waitcnt lgkmcnt(9)
    ds_read_b64_tr_b16 a[26:27], v113 offset:19968
    s_mul_i32 s37, s30, 11520
    s_add_u32 m0, s37, 2560
    s_add_u32 s51, s51, 221184
    s_cmp_ge_u32 s51, s100
    s_cselect_b32 s37, 1990656, 0
    s_sub_u32 s51, s51, s37
    buffer_load_dwordx4 v164, s[16:19], s51 offen lds
    v_mfma_f32_16x16x32_bf16 v[64:67], a[4:7], a[176:179], v[64:67]
    ds_read_b64_tr_b16 a[28:29], v113 offset:19840
    v_mfma_f32_16x16x32_bf16 v[68:71], a[4:7], a[180:183], v[68:71]
    s_waitcnt lgkmcnt(9)
    ds_read_b64_tr_b16 a[30:31], v113 offset:20016
    v_mfma_f32_16x16x32_bf16 v[72:75], a[8:11], a[176:179], v[72:75]
    s_barrier
    ds_read_b64_tr_b16 a[0:1], v112 offset:22528
    v_mfma_f32_16x16x32_bf16 v[76:79], a[8:11], a[180:183], v[76:79]
    s_waitcnt lgkmcnt(9)
    ds_read_b64_tr_b16 a[2:3], v112 offset:22704
    s_mov_b64 exec, 0xffff
    buffer_load_dwordx4 v165, s[16:19], s51 offen offset:1024 lds
    s_mov_b64 exec, -1
    s_waitcnt vmcnt(10)
    v_mfma_f32_16x16x32_bf16 v[48:51], a[12:15], a[184:187], v[48:51]
    ds_read_b64_tr_b16 a[4:5], v112 offset:22560
    v_mfma_f32_16x16x32_bf16 v[52:55], a[12:15], a[188:191], v[52:55]
    s_waitcnt lgkmcnt(9)
    ds_read_b64_tr_b16 a[6:7], v112 offset:22736
    v_mfma_f32_16x16x32_bf16 v[56:59], a[16:19], a[184:187], v[56:59]
    ds_read_b64_tr_b16 a[8:9], v114 offset:22528
    v_mfma_f32_16x16x32_bf16 v[60:63], a[16:19], a[188:191], v[60:63]
    s_waitcnt lgkmcnt(9)
    ds_read_b64_tr_b16 a[10:11], v114 offset:22704
    v_mfma_f32_16x16x32_bf16 v[80:83], a[20:23], a[184:187], v[80:83]
    ds_read_b64_tr_b16 a[12:13], v112 offset:22608
    v_mfma_f32_16x16x32_bf16 v[84:87], a[20:23], a[188:191], v[84:87]
    s_waitcnt lgkmcnt(9)
    ds_read_b64_tr_b16 a[14:15], v112 offset:22784
    v_mfma_f32_16x16x32_bf16 v[64:67], a[24:27], a[184:187], v[64:67]
    ds_read_b64_tr_b16 a[16:17], v112 offset:22656
    v_mfma_f32_16x16x32_bf16 v[68:71], a[24:27], a[188:191], v[68:71]
    s_waitcnt lgkmcnt(9)
    ds_read_b64_tr_b16 a[18:19], v112 offset:22832
    v_mfma_f32_16x16x32_bf16 v[72:75], a[28:31], a[184:187], v[72:75]
    ds_read_b64_tr_b16 a[20:21], v113 offset:22528
    v_mfma_f32_16x16x32_bf16 v[76:79], a[28:31], a[188:191], v[76:79]
    s_waitcnt lgkmcnt(9)
    ds_read_b64_tr_b16 a[22:23], v113 offset:22704
    s_waitcnt vmcnt(8)
    v_mfma_f32_16x16x32_bf16 v[48:51], a[0:3], a[192:195], v[48:51]
    ds_read_b64_tr_b16 a[24:25], v113 offset:22560
    v_mfma_f32_16x16x32_bf16 v[52:55], a[0:3], a[196:199], v[52:55]
    s_waitcnt lgkmcnt(9)
    ds_read_b64_tr_b16 a[26:27], v113 offset:22736
    v_mfma_f32_16x16x32_bf16 v[56:59], a[4:7], a[192:195], v[56:59]
    ds_read_b64_tr_b16 a[28:29], v115 offset:22528
    v_mfma_f32_16x16x32_bf16 v[60:63], a[4:7], a[196:199], v[60:63]
    s_waitcnt lgkmcnt(9)
    ds_read_b64_tr_b16 a[30:31], v115 offset:22704
    v_mfma_f32_16x16x32_bf16 v[80:83], a[8:11], a[192:195], v[80:83]
    ds_read_b64_tr_b16 a[0:1], v113 offset:22608
    v_mfma_f32_16x16x32_bf16 v[84:87], a[8:11], a[196:199], v[84:87]
    s_waitcnt lgkmcnt(9)
    ds_read_b64_tr_b16 a[2:3], v113 offset:22784
    ds_read_b64_tr_b16 a[232:233], v118 offset:0
    ds_read_b64_tr_b16 a[234:235], v118 offset:2048
    ds_read_b64_tr_b16 a[244:245], v118 offset:4096
    ds_read_b64_tr_b16 a[236:237], v118 offset:32
    ds_read_b64_tr_b16 a[238:239], v118 offset:2080
    ds_read_b64_tr_b16 a[248:249], v118 offset:4128
    ds_read_b64_tr_b16 a[240:241], v118 offset:64
    ds_read_b64_tr_b16 a[242:243], v118 offset:2112
    ds_read_b64_tr_b16 a[252:253], v118 offset:4160
    v_mfma_f32_16x16x32_bf16 v[64:67], a[12:15], a[192:195], v[64:67]
    ds_read_b64_tr_b16 a[4:5], v113 offset:22656
    v_mfma_f32_16x16x32_bf16 v[68:71], a[12:15], a[196:199], v[68:71]
    s_waitcnt lgkmcnt(15)
    ds_read_b64_tr_b16 a[6:7], v113 offset:22832
    v_mfma_f32_16x16x32_bf16 v[72:75], a[16:19], a[192:195], v[72:75]
    v_mfma_f32_16x16x32_bf16 v[76:79], a[16:19], a[196:199], v[76:79]
    s_waitcnt vmcnt(6)
    v_mfma_f32_16x16x32_bf16 v[48:51], a[20:23], a[200:203], v[48:51]
    v_mfma_f32_16x16x32_bf16 v[52:55], a[20:23], a[204:207], v[52:55]
    s_waitcnt lgkmcnt(15)
    v_mfma_f32_16x16x32_bf16 v[56:59], a[24:27], a[200:203], v[56:59]
    v_mfma_f32_16x16x32_bf16 v[60:63], a[24:27], a[204:207], v[60:63]
    s_waitcnt lgkmcnt(13)
    v_mfma_f32_16x16x32_bf16 v[80:83], a[28:31], a[200:203], v[80:83]
    v_mfma_f32_16x16x32_bf16 v[84:87], a[28:31], a[204:207], v[84:87]
    s_waitcnt lgkmcnt(11)
    v_mfma_f32_16x16x32_bf16 v[64:67], a[0:3], a[200:203], v[64:67]
    v_mfma_f32_16x16x32_bf16 v[68:71], a[0:3], a[204:207], v[68:71]
    s_waitcnt lgkmcnt(0)
    s_mov_b32 s50, 0x3f803f80
    v_dot2_f32_bf16 v230, v220, s50, 0
    v_dot2_f32_bf16 v231, v221, s50, 0
    v_dot2_f32_bf16 v230, v222, s50, v230
    v_dot2_f32_bf16 v231, v223, s50, v231
    v_dot2_f32_bf16 v230, v224, s50, v230
    v_dot2_f32_bf16 v231, v225, s50, v231
    v_dot2_f32_bf16 v230, v226, s50, v230
    v_dot2_f32_bf16 v231, v227, s50, v231
    s_nop 2
    v_add_f32 v230, v230, v231
    v_mov_b32 v231, v230
    s_nop 1
    v_permlane32_swap_b32 v230, v231
    v_add_f32 v230, v230, v231
    v_mov_b32 v231, v230
    s_nop 1
    v_permlane16_swap_b32 v230, v231
    v_add_f32 v230, v230, v231
    s_nop 1
    v_add_f32_dpp v230, v230, v230 row_ror:8 row_mask:0xf bank_mask:0xf
    s_nop 1
    v_add_f32_dpp v230, v230, v230 row_ror:4 row_mask:0xf bank_mask:0xf
    s_nop 1
    v_add_f32_dpp v230, v230, v230 row_ror:2 row_mask:0xf bank_mask:0xf
    s_nop 1
    v_add_f32_dpp v230, v230, v230 row_ror:1 row_mask:0xf bank_mask:0xf
    v_mul_f32 v230, 0x3ae38e39, v230
    v_lshlrev_b32 v229, 2, v15
    s_lshl_b32 s55, s32, 4
    s_add_u32 s55, s55, s31
    s_lshl_b32 s55, s55, 5
    s_add_u32 s55, s55, 46927872
    s_cmp_eq_u32 s30, 0
    s_cselect_b32 s3, 0, 2147483392
    s_add_u32 s55, s55, s3
    s_mov_b64 exec, 1
    buffer_store_dword v230, v229, s[20:23], s54 offen sc1
    s_mov_b64 exec, 0xff
    buffer_store_dword v228, v229, s[20:23], s55 offen sc1
    s_mov_b64 exec, -1
    s_mov_b32 s54, 0xfffff
    s_mov_b32 s55, 0xfffff
    v_mfma_f32_16x16x32_bf16 v[72:75], a[4:7], a[200:203], v[72:75]
    v_mfma_f32_16x16x32_bf16 v[76:79], a[4:7], a[204:207], v[76:79]
    v_mov_b32 v7, v168
    v_mov_b32 v12, v169
    v_add_u32 v122, s34, v122
    v_add_u32 v123, s34, v123
    v_add_u32 v124, s34, v124
    v_min_u32 v124, 157696, v124
    s_lshr_b32 s92, s30, 1
    s_and_b32 s93, s30, 1
    s_mul_i32 s96, s92, 4608
    s_mul_i32 s97, s93, 48
    s_add_u32 s97, s97, s96
    v_add_u32 v125, s97, v125
    v_add_u32 v126, s97, v126
    v_add_u32 v127, s96, v127
    v_add_u32 v128, s96, v128
    s_mul_i32 s96, s92, 1920
    s_mul_i32 s97, s93, 24
    s_add_u32 s97, s97, s96
    v_add_u32 v135, s97, v135
    v_add_u32 v136, s97, v136
    v_min_u32 v135, 157696, v135
    v_min_u32 v136, 157696, v136
    v_cvt_pk_bf16_f32 v32, v48, v49
    v_cvt_pk_bf16_f32 v33, v50, v51
    v_cvt_pk_bf16_f32 v34, v56, v57
    v_cvt_pk_bf16_f32 v35, v58, v59
    v_cvt_pk_bf16_f32 v40, v80, v81
    v_cvt_pk_bf16_f32 v41, v82, v83
    v_cvt_pk_bf16_f32 v36, v52, v53
    v_cvt_pk_bf16_f32 v37, v54, v55
    v_cvt_pk_bf16_f32 v38, v60, v61
    v_cvt_pk_bf16_f32 v39, v62, v63
    v_cvt_pk_bf16_f32 v44, v84, v85
    v_cvt_pk_bf16_f32 v45, v86, v87
    s_waitcnt lgkmcnt(0)
    v_mfma_f32_16x16x32_bf16 v[88:91], a[232:235], v[32:35], 0
    v_mfma_f32_16x16x32_bf16 v[92:95], a[236:239], v[32:35], 0
    v_mfma_f32_16x16x32_bf16 v[96:99], a[240:243], v[32:35], 0
    v_mfma_f32_16x16x32_bf16 v[100:103], a[232:235], v[36:39], 0
    v_mfma_f32_16x16x32_bf16 v[104:107], a[236:239], v[36:39], 0
    v_mfma_f32_16x16x32_bf16 v[108:111], a[240:243], v[36:39], 0
    v_mfma_f32_16x16x32_bf16 v[88:91], a[244:247], v[40:43], v[88:91]
    v_mfma_f32_16x16x32_bf16 v[92:95], a[248:251], v[40:43], v[92:95]
    v_mfma_f32_16x16x32_bf16 v[96:99], a[252:255], v[40:43], v[96:99]
    v_mfma_f32_16x16x32_bf16 v[100:103], a[244:247], v[44:47], v[100:103]
    v_mfma_f32_16x16x32_bf16 v[104:107], a[248:251], v[44:47], v[104:107]
    v_mfma_f32_16x16x32_bf16 v[108:111], a[252:255], v[44:47], v[108:111]
    s_mul_i32 s37, s30, 11520
    s_add_u32 m0, s37, 3840
    s_add_u32 s51, s51, 221184
    s_cmp_ge_u32 s51, s100
    s_cselect_b32 s37, 1990656, 0
    s_sub_u32 s51, s51, s37
    buffer_load_dwordx4 v164, s[16:19], s51 offen lds
    s_mov_b64 exec, 0xffff
    buffer_load_dwordx4 v165, s[16:19], s51 offen offset:1024 lds
    s_mov_b64 exec, -1
    s_mul_i32 s37, s30, 11520
    s_add_u32 m0, s37, 5120
    s_add_u32 s51, s51, 221184
    s_cmp_ge_u32 s51, s100
    s_cselect_b32 s37, 1990656, 0
    s_sub_u32 s51, s51, s37
    buffer_load_dwordx4 v164, s[16:19], s51 offen lds
    s_mov_b64 exec, 0xffff
    buffer_load_dwordx4 v165, s[16:19], s51 offen offset:1024 lds
    s_mov_b64 exec, -1
    v_cvt_pk_bf16_f32 v200, v64, v65
    v_cvt_pk_bf16_f32 v201, v66, v67
    v_cvt_pk_bf16_f32 v202, v72, v73
    v_cvt_pk_bf16_f32 v203, v74, v75
    v_mov_b32 v208, v41
    v_cvt_pk_bf16_f32 v204, v68, v69
    v_cvt_pk_bf16_f32 v205, v70, v71
    v_cvt_pk_bf16_f32 v206, v76, v77
    v_cvt_pk_bf16_f32 v207, v78, v79
    v_mov_b32 v210, v45
    s_barrier
    ds_write_b64 v123, v[200:201] offset:0
    ds_write_b64 v123, v[202:203] offset:4608
    ds_write_b64 v124, v[208:209] offset:0
    ds_write_b64 v123, v[204:205] offset:2304
    ds_write_b64 v123, v[206:207] offset:6912
    ds_write_b64 v124, v[210:211] offset:2304
    s_mul_i32 s37, s30, 11520
    s_add_u32 m0, s37, 6400
    s_add_u32 s51, s51, 221184
    s_cmp_ge_u32 s51, s100
    s_cselect_b32 s37, 1990656, 0
    s_sub_u32 s51, s51, s37
    buffer_load_dwordx4 v164, s[16:19], s51 offen lds
    s_mov_b64 exec, 0xffff
    buffer_load_dwordx4 v165, s[16:19], s51 offen offset:1024 lds
    s_mov_b64 exec, -1
    v_max3_f32 v16, v88, v89, v90
    v_min3_f32 v18, v88, v89, v90
    v_max3_f32 v17, v100, v101, v102
    v_min3_f32 v19, v100, v101, v102
    v_max3_f32 v16, v16, v91, v92
    v_min3_f32 v18, v18, v91, v92
    v_max3_f32 v17, v17, v103, v104
    v_min3_f32 v19, v19, v103, v104
    v_max3_f32 v16, v16, v93, v94
    v_min3_f32 v18, v18, v93, v94
    v_max3_f32 v17, v17, v105, v106
    v_min3_f32 v19, v19, v105, v106
    v_max3_f32 v16, v16, v95, v96
    v_min3_f32 v18, v18, v95, v96
    v_max3_f32 v17, v17, v107, v108
    v_min3_f32 v19, v19, v107, v108
    v_max_f32 v16, v16, v97
    v_min_f32 v18, v18, v97
    v_max_f32 v17, v17, v109
    v_min_f32 v19, v19, v109
    s_nop 0
    v_permlane16_swap_b32 v16, v17
    v_permlane16_swap_b32 v18, v19
    v_max_f32 v16, v16, v17
    v_min_f32 v18, v18, v19
    v_mul_f32 v20, s48, v16
    v_mul_f32 v24, s48, v18
    v_mov_b32 v22, v20
    v_mov_b32 v26, v24
    s_nop 0
    v_permlane16_swap_b32 v20, v22
    s_mul_i32 s37, s30, 11520
    s_add_u32 m0, s37, 7680
    s_add_u32 s51, s51, 221184
    s_cmp_ge_u32 s51, s100
    s_cselect_b32 s37, 1990656, 0
    s_sub_u32 s51, s51, s37
    buffer_load_dwordx4 v164, s[16:19], s51 offen lds
    s_mov_b64 exec, 0xffff
    buffer_load_dwordx4 v165, s[16:19], s51 offen offset:1024 lds
    s_mov_b64 exec, -1
    v_permlane16_swap_b32 v24, v26
    v_pk_fma_f32 v[140:141], v[88:89], s[48:49], v[24:25] op_sel_hi:[1,0,0] neg_lo:[1,0,0] neg_hi:[1,0,0]
    v_pk_fma_f32 v[88:89], v[88:89], s[48:49], v[20:21] op_sel_hi:[1,0,0] neg_lo:[0,0,1] neg_hi:[0,0,1]
    v_pk_fma_f32 v[142:143], v[90:91], s[48:49], v[24:25] op_sel_hi:[1,0,0] neg_lo:[1,0,0] neg_hi:[1,0,0]
    v_pk_fma_f32 v[90:91], v[90:91], s[48:49], v[20:21] op_sel_hi:[1,0,0] neg_lo:[0,0,1] neg_hi:[0,0,1]
    v_pk_fma_f32 v[144:145], v[92:93], s[48:49], v[24:25] op_sel_hi:[1,0,0] neg_lo:[1,0,0] neg_hi:[1,0,0]
    v_pk_fma_f32 v[92:93], v[92:93], s[48:49], v[20:21] op_sel_hi:[1,0,0] neg_lo:[0,0,1] neg_hi:[0,0,1]
    v_pk_fma_f32 v[146:147], v[94:95], s[48:49], v[24:25] op_sel_hi:[1,0,0] neg_lo:[1,0,0] neg_hi:[1,0,0]
    v_pk_fma_f32 v[94:95], v[94:95], s[48:49], v[20:21] op_sel_hi:[1,0,0] neg_lo:[0,0,1] neg_hi:[0,0,1]
    v_pk_fma_f32 v[148:149], v[96:97], s[48:49], v[24:25] op_sel_hi:[1,0,0] neg_lo:[1,0,0] neg_hi:[1,0,0]
    v_pk_fma_f32 v[96:97], v[96:97], s[48:49], v[20:21] op_sel_hi:[1,0,0] neg_lo:[0,0,1] neg_hi:[0,0,1]
    v_pk_fma_f32 v[152:153], v[100:101], s[48:49], v[26:27] op_sel_hi:[1,0,0] neg_lo:[1,0,0] neg_hi:[1,0,0]
    v_pk_fma_f32 v[100:101], v[100:101], s[48:49], v[22:23] op_sel_hi:[1,0,0] neg_lo:[0,0,1] neg_hi:[0,0,1]
    v_pk_fma_f32 v[154:155], v[102:103], s[48:49], v[26:27] op_sel_hi:[1,0,0] neg_lo:[1,0,0] neg_hi:[1,0,0]
    v_pk_fma_f32 v[102:103], v[102:103], s[48:49], v[22:23] op_sel_hi:[1,0,0] neg_lo:[0,0,1] neg_hi:[0,0,1]
    v_pk_fma_f32 v[156:157], v[104:105], s[48:49], v[26:27] op_sel_hi:[1,0,0] neg_lo:[1,0,0] neg_hi:[1,0,0]
    v_pk_fma_f32 v[104:105], v[104:105], s[48:49], v[22:23] op_sel_hi:[1,0,0] neg_lo:[0,0,1] neg_hi:[0,0,1]
    v_pk_fma_f32 v[158:159], v[106:107], s[48:49], v[26:27] op_sel_hi:[1,0,0] neg_lo:[1,0,0] neg_hi:[1,0,0]
    v_pk_fma_f32 v[106:107], v[106:107], s[48:49], v[22:23] op_sel_hi:[1,0,0] neg_lo:[0,0,1] neg_hi:[0,0,1]
    v_pk_fma_f32 v[160:161], v[108:109], s[48:49], v[26:27] op_sel_hi:[1,0,0] neg_lo:[1,0,0] neg_hi:[1,0,0]
    v_pk_fma_f32 v[108:109], v[108:109], s[48:49], v[22:23] op_sel_hi:[1,0,0] neg_lo:[0,0,1] neg_hi:[0,0,1]
    v_exp_f32 v88, v88
    v_exp_f32 v140, v140
    v_exp_f32 v89, v89
    v_exp_f32 v141, v141
    v_exp_f32 v90, v90
    v_exp_f32 v142, v142
    v_exp_f32 v91, v91
    v_exp_f32 v143, v143
    s_mul_i32 s37, s30, 11520
    s_add_u32 m0, s37, 8960
    s_add_u32 s51, s51, 221184
    s_cmp_ge_u32 s51, s100
    s_cselect_b32 s37, 1990656, 0
    s_sub_u32 s51, s51, s37
    buffer_load_dwordx4 v164, s[16:19], s51 offen lds
    s_mov_b64 exec, 0xffff
    buffer_load_dwordx4 v165, s[16:19], s51 offen offset:1024 lds
    s_mov_b64 exec, -1
    v_exp_f32 v92, v92
    v_exp_f32 v144, v144
    v_exp_f32 v93, v93
    v_exp_f32 v145, v145
    v_exp_f32 v94, v94
    v_exp_f32 v146, v146
    v_exp_f32 v95, v95
    v_exp_f32 v147, v147
    v_exp_f32 v96, v96
    v_exp_f32 v148, v148
    v_exp_f32 v97, v97
    v_exp_f32 v149, v149
    v_exp_f32 v100, v100
    v_exp_f32 v152, v152
    v_exp_f32 v101, v101
    v_exp_f32 v153, v153
    v_exp_f32 v102, v102
    v_exp_f32 v154, v154
    v_exp_f32 v103, v103
    v_exp_f32 v155, v155
    v_exp_f32 v104, v104
    v_exp_f32 v156, v156
    v_exp_f32 v105, v105
    v_exp_f32 v157, v157
    v_exp_f32 v106, v106
    v_exp_f32 v158, v158
    v_exp_f32 v107, v107
    v_exp_f32 v159, v159
    v_exp_f32 v108, v108
    s_mul_i32 s37, s30, 11520
    s_add_u32 m0, s37, 10240
    s_add_u32 s51, s51, 221184
    s_cmp_ge_u32 s51, s100
    s_cselect_b32 s37, 1990656, 0
    s_sub_u32 s51, s51, s37
    buffer_load_dwordx4 v164, s[16:19], s51 offen lds
    s_mov_b64 exec, 0xffff
    buffer_load_dwordx4 v165, s[16:19], s51 offen offset:1024 lds
    s_mov_b64 exec, -1
    v_exp_f32 v160, v160
    v_exp_f32 v109, v109
    v_exp_f32 v161, v161
    v_pk_mul_f32 v[96:97], v[96:97], v[138:139] op_sel_hi:[1,0]
    v_pk_mul_f32 v[108:109], v[108:109], v[138:139] op_sel_hi:[1,0]
    v_pk_mul_f32 v[148:149], v[148:149], v[138:139] op_sel_hi:[1,0]
    v_pk_mul_f32 v[160:161], v[160:161], v[138:139] op_sel_hi:[1,0]
    v_pk_add_f32 v[16:17], v[88:89], v[90:91]
    v_pk_add_f32 v[18:19], v[100:101], v[102:103]
    v_pk_add_f32 v[20:21], v[140:141], v[142:143]
    v_pk_add_f32 v[22:23], v[152:153], v[154:155]
    v_pk_add_f32 v[24:25], v[92:93], v[94:95]
    v_pk_add_f32 v[26:27], v[104:105], v[106:107]
    v_pk_add_f32 v[28:29], v[144:145], v[146:147]
    v_pk_add_f32 v[30:31], v[156:157], v[158:159]
    v_pk_add_f32 v[16:17], v[16:17], v[96:97]
    v_pk_add_f32 v[18:19], v[18:19], v[108:109]
    v_pk_add_f32 v[20:21], v[20:21], v[148:149]
    v_pk_add_f32 v[22:23], v[22:23], v[160:161]
    v_pk_add_f32 v[16:17], v[16:17], v[24:25]
    v_pk_add_f32 v[18:19], v[18:19], v[26:27]
    v_pk_add_f32 v[20:21], v[20:21], v[28:29]
    v_pk_add_f32 v[22:23], v[22:23], v[30:31]
    v_add_f32 v16, v16, v17
    v_add_f32 v18, v18, v19
    v_add_f32 v20, v20, v21
    v_add_f32 v22, v22, v23
    v_permlane16_swap_b32 v16, v18
    s_nop 0
    v_permlane16_swap_b32 v20, v22
    v_add_f32 v16, v16, v18
    v_add_f32 v20, v20, v22
    v_rcp_f32 v16, v16
    v_rcp_f32 v20, v20
    s_nop 0
    v_mov_b32 v18, v16
    v_mov_b32 v22, v20
    s_nop 0
    v_permlane16_swap_b32 v16, v18
    v_permlane16_swap_b32 v20, v22
    v_pk_mul_f32 v[88:89], v[88:89], v[16:17] op_sel_hi:[1,0]
    v_pk_mul_f32 v[90:91], v[90:91], v[16:17] op_sel_hi:[1,0]
    v_pk_mul_f32 v[92:93], v[92:93], v[16:17] op_sel_hi:[1,0]
    v_pk_mul_f32 v[94:95], v[94:95], v[16:17] op_sel_hi:[1,0]
    v_pk_mul_f32 v[96:97], v[96:97], v[16:17] op_sel_hi:[1,0]
    v_pk_mul_f32 v[100:101], v[100:101], v[18:19] op_sel_hi:[1,0]
    v_pk_mul_f32 v[102:103], v[102:103], v[18:19] op_sel_hi:[1,0]
    v_pk_mul_f32 v[104:105], v[104:105], v[18:19] op_sel_hi:[1,0]
    v_pk_mul_f32 v[106:107], v[106:107], v[18:19] op_sel_hi:[1,0]
    v_pk_mul_f32 v[108:109], v[108:109], v[18:19] op_sel_hi:[1,0]
    v_pk_mul_f32 v[140:141], v[140:141], v[20:21] op_sel_hi:[1,0]
    v_pk_mul_f32 v[142:143], v[142:143], v[20:21] op_sel_hi:[1,0]
    v_pk_mul_f32 v[144:145], v[144:145], v[20:21] op_sel_hi:[1,0]
    v_pk_mul_f32 v[146:147], v[146:147], v[20:21] op_sel_hi:[1,0]
    v_pk_mul_f32 v[148:149], v[148:149], v[20:21] op_sel_hi:[1,0]
    v_pk_mul_f32 v[152:153], v[152:153], v[22:23] op_sel_hi:[1,0]
    v_pk_mul_f32 v[154:155], v[154:155], v[22:23] op_sel_hi:[1,0]
    v_pk_mul_f32 v[156:157], v[156:157], v[22:23] op_sel_hi:[1,0]
    v_pk_mul_f32 v[158:159], v[158:159], v[22:23] op_sel_hi:[1,0]
    v_pk_mul_f32 v[160:161], v[160:161], v[22:23] op_sel_hi:[1,0]
    v_mul_u32_u24 v16, 7282, v14
    v_lshrrev_b32 v16, 16, v16
    v_mul_u32_u24 v17, 9, v16
    v_sub_u32 v17, v14, v17
    v_mul_u32_u24 v16, 1152, v16
    v_lshl_add_u32 v16, v17, 7, v16
    v_mov_b32 v17, 2147483392
    v_cmp_gt_u32 vcc, 162, v14
    s_mul_i32 s96, s28, 20736
    s_add_u32 s96, s96, 2048
    v_cndmask_b32 v16, v17, v16, vcc
    buffer_load_dword a208, v16, s[44:47], s96 offen
    v_mul_u32_u24 v16, 7282, v15
    v_lshrrev_b32 v16, 16, v16
    v_mul_u32_u24 v17, 9, v16
    v_sub_u32 v17, v15, v17
    v_mul_u32_u24 v16, 9216, v16
    v_lshl_add_u32 v16, v17, 7, v16
    v_mov_b32 v17, 2147483392
    v_cmp_gt_u32 vcc, 9, v15
    s_cmp_lt_u32 s30, 2
    s_cselect_b32 s92, s4, s6
    s_cselect_b32 s93, s5, s7
    s_mov_b32 s94, 5308416
    s_mov_b32 s95, 0x20000
    s_lshl_b32 s96, s28, 1
    s_and_b32 s97, s30, 1
    s_add_u32 s96, s96, s97
    s_mul_i32 s96, s96, 9216
    s_mul_i32 s97, s29, 1152
    s_add_u32 s96, s96, s97
    v_cndmask_b32 v16, v17, v16, vcc
    buffer_load_dword a209, v16, s[92:95], s96 offen
    v_cvt_pk_bf16_f32 v176, v88, v89
    v_cvt_pk_bf16_f32 v177, v90, v91
    v_cvt_pk_bf16_f32 v178, v92, v93
    v_cvt_pk_bf16_f32 v179, v94, v95
    v_cvt_pk_bf16_f32 v180, v96, v97
    v_cvt_pk_bf16_f32 v182, v140, v141
    v_cvt_pk_bf16_f32 v183, v142, v143
    v_cvt_pk_bf16_f32 v184, v144, v145
    v_cvt_pk_bf16_f32 v185, v146, v147
    v_cvt_pk_bf16_f32 v186, v148, v149
    ds_write_b64 v122, v[176:177] offset:0
    ds_write_b64 v122, v[178:179] offset:8
    ds_write_b64 v122, v[180:181] offset:16
    ds_write_b64 v122, v[182:183] offset:48
    ds_write_b64 v122, v[184:185] offset:56
    ds_write_b64 v122, v[186:187] offset:64
    v_cvt_pk_bf16_f32 v188, v100, v101
    v_cvt_pk_bf16_f32 v189, v102, v103
    v_cvt_pk_bf16_f32 v190, v104, v105
    v_cvt_pk_bf16_f32 v191, v106, v107
    v_cvt_pk_bf16_f32 v192, v108, v109
    v_cvt_pk_bf16_f32 v194, v152, v153
    v_cvt_pk_bf16_f32 v195, v154, v155
    v_cvt_pk_bf16_f32 v196, v156, v157
    v_cvt_pk_bf16_f32 v197, v158, v159
    v_cvt_pk_bf16_f32 v198, v160, v161
    ds_write_b64 v122, v[188:189] offset:2304
    ds_write_b64 v122, v[190:191] offset:2312
    ds_write_b64 v122, v[192:193] offset:2320
    ds_write_b64 v122, v[194:195] offset:2352
    ds_write_b64 v122, v[196:197] offset:2360
    ds_write_b64 v122, v[198:199] offset:2368
    s_mul_i32 s37, s32, 4096
    s_add_u32 s37, s37, s52
    s_lshl_b32 s53, s31, 8
    s_add_u32 s53, s53, 46137344
    s_waitcnt lgkmcnt(0)
    s_barrier
    ds_read_b64_tr_b16 a[0:1], v125 offset:0
    ds_read_b64_tr_b16 a[2:3], v125 offset:576
    ds_read_b64_tr_b16 a[4:5], v127 offset:0
    ds_read_b64_tr_b16 a[6:7], v127 offset:576
    ds_read_b64_tr_b16 a[8:9], v125 offset:2304
    ds_read_b64_tr_b16 a[10:11], v125 offset:2880
    ds_read_b64_tr_b16 a[12:13], v127 offset:2304
    ds_read_b64_tr_b16 a[14:15], v127 offset:2880
    ds_read_b64_tr_b16 a[16:17], v125 offset:25344
    ds_read_b64_tr_b16 a[18:19], v125 offset:25920
    ds_read_b64_tr_b16 a[20:21], v127 offset:25344
    ds_read_b64_tr_b16 a[22:23], v127 offset:25920
    s_waitcnt lgkmcnt(8)
    v_mfma_f32_32x32x16_bf16 v[64:79], a[0:3], a[4:7], 0
    ds_read_b64_tr_b16 a[24:25], v125 offset:27648
    ds_read_b64_tr_b16 a[26:27], v125 offset:28224
    ds_read_b64_tr_b16 a[28:29], v127 offset:27648
    ds_read_b64_tr_b16 a[30:31], v127 offset:28224
    s_waitcnt lgkmcnt(8)
    v_mfma_f32_32x32x16_bf16 v[64:79], a[8:11], a[12:15], v[64:79]
    ds_read_b64_tr_b16 a[32:33], v126 offset:0
    ds_read_b64_tr_b16 a[34:35], v126 offset:576
    ds_read_b64_tr_b16 a[36:37], v128 offset:0
    ds_read_b64_tr_b16 a[38:39], v128 offset:576
    s_waitcnt lgkmcnt(8)
    v_mfma_f32_32x32x16_bf16 v[64:79], a[16:19], a[20:23], v[64:79]
    ds_read_b64_tr_b16 a[40:41], v126 offset:2304
    ds_read_b64_tr_b16 a[42:43], v126 offset:2880
    ds_read_b64_tr_b16 a[44:45], v128 offset:2304
    ds_read_b64_tr_b16 a[46:47], v128 offset:2880
    s_waitcnt lgkmcnt(8)
    v_mfma_f32_32x32x16_bf16 v[64:79], a[24:27], a[28:31], v[64:79]
    ds_read_b64_tr_b16 a[48:49], v126 offset:25344
    ds_read_b64_tr_b16 a[50:51], v126 offset:25920
    ds_read_b64_tr_b16 a[52:53], v128 offset:25344
    ds_read_b64_tr_b16 a[54:55], v128 offset:25920
    s_waitcnt lgkmcnt(8)
    v_mfma_f32_32x32x16_bf16 v[64:79], a[32:35], a[36:39], v[64:79]
    ds_read_b64_tr_b16 a[56:57], v126 offset:27648
    ds_read_b64_tr_b16 a[58:59], v126 offset:28224
    ds_read_b64_tr_b16 a[60:61], v128 offset:27648
    ds_read_b64_tr_b16 a[62:63], v128 offset:28224
    s_waitcnt lgkmcnt(8)
    v_mfma_f32_32x32x16_bf16 v[64:79], a[40:43], a[44:47], v[64:79]
    s_waitcnt lgkmcnt(4)
    v_mfma_f32_32x32x16_bf16 v[64:79], a[48:51], a[52:55], v[64:79]
    s_waitcnt lgkmcnt(0)
    v_mfma_f32_32x32x16_bf16 v[64:79], a[56:59], a[60:63], v[64:79]
    s_nop 11
    v_cvt_pk_bf16_f32 v16, v64, v65
    v_cvt_pk_bf16_f32 v17, v66, v67
    v_cvt_pk_bf16_f32 v18, v68, v69
    v_cvt_pk_bf16_f32 v19, v70, v71
    v_cvt_pk_bf16_f32 v20, v72, v73
    v_cvt_pk_bf16_f32 v21, v74, v75
    s_mov_b64 exec, s[54:55]
    buffer_store_dwordx4 v[16:19], v129, s[20:23], s37 offen sc1
    s_mov_b32 exec_lo, -1
    s_mov_b32 exec_hi, 0
    buffer_store_dwordx2 v[20:21], v130, s[20:23], s37 offen sc1
    s_mov_b64 exec, -1
    s_waitcnt vmcnt(4)
    s_barrier
    s_cmp_ge_u32 s28, 24
    s_cselect_b32 s46, 0, s46
    ds_read_b64_tr_b16 a[0:1], v116 offset:0
    ds_read_b64_tr_b16 a[2:3], v116 offset:80
    ds_read_b64_tr_b16 a[4:5], v116 offset:32
    ds_read_b64_tr_b16 a[6:7], v116 offset:112
    ds_read_b64_tr_b16 a[8:9], v117 offset:0
    ds_read_b64_tr_b16 a[10:11], v117 offset:80
    ds_read_b64_tr_b16 a[12:13], v116 offset:23040
    ds_read_b64_tr_b16 a[14:15], v116 offset:23120
    ds_read_b64_tr_b16 a[16:17], v116 offset:23072
    ds_read_b64_tr_b16 a[18:19], v116 offset:23152
    ds_read_b64_tr_b16 a[20:21], v117 offset:23040
    ds_read_b64_tr_b16 a[22:23], v117 offset:23120
    s_waitcnt lgkmcnt(10)
    v_mfma_f32_16x16x32_bf16 v[48:51], a[0:3], a[64:67], 0
    ds_read_b64_tr_b16 a[24:25], v116 offset:1280
    v_mfma_f32_16x16x32_bf16 v[52:55], a[0:3], a[68:71], 0
    s_waitcnt lgkmcnt(9)
    ds_read_b64_tr_b16 a[26:27], v116 offset:1360
    s_mul_i32 s38, s26, 192
    s_mul_i32 s37, s30, 20736
    s_add_u32 s39, s38, s37
    s_mul_i32 s37, s30, 165888
    s_add_u32 s38, s38, s37
    s_add_u32 s38, s38, 18432
    s_mul_i32 s40, s30, 3072
    s_add_u32 s40, s40, 36864
    s_add_u32 m0, s40, 12288
    s_add_u32 s39, s39, 82944
    buffer_load_dwordx4 v7, s[44:47], s39 offen offset:0 lds
    v_mfma_f32_16x16x32_bf16 v[56:59], a[4:7], a[64:67], 0
    ds_read_b64_tr_b16 a[28:29], v116 offset:1312
    v_mfma_f32_16x16x32_bf16 v[60:63], a[4:7], a[68:71], 0
    s_waitcnt lgkmcnt(9)
    ds_read_b64_tr_b16 a[30:31], v116 offset:1392
    v_mfma_f32_16x16x32_bf16 v[80:83], a[8:11], a[64:67], 0
    ds_read_b64_tr_b16 a[0:1], v117 offset:1280
    v_mfma_f32_16x16x32_bf16 v[84:87], a[8:11], a[68:71], 0
    s_waitcnt lgkmcnt(9)
    ds_read_b64_tr_b16 a[2:3], v117 offset:1360
    buffer_load_dwordx4 v8, s[44:47], s39 offen offset:1024 lds
    v_mfma_f32_16x16x32_bf16 v[48:51], a[12:15], a[72:75], v[48:51]
    ds_read_b64_tr_b16 a[4:5], v116 offset:24320
    v_mfma_f32_16x16x32_bf16 v[52:55], a[12:15], a[76:79], v[52:55]
    s_waitcnt lgkmcnt(9)
    ds_read_b64_tr_b16 a[6:7], v116 offset:24400
    v_mfma_f32_16x16x32_bf16 v[56:59], a[16:19], a[72:75], v[56:59]
    ds_read_b64_tr_b16 a[8:9], v116 offset:24352
    v_mfma_f32_16x16x32_bf16 v[60:63], a[16:19], a[76:79], v[60:63]
    s_waitcnt lgkmcnt(9)
    ds_read_b64_tr_b16 a[10:11], v116 offset:24432
    buffer_load_dwordx4 v9, s[44:47], s39 offen offset:2048 lds
    v_mfma_f32_16x16x32_bf16 v[80:83], a[20:23], a[72:75], v[80:83]
    ds_read_b64_tr_b16 a[12:13], v117 offset:24320
    v_mfma_f32_16x16x32_bf16 v[84:87], a[20:23], a[76:79], v[84:87]
    s_waitcnt lgkmcnt(9)
    ds_read_b64_tr_b16 a[14:15], v117 offset:24400
    v_mfma_f32_16x16x32_bf16 v[48:51], a[24:27], a[80:83], v[48:51]
    ds_read_b64_tr_b16 a[16:17], v116 offset:2560
    v_mfma_f32_16x16x32_bf16 v[52:55], a[24:27], a[84:87], v[52:55]
    s_waitcnt lgkmcnt(9)
    ds_read_b64_tr_b16 a[18:19], v116 offset:2640
    s_add_u32 m0, s40, 24576
    s_add_u32 s39, s39, 82944
    buffer_load_dwordx4 v7, s[44:47], s39 offen offset:0 lds
    v_mfma_f32_16x16x32_bf16 v[56:59], a[28:31], a[80:83], v[56:59]
    ds_read_b64_tr_b16 a[20:21], v116 offset:2592
    v_mfma_f32_16x16x32_bf16 v[60:63], a[28:31], a[84:87], v[60:63]
    s_waitcnt lgkmcnt(9)
    ds_read_b64_tr_b16 a[22:23], v116 offset:2672
    v_mfma_f32_16x16x32_bf16 v[80:83], a[0:3], a[80:83], v[80:83]
    ds_read_b64_tr_b16 a[24:25], v117 offset:2560
    v_mfma_f32_16x16x32_bf16 v[84:87], a[0:3], a[84:87], v[84:87]
    s_waitcnt lgkmcnt(9)
    ds_read_b64_tr_b16 a[26:27], v117 offset:2640
    buffer_load_dwordx4 v8, s[44:47], s39 offen offset:1024 lds
    v_mfma_f32_16x16x32_bf16 v[48:51], a[4:7], a[88:91], v[48:51]
    ds_read_b64_tr_b16 a[28:29], v116 offset:25600
    v_mfma_f32_16x16x32_bf16 v[52:55], a[4:7], a[92:95], v[52:55]
    s_waitcnt lgkmcnt(9)
    ds_read_b64_tr_b16 a[30:31], v116 offset:25680
    v_mfma_f32_16x16x32_bf16 v[56:59], a[8:11], a[88:91], v[56:59]
    ds_read_b64_tr_b16 a[0:1], v116 offset:25632
    v_mfma_f32_16x16x32_bf16 v[60:63], a[8:11], a[92:95], v[60:63]
    s_waitcnt lgkmcnt(9)
    ds_read_b64_tr_b16 a[2:3], v116 offset:25712
    buffer_load_dwordx4 v9, s[44:47], s39 offen offset:2048 lds
    v_mfma_f32_16x16x32_bf16 v[80:83], a[12:15], a[88:91], v[80:83]
    ds_read_b64_tr_b16 a[4:5], v117 offset:25600
    v_mfma_f32_16x16x32_bf16 v[84:87], a[12:15], a[92:95], v[84:87]
    s_waitcnt lgkmcnt(9)
    ds_read_b64_tr_b16 a[6:7], v117 offset:25680
    v_mfma_f32_16x16x32_bf16 v[48:51], a[16:19], a[96:99], v[48:51]
    ds_read_b64_tr_b16 a[8:9], v116 offset:3840
    v_mfma_f32_16x16x32_bf16 v[52:55], a[16:19], a[100:103], v[52:55]
    s_waitcnt lgkmcnt(9)
    ds_read_b64_tr_b16 a[10:11], v116 offset:3920
    s_add_u32 m0, s40, 36864
    s_add_u32 s39, s39, 82944
    buffer_load_dwordx4 v7, s[44:47], s39 offen offset:0 lds
    v_mfma_f32_16x16x32_bf16 v[56:59], a[20:23], a[96:99], v[56:59]
    ds_read_b64_tr_b16 a[12:13], v116 offset:3872
    v_mfma_f32_16x16x32_bf16 v[60:63], a[20:23], a[100:103], v[60:63]
    s_waitcnt lgkmcnt(9)
    ds_read_b64_tr_b16 a[14:15], v116 offset:3952
    v_mfma_f32_16x16x32_bf16 v[80:83], a[24:27], a[96:99], v[80:83]
    ds_read_b64_tr_b16 a[16:17], v117 offset:3840
    v_mfma_f32_16x16x32_bf16 v[84:87], a[24:27], a[100:103], v[84:87]
    s_waitcnt lgkmcnt(9)
    ds_read_b64_tr_b16 a[18:19], v117 offset:3920
    buffer_load_dwordx4 v8, s[44:47], s39 offen offset:1024 lds
    v_mfma_f32_16x16x32_bf16 v[48:51], a[28:31], a[104:107], v[48:51]
    ds_read_b64_tr_b16 a[20:21], v116 offset:26880
    v_mfma_f32_16x16x32_bf16 v[52:55], a[28:31], a[108:111], v[52:55]
    s_waitcnt lgkmcnt(9)
    ds_read_b64_tr_b16 a[22:23], v116 offset:26960
    v_mfma_f32_16x16x32_bf16 v[56:59], a[0:3], a[104:107], v[56:59]
    ds_read_b64_tr_b16 a[24:25], v116 offset:26912
    v_mfma_f32_16x16x32_bf16 v[60:63], a[0:3], a[108:111], v[60:63]
    s_waitcnt lgkmcnt(9)
    ds_read_b64_tr_b16 a[26:27], v116 offset:26992
    s_waitcnt vmcnt(8)
    s_barrier
    s_cmp_lg_u32 s30, 0
    s_cbranch_scc1 Ksig_11
    s_mov_b32 s98, 1
    s_atomic_add s98, s[20:21], s53
Ksig_11:
    buffer_load_dwordx4 v9, s[44:47], s39 offen offset:2048 lds
    v_mfma_f32_16x16x32_bf16 v[80:83], a[4:7], a[104:107], v[80:83]
    ds_read_b64_tr_b16 a[28:29], v117 offset:26880
    v_mfma_f32_16x16x32_bf16 v[84:87], a[4:7], a[108:111], v[84:87]
    s_waitcnt lgkmcnt(9)
    ds_read_b64_tr_b16 a[30:31], v117 offset:26960
    v_mfma_f32_16x16x32_bf16 v[48:51], a[8:11], a[112:115], v[48:51]
    ds_read_b64_tr_b16 a[0:1], v116 offset:5120
    v_mfma_f32_16x16x32_bf16 v[52:55], a[8:11], a[116:119], v[52:55]
    s_waitcnt lgkmcnt(9)
    ds_read_b64_tr_b16 a[2:3], v116 offset:5200
    s_add_u32 m0, s40, 49152
    s_add_u32 s39, s39, 82944
    buffer_load_dwordx4 v7, s[44:47], s39 offen offset:0 lds
    v_mfma_f32_16x16x32_bf16 v[56:59], a[12:15], a[112:115], v[56:59]
    ds_read_b64_tr_b16 a[4:5], v116 offset:5152
    v_mfma_f32_16x16x32_bf16 v[60:63], a[12:15], a[116:119], v[60:63]
    s_waitcnt lgkmcnt(9)
    ds_read_b64_tr_b16 a[6:7], v116 offset:5232
    v_mfma_f32_16x16x32_bf16 v[80:83], a[16:19], a[112:115], v[80:83]
    ds_read_b64_tr_b16 a[8:9], v117 offset:5120
    v_mfma_f32_16x16x32_bf16 v[84:87], a[16:19], a[116:119], v[84:87]
    s_waitcnt lgkmcnt(9)
    ds_read_b64_tr_b16 a[10:11], v117 offset:5200
    buffer_load_dwordx4 v8, s[44:47], s39 offen offset:1024 lds
    v_mfma_f32_16x16x32_bf16 v[48:51], a[20:23], a[120:123], v[48:51]
    ds_read_b64_tr_b16 a[12:13], v116 offset:28160
    v_mfma_f32_16x16x32_bf16 v[52:55], a[20:23], a[124:127], v[52:55]
    s_waitcnt lgkmcnt(9)
    ds_read_b64_tr_b16 a[14:15], v116 offset:28240
    v_mfma_f32_16x16x32_bf16 v[56:59], a[24:27], a[120:123], v[56:59]
    ds_read_b64_tr_b16 a[16:17], v116 offset:28192
    v_mfma_f32_16x16x32_bf16 v[60:63], a[24:27], a[124:127], v[60:63]
    s_waitcnt lgkmcnt(9)
    ds_read_b64_tr_b16 a[18:19], v116 offset:28272
    buffer_load_dwordx4 v9, s[44:47], s39 offen offset:2048 lds
    v_mfma_f32_16x16x32_bf16 v[80:83], a[28:31], a[120:123], v[80:83]
    ds_read_b64_tr_b16 a[20:21], v117 offset:28160
    v_mfma_f32_16x16x32_bf16 v[84:87], a[28:31], a[124:127], v[84:87]
    s_waitcnt lgkmcnt(9)
    ds_read_b64_tr_b16 a[22:23], v117 offset:28240
    v_mfma_f32_16x16x32_bf16 v[48:51], a[0:3], a[128:131], v[48:51]
    ds_read_b64_tr_b16 a[24:25], v116 offset:6400
    v_mfma_f32_16x16x32_bf16 v[52:55], a[0:3], a[132:135], v[52:55]
    s_waitcnt lgkmcnt(9)
    ds_read_b64_tr_b16 a[26:27], v116 offset:6480
    s_add_u32 m0, s40, 61440
    s_add_u32 s39, s39, 82944
    buffer_load_dwordx4 v7, s[44:47], s39 offen offset:0 lds
    v_mfma_f32_16x16x32_bf16 v[56:59], a[4:7], a[128:131], v[56:59]
    ds_read_b64_tr_b16 a[28:29], v116 offset:6432
    v_mfma_f32_16x16x32_bf16 v[60:63], a[4:7], a[132:135], v[60:63]
    s_waitcnt lgkmcnt(9)
    ds_read_b64_tr_b16 a[30:31], v116 offset:6512
    v_mfma_f32_16x16x32_bf16 v[80:83], a[8:11], a[128:131], v[80:83]
    ds_read_b64_tr_b16 a[0:1], v117 offset:6400
    v_mfma_f32_16x16x32_bf16 v[84:87], a[8:11], a[132:135], v[84:87]
    s_waitcnt lgkmcnt(9)
    ds_read_b64_tr_b16 a[2:3], v117 offset:6480
    buffer_load_dwordx4 v8, s[44:47], s39 offen offset:1024 lds
    v_mfma_f32_16x16x32_bf16 v[48:51], a[12:15], a[136:139], v[48:51]
    ds_read_b64_tr_b16 a[4:5], v116 offset:29440
    v_mfma_f32_16x16x32_bf16 v[52:55], a[12:15], a[140:143], v[52:55]
    s_waitcnt lgkmcnt(9)
    ds_read_b64_tr_b16 a[6:7], v116 offset:29520
    v_mfma_f32_16x16x32_bf16 v[56:59], a[16:19], a[136:139], v[56:59]
    ds_read_b64_tr_b16 a[8:9], v116 offset:29472
    v_mfma_f32_16x16x32_bf16 v[60:63], a[16:19], a[140:143], v[60:63]
    s_waitcnt lgkmcnt(9)
    ds_read_b64_tr_b16 a[10:11], v116 offset:29552
    buffer_load_dwordx4 v9, s[44:47], s39 offen offset:2048 lds
    v_mfma_f32_16x16x32_bf16 v[80:83], a[20:23], a[136:139], v[80:83]
    ds_read_b64_tr_b16 a[12:13], v117 offset:29440
    v_mfma_f32_16x16x32_bf16 v[84:87], a[20:23], a[140:143], v[84:87]
    s_waitcnt lgkmcnt(9)
    ds_read_b64_tr_b16 a[14:15], v117 offset:29520
    v_mfma_f32_16x16x32_bf16 v[48:51], a[24:27], a[144:147], v[48:51]
    ds_read_b64_tr_b16 a[16:17], v116 offset:7680
    v_mfma_f32_16x16x32_bf16 v[52:55], a[24:27], a[148:151], v[52:55]
    s_waitcnt lgkmcnt(9)
    ds_read_b64_tr_b16 a[18:19], v116 offset:7760
    s_add_u32 m0, s40, 73728
    s_add_u32 s39, s39, 82944
    buffer_load_dwordx4 v7, s[44:47], s39 offen offset:0 lds
    v_mfma_f32_16x16x32_bf16 v[56:59], a[28:31], a[144:147], v[56:59]
    ds_read_b64_tr_b16 a[20:21], v116 offset:7712
    v_mfma_f32_16x16x32_bf16 v[60:63], a[28:31], a[148:151], v[60:63]
    s_waitcnt lgkmcnt(9)
    ds_read_b64_tr_b16 a[22:23], v116 offset:7792
    v_mfma_f32_16x16x32_bf16 v[80:83], a[0:3], a[144:147], v[80:83]
    ds_read_b64_tr_b16 a[24:25], v117 offset:7680
    v_mfma_f32_16x16x32_bf16 v[84:87], a[0:3], a[148:151], v[84:87]
    s_waitcnt lgkmcnt(9)
    ds_read_b64_tr_b16 a[26:27], v117 offset:7760
    buffer_load_dwordx4 v8, s[44:47], s39 offen offset:1024 lds
    v_mfma_f32_16x16x32_bf16 v[48:51], a[4:7], a[152:155], v[48:51]
    ds_read_b64_tr_b16 a[28:29], v116 offset:30720
    v_mfma_f32_16x16x32_bf16 v[52:55], a[4:7], a[156:159], v[52:55]
    s_waitcnt lgkmcnt(9)
    ds_read_b64_tr_b16 a[30:31], v116 offset:30800
    v_mfma_f32_16x16x32_bf16 v[56:59], a[8:11], a[152:155], v[56:59]
    ds_read_b64_tr_b16 a[0:1], v116 offset:30752
    v_mfma_f32_16x16x32_bf16 v[60:63], a[8:11], a[156:159], v[60:63]
    s_waitcnt lgkmcnt(9)
    ds_read_b64_tr_b16 a[2:3], v116 offset:30832
    buffer_load_dwordx4 v9, s[44:47], s39 offen offset:2048 lds
    v_mfma_f32_16x16x32_bf16 v[80:83], a[12:15], a[152:155], v[80:83]
    ds_read_b64_tr_b16 a[4:5], v117 offset:30720
    v_mfma_f32_16x16x32_bf16 v[84:87], a[12:15], a[156:159], v[84:87]
    s_waitcnt lgkmcnt(9)
    ds_read_b64_tr_b16 a[6:7], v117 offset:30800
    v_mfma_f32_16x16x32_bf16 v[48:51], a[16:19], a[160:163], v[48:51]
    ds_read_b64_tr_b16 a[8:9], v116 offset:8960
    v_mfma_f32_16x16x32_bf16 v[52:55], a[16:19], a[164:167], v[52:55]
    s_waitcnt lgkmcnt(9)
    ds_read_b64_tr_b16 a[10:11], v116 offset:9040
    s_add_u32 m0, s40, 86016
    s_add_u32 s39, s39, 82944
    buffer_load_dwordx4 v7, s[44:47], s39 offen offset:0 lds
    v_mfma_f32_16x16x32_bf16 v[56:59], a[20:23], a[160:163], v[56:59]
    ds_read_b64_tr_b16 a[12:13], v116 offset:8992
    v_mfma_f32_16x16x32_bf16 v[60:63], a[20:23], a[164:167], v[60:63]
    s_waitcnt lgkmcnt(9)
    ds_read_b64_tr_b16 a[14:15], v116 offset:9072
    v_mfma_f32_16x16x32_bf16 v[80:83], a[24:27], a[160:163], v[80:83]
    ds_read_b64_tr_b16 a[16:17], v117 offset:8960
    v_mfma_f32_16x16x32_bf16 v[84:87], a[24:27], a[164:167], v[84:87]
    s_waitcnt lgkmcnt(9)
    ds_read_b64_tr_b16 a[18:19], v117 offset:9040
    buffer_load_dwordx4 v8, s[44:47], s39 offen offset:1024 lds
    v_mfma_f32_16x16x32_bf16 v[48:51], a[28:31], a[168:171], v[48:51]
    ds_read_b64_tr_b16 a[20:21], v116 offset:32000
    v_mfma_f32_16x16x32_bf16 v[52:55], a[28:31], a[172:175], v[52:55]
    s_waitcnt lgkmcnt(9)
    ds_read_b64_tr_b16 a[22:23], v116 offset:32080
    v_mfma_f32_16x16x32_bf16 v[56:59], a[0:3], a[168:171], v[56:59]
    ds_read_b64_tr_b16 a[24:25], v116 offset:32032
    v_mfma_f32_16x16x32_bf16 v[60:63], a[0:3], a[172:175], v[60:63]
    s_waitcnt lgkmcnt(9)
    ds_read_b64_tr_b16 a[26:27], v116 offset:32112
    buffer_load_dwordx4 v9, s[44:47], s39 offen offset:2048 lds
    v_mfma_f32_16x16x32_bf16 v[80:83], a[4:7], a[168:171], v[80:83]
    ds_read_b64_tr_b16 a[28:29], v117 offset:32000
    v_mfma_f32_16x16x32_bf16 v[84:87], a[4:7], a[172:175], v[84:87]
    s_waitcnt lgkmcnt(9)
    ds_read_b64_tr_b16 a[30:31], v117 offset:32080
    v_mfma_f32_16x16x32_bf16 v[48:51], a[8:11], a[176:179], v[48:51]
    ds_read_b64_tr_b16 a[0:1], v116 offset:10240
    v_mfma_f32_16x16x32_bf16 v[52:55], a[8:11], a[180:183], v[52:55]
    s_waitcnt lgkmcnt(9)
    ds_read_b64_tr_b16 a[2:3], v116 offset:10320
    s_add_u32 m0, s40, 98304
    s_nop 0
    buffer_load_dwordx4 v10, s[44:47], s38 offen offset:0 lds
    v_mfma_f32_16x16x32_bf16 v[56:59], a[12:15], a[176:179], v[56:59]
    ds_read_b64_tr_b16 a[4:5], v116 offset:10272
    v_mfma_f32_16x16x32_bf16 v[60:63], a[12:15], a[180:183], v[60:63]
    s_waitcnt lgkmcnt(9)
    ds_read_b64_tr_b16 a[6:7], v116 offset:10352
    v_mfma_f32_16x16x32_bf16 v[80:83], a[16:19], a[176:179], v[80:83]
    ds_read_b64_tr_b16 a[8:9], v117 offset:10240
    v_mfma_f32_16x16x32_bf16 v[84:87], a[16:19], a[180:183], v[84:87]
    s_waitcnt lgkmcnt(9)
    ds_read_b64_tr_b16 a[10:11], v117 offset:10320
    s_cmp_lg_u32 s30, 0
    s_cbranch_scc1 Kps_12
    s_mov_b32 s96, 0
    s_atomic_add s96, s[20:21], s53 glc
Kps_12:
    buffer_load_dwordx4 v11, s[44:47], s38 offen offset:1024 lds
    v_mfma_f32_16x16x32_bf16 v[48:51], a[20:23], a[184:187], v[48:51]
    ds_read_b64_tr_b16 a[12:13], v116 offset:33280
    v_mfma_f32_16x16x32_bf16 v[52:55], a[20:23], a[188:191], v[52:55]
    s_waitcnt lgkmcnt(9)
    ds_read_b64_tr_b16 a[14:15], v116 offset:33360
    v_mfma_f32_16x16x32_bf16 v[56:59], a[24:27], a[184:187], v[56:59]
    ds_read_b64_tr_b16 a[16:17], v116 offset:33312
    v_mfma_f32_16x16x32_bf16 v[60:63], a[24:27], a[188:191], v[60:63]
    s_waitcnt lgkmcnt(9)
    ds_read_b64_tr_b16 a[18:19], v116 offset:33392
    buffer_load_dwordx4 v12, s[44:47], s38 offen offset:2048 lds
    v_mfma_f32_16x16x32_bf16 v[80:83], a[28:31], a[184:187], v[80:83]
    ds_read_b64_tr_b16 a[20:21], v117 offset:33280
    v_mfma_f32_16x16x32_bf16 v[84:87], a[28:31], a[188:191], v[84:87]
    s_waitcnt lgkmcnt(9)
    ds_read_b64_tr_b16 a[22:23], v117 offset:33360
    v_mfma_f32_16x16x32_bf16 v[48:51], a[0:3], a[192:195], v[48:51]
    v_mfma_f32_16x16x32_bf16 v[52:55], a[0:3], a[196:199], v[52:55]
    s_waitcnt lgkmcnt(8)
    v_mfma_f32_16x16x32_bf16 v[56:59], a[4:7], a[192:195], v[56:59]
    v_mfma_f32_16x16x32_bf16 v[60:63], a[4:7], a[196:199], v[60:63]
    s_waitcnt lgkmcnt(6)
    v_mfma_f32_16x16x32_bf16 v[80:83], a[8:11], a[192:195], v[80:83]
    v_mfma_f32_16x16x32_bf16 v[84:87], a[8:11], a[196:199], v[84:87]
    s_waitcnt lgkmcnt(4)
    v_mfma_f32_16x16x32_bf16 v[48:51], a[12:15], a[200:203], v[48:51]
    v_mfma_f32_16x16x32_bf16 v[52:55], a[12:15], a[204:207], v[52:55]
    s_waitcnt lgkmcnt(2)
    v_mfma_f32_16x16x32_bf16 v[56:59], a[16:19], a[200:203], v[56:59]
    v_mfma_f32_16x16x32_bf16 v[60:63], a[16:19], a[204:207], v[60:63]
    s_waitcnt lgkmcnt(0)
    v_mfma_f32_16x16x32_bf16 v[80:83], a[20:23], a[200:203], v[80:83]
    v_mfma_f32_16x16x32_bf16 v[84:87], a[20:23], a[204:207], v[84:87]
    s_nop 0
    v_cvt_pk_bf16_f32 v32, v48, v49
    v_cvt_pk_bf16_f32 v33, v50, v51
    s_nop 0
    v_cvt_pk_bf16_f32 v34, v56, v57
    v_cvt_pk_bf16_f32 v35, v58, v59
    s_nop 0
    v_cvt_pk_bf16_f32 v40, v80, v81
    v_cvt_pk_bf16_f32 v41, v82, v83
    v_cvt_pk_bf16_f32 v36, v52, v53
    v_cvt_pk_bf16_f32 v37, v54, v55
    v_cvt_pk_bf16_f32 v38, v60, v61
    v_cvt_pk_bf16_f32 v39, v62, v63
    v_cvt_pk_bf16_f32 v44, v84, v85
    v_cvt_pk_bf16_f32 v45, v86, v87
    v_mfma_f32_16x16x32_bf16 v[88:91], a[232:235], v[32:35], 0
    v_mfma_f32_16x16x32_bf16 v[92:95], a[236:239], v[32:35], 0
    v_mfma_f32_16x16x32_bf16 v[96:99], a[240:243], v[32:35], 0
    v_mfma_f32_16x16x32_bf16 v[100:103], a[232:235], v[36:39], 0
    v_mfma_f32_16x16x32_bf16 v[104:107], a[236:239], v[36:39], 0
    v_mfma_f32_16x16x32_bf16 v[108:111], a[240:243], v[36:39], 0
    v_mfma_f32_16x16x32_bf16 v[88:91], a[244:247], v[40:43], v[88:91]
    v_mfma_f32_16x16x32_bf16 v[92:95], a[248:251], v[40:43], v[92:95]
    v_mfma_f32_16x16x32_bf16 v[96:99], a[252:255], v[40:43], v[96:99]
    v_mfma_f32_16x16x32_bf16 v[100:103], a[244:247], v[44:47], v[100:103]
    v_mfma_f32_16x16x32_bf16 v[104:107], a[248:251], v[44:47], v[104:107]
    v_mfma_f32_16x16x32_bf16 v[108:111], a[252:255], v[44:47], v[108:111]
    s_cmp_lg_u32 s30, 0
    s_cbranch_scc1 Kpf_13
    s_mov_b32 s97, 0
Kpfl_14:
    s_waitcnt lgkmcnt(0)
    s_cmp_ge_u32 s96, 16
    s_cbranch_scc1 Kpf_13
    s_mov_b32 s96, 0
    s_atomic_add s96, s[20:21], s53 glc
    s_add_u32 s97, s97, 1
    s_cmp_lt_u32 s97, 0x100000
    s_cbranch_scc1 Kpfl_14
    s_waitcnt lgkmcnt(0)
Kpf_13:
    s_barrier
    s_add_u32 s36, s52, 65536
    s_and_b32 s37, s32, 3
    s_mul_i32 s37, s37, 16384
    s_add_u32 s52, s52, s37
    buffer_load_dwordx4 a[64:67], v131, s[20:23], s52 offen offset:0 sc1
    buffer_load_dwordx4 a[68:71], v131, s[20:23], s52 offen offset:256 sc1
    buffer_load_dwordx4 a[72:75], v131, s[20:23], s52 offen offset:512 sc1
    buffer_load_dwordx4 a[76:79], v132, s[20:23], s52 offen offset:768 sc1
    s_add_u32 s52, s52, 16384
    s_cmp_ge_u32 s52, s36
    s_cselect_b32 s37, 65536, 0
    s_sub_u32 s52, s52, s37
    buffer_load_dwordx4 a[80:83], v131, s[20:23], s52 offen offset:0 sc1
    buffer_load_dwordx4 a[84:87], v131, s[20:23], s52 offen offset:256 sc1
    buffer_load_dwordx4 a[88:91], v131, s[20:23], s52 offen offset:512 sc1
    buffer_load_dwordx4 a[92:95], v132, s[20:23], s52 offen offset:768 sc1
    s_add_u32 s52, s52, 16384
    s_cmp_ge_u32 s52, s36
    s_cselect_b32 s37, 65536, 0
    s_sub_u32 s52, s52, s37
    buffer_load_dwordx4 a[96:99], v131, s[20:23], s52 offen offset:0 sc1
    buffer_load_dwordx4 a[100:103], v131, s[20:23], s52 offen offset:256 sc1
    buffer_load_dwordx4 a[104:107], v131, s[20:23], s52 offen offset:512 sc1
    buffer_load_dwordx4 a[108:111], v132, s[20:23], s52 offen offset:768 sc1
    s_add_u32 s52, s52, 16384
    s_cmp_ge_u32 s52, s36
    s_cselect_b32 s37, 65536, 0
    s_sub_u32 s52, s52, s37
    buffer_load_dwordx4 a[112:115], v131, s[20:23], s52 offen offset:0 sc1
    buffer_load_dwordx4 a[116:119], v131, s[20:23], s52 offen offset:256 sc1
    buffer_load_dwordx4 a[120:123], v131, s[20:23], s52 offen offset:512 sc1
    buffer_load_dwordx4 a[124:127], v132, s[20:23], s52 offen offset:768 sc1
    s_mul_i32 s92, s31, 144
    s_add_u32 s92, s92, 46923776
    buffer_load_dwordx4 v[220:223], v166, s[20:23], s92 offen sc1
    buffer_load_dwordx4 v[224:227], v166, s[20:23], s92 offen offset:16 sc1
    buffer_load_dwordx2 v[228:229], v167, s[20:23], s92 offen sc1
    s_add_u32 m0, s40, 0
    s_sub_u32 s39, s39, 580608
    buffer_load_dwordx4 v7, s[44:47], s39 offen offset:0 lds
    buffer_load_dwordx4 v8, s[44:47], s39 offen offset:1024 lds
    buffer_load_dwordx4 v9, s[44:47], s39 offen offset:2048 lds
    v_max3_f32 v16, v88, v89, v90
    v_min3_f32 v18, v88, v89, v90
    v_max3_f32 v17, v100, v101, v102
    v_min3_f32 v19, v100, v101, v102
    v_max3_f32 v16, v16, v91, v92
    v_min3_f32 v18, v18, v91, v92
    v_max3_f32 v17, v17, v103, v104
    v_min3_f32 v19, v19, v103, v104
    v_max3_f32 v16, v16, v93, v94
    v_min3_f32 v18, v18, v93, v94
    v_max3_f32 v17, v17, v105, v106
    v_min3_f32 v19, v19, v105, v106
    v_max3_f32 v16, v16, v95, v96
    v_min3_f32 v18, v18, v95, v96
    v_max3_f32 v17, v17, v107, v108
    v_min3_f32 v19, v19, v107, v108
    v_max_f32 v16, v16, v97
    v_min_f32 v18, v18, v97
    v_max_f32 v17, v17, v109
    v_min_f32 v19, v19, v109
    s_nop 0
    v_permlane16_swap_b32 v16, v17
    v_permlane16_swap_b32 v18, v19
    v_max_f32 v16, v16, v17
    v_min_f32 v18, v18, v19
    v_mul_f32 v20, s48, v16
    v_mul_f32 v24, s48, v18
    v_mov_b32 v22, v20
    v_mov_b32 v26, v24
    s_nop 0
    v_permlane16_swap_b32 v20, v22
    v_permlane16_swap_b32 v24, v26
    v_pk_fma_f32 v[140:141], v[88:89], s[48:49], v[24:25] op_sel_hi:[1,0,0] neg_lo:[1,0,0] neg_hi:[1,0,0]
    v_pk_fma_f32 v[88:89], v[88:89], s[48:49], v[20:21] op_sel_hi:[1,0,0] neg_lo:[0,0,1] neg_hi:[0,0,1]
    v_pk_fma_f32 v[142:143], v[90:91], s[48:49], v[24:25] op_sel_hi:[1,0,0] neg_lo:[1,0,0] neg_hi:[1,0,0]
    v_pk_fma_f32 v[90:91], v[90:91], s[48:49], v[20:21] op_sel_hi:[1,0,0] neg_lo:[0,0,1] neg_hi:[0,0,1]
    v_pk_fma_f32 v[144:145], v[92:93], s[48:49], v[24:25] op_sel_hi:[1,0,0] neg_lo:[1,0,0] neg_hi:[1,0,0]
    v_pk_fma_f32 v[92:93], v[92:93], s[48:49], v[20:21] op_sel_hi:[1,0,0] neg_lo:[0,0,1] neg_hi:[0,0,1]
    v_pk_fma_f32 v[146:147], v[94:95], s[48:49], v[24:25] op_sel_hi:[1,0,0] neg_lo:[1,0,0] neg_hi:[1,0,0]
    v_pk_fma_f32 v[94:95], v[94:95], s[48:49], v[20:21] op_sel_hi:[1,0,0] neg_lo:[0,0,1] neg_hi:[0,0,1]
    v_pk_fma_f32 v[148:149], v[96:97], s[48:49], v[24:25] op_sel_hi:[1,0,0] neg_lo:[1,0,0] neg_hi:[1,0,0]
    v_pk_fma_f32 v[96:97], v[96:97], s[48:49], v[20:21] op_sel_hi:[1,0,0] neg_lo:[0,0,1] neg_hi:[0,0,1]
    v_pk_fma_f32 v[152:153], v[100:101], s[48:49], v[26:27] op_sel_hi:[1,0,0] neg_lo:[1,0,0] neg_hi:[1,0,0]
    v_pk_fma_f32 v[100:101], v[100:101], s[48:49], v[22:23] op_sel_hi:[1,0,0] neg_lo:[0,0,1] neg_hi:[0,0,1]
    v_pk_fma_f32 v[154:155], v[102:103], s[48:49], v[26:27] op_sel_hi:[1,0,0] neg_lo:[1,0,0] neg_hi:[1,0,0]
    v_pk_fma_f32 v[102:103], v[102:103], s[48:49], v[22:23] op_sel_hi:[1,0,0] neg_lo:[0,0,1] neg_hi:[0,0,1]
    v_pk_fma_f32 v[156:157], v[104:105], s[48:49], v[26:27] op_sel_hi:[1,0,0] neg_lo:[1,0,0] neg_hi:[1,0,0]
    v_pk_fma_f32 v[104:105], v[104:105], s[48:49], v[22:23] op_sel_hi:[1,0,0] neg_lo:[0,0,1] neg_hi:[0,0,1]
    v_pk_fma_f32 v[158:159], v[106:107], s[48:49], v[26:27] op_sel_hi:[1,0,0] neg_lo:[1,0,0] neg_hi:[1,0,0]
    v_pk_fma_f32 v[106:107], v[106:107], s[48:49], v[22:23] op_sel_hi:[1,0,0] neg_lo:[0,0,1] neg_hi:[0,0,1]
    v_pk_fma_f32 v[160:161], v[108:109], s[48:49], v[26:27] op_sel_hi:[1,0,0] neg_lo:[1,0,0] neg_hi:[1,0,0]
    v_pk_fma_f32 v[108:109], v[108:109], s[48:49], v[22:23] op_sel_hi:[1,0,0] neg_lo:[0,0,1] neg_hi:[0,0,1]
    v_exp_f32 v88, v88
    v_exp_f32 v140, v140
    v_exp_f32 v89, v89
    v_exp_f32 v141, v141
    v_exp_f32 v90, v90
    v_exp_f32 v142, v142
    v_exp_f32 v91, v91
    v_exp_f32 v143, v143
    v_exp_f32 v92, v92
    v_exp_f32 v144, v144
    v_exp_f32 v93, v93
    v_exp_f32 v145, v145
    v_exp_f32 v94, v94
    v_exp_f32 v146, v146
    v_exp_f32 v95, v95
    v_exp_f32 v147, v147
    v_exp_f32 v96, v96
    v_exp_f32 v148, v148
    v_exp_f32 v97, v97
    v_exp_f32 v149, v149
    v_exp_f32 v100, v100
    v_exp_f32 v152, v152
    v_exp_f32 v101, v101
    v_exp_f32 v153, v153
    v_exp_f32 v102, v102
    v_exp_f32 v154, v154
    v_exp_f32 v103, v103
    v_exp_f32 v155, v155
    v_exp_f32 v104, v104
    v_exp_f32 v156, v156
    v_exp_f32 v105, v105
    v_exp_f32 v157, v157
    v_exp_f32 v106, v106
    v_exp_f32 v158, v158
    v_exp_f32 v107, v107
    v_exp_f32 v159, v159
    v_exp_f32 v108, v108
    v_exp_f32 v160, v160
    v_exp_f32 v109, v109
    v_exp_f32 v161, v161
    v_pk_mul_f32 v[96:97], v[96:97], v[138:139] op_sel_hi:[1,0]
    v_pk_mul_f32 v[108:109], v[108:109], v[138:139] op_sel_hi:[1,0]
    v_pk_mul_f32 v[148:149], v[148:149], v[138:139] op_sel_hi:[1,0]
    v_pk_mul_f32 v[160:161], v[160:161], v[138:139] op_sel_hi:[1,0]
    v_pk_add_f32 v[16:17], v[88:89], v[90:91]
    v_pk_add_f32 v[18:19], v[100:101], v[102:103]
    v_pk_add_f32 v[20:21], v[140:141], v[142:143]
    v_pk_add_f32 v[22:23], v[152:153], v[154:155]
    v_pk_add_f32 v[24:25], v[92:93], v[94:95]
    v_pk_add_f32 v[26:27], v[104:105], v[106:107]
    v_pk_add_f32 v[28:29], v[144:145], v[146:147]
    v_pk_add_f32 v[30:31], v[156:157], v[158:159]
    v_pk_add_f32 v[16:17], v[16:17], v[96:97]
    v_pk_add_f32 v[18:19], v[18:19], v[108:109]
    v_pk_add_f32 v[20:21], v[20:21], v[148:149]
    v_pk_add_f32 v[22:23], v[22:23], v[160:161]
    v_pk_add_f32 v[16:17], v[16:17], v[24:25]
    v_pk_add_f32 v[18:19], v[18:19], v[26:27]
    v_pk_add_f32 v[20:21], v[20:21], v[28:29]
    v_pk_add_f32 v[22:23], v[22:23], v[30:31]
    v_add_f32 v16, v16, v17
    v_add_f32 v18, v18, v19
    v_add_f32 v20, v20, v21
    v_add_f32 v22, v22, v23
    v_permlane16_swap_b32 v16, v18
    s_nop 0
    v_permlane16_swap_b32 v20, v22
    v_add_f32 v16, v16, v18
    v_add_f32 v20, v20, v22
    v_rcp_f32 v16, v16
    v_rcp_f32 v20, v20
    s_nop 0
    v_mov_b32 v18, v16
    v_mov_b32 v22, v20
    s_nop 0
    v_permlane16_swap_b32 v16, v18
    v_permlane16_swap_b32 v20, v22
    v_pk_mul_f32 v[88:89], v[88:89], v[16:17] op_sel_hi:[1,0]
    v_pk_mul_f32 v[90:91], v[90:91], v[16:17] op_sel_hi:[1,0]
    v_pk_mul_f32 v[92:93], v[92:93], v[16:17] op_sel_hi:[1,0]
    v_pk_mul_f32 v[94:95], v[94:95], v[16:17] op_sel_hi:[1,0]
    v_pk_mul_f32 v[96:97], v[96:97], v[16:17] op_sel_hi:[1,0]
    v_pk_mul_f32 v[100:101], v[100:101], v[18:19] op_sel_hi:[1,0]
    v_pk_mul_f32 v[102:103], v[102:103], v[18:19] op_sel_hi:[1,0]
    v_pk_mul_f32 v[104:105], v[104:105], v[18:19] op_sel_hi:[1,0]
    v_pk_mul_f32 v[106:107], v[106:107], v[18:19] op_sel_hi:[1,0]
    v_pk_mul_f32 v[108:109], v[108:109], v[18:19] op_sel_hi:[1,0]
    v_pk_mul_f32 v[140:141], v[140:141], v[20:21] op_sel_hi:[1,0]
    v_pk_mul_f32 v[142:143], v[142:143], v[20:21] op_sel_hi:[1,0]
    v_pk_mul_f32 v[144:145], v[144:145], v[20:21] op_sel_hi:[1,0]
    v_pk_mul_f32 v[146:147], v[146:147], v[20:21] op_sel_hi:[1,0]
    v_pk_mul_f32 v[148:149], v[148:149], v[20:21] op_sel_hi:[1,0]
    v_pk_mul_f32 v[152:153], v[152:153], v[22:23] op_sel_hi:[1,0]
    v_pk_mul_f32 v[154:155], v[154:155], v[22:23] op_sel_hi:[1,0]
    v_pk_mul_f32 v[156:157], v[156:157], v[22:23] op_sel_hi:[1,0]
    v_pk_mul_f32 v[158:159], v[158:159], v[22:23] op_sel_hi:[1,0]
    v_pk_mul_f32 v[160:161], v[160:161], v[22:23] op_sel_hi:[1,0]
    v_cvt_pk_bf16_f32 v176, v88, v89
    v_cvt_pk_bf16_f32 v177, v90, v91
    v_cvt_pk_bf16_f32 v178, v92, v93
    v_cvt_pk_bf16_f32 v179, v94, v95
    v_cvt_pk_bf16_f32 v180, v96, v97
    v_cvt_pk_bf16_f32 v182, v140, v141
    v_cvt_pk_bf16_f32 v183, v142, v143
    v_cvt_pk_bf16_f32 v184, v144, v145
    v_cvt_pk_bf16_f32 v185, v146, v147
    v_cvt_pk_bf16_f32 v186, v148, v149
    v_cvt_pk_bf16_f32 v188, v100, v101
    v_cvt_pk_bf16_f32 v189, v102, v103
    v_cvt_pk_bf16_f32 v190, v104, v105
    v_cvt_pk_bf16_f32 v191, v106, v107
    v_cvt_pk_bf16_f32 v192, v108, v109
    v_cvt_pk_bf16_f32 v194, v152, v153
    v_cvt_pk_bf16_f32 v195, v154, v155
    v_cvt_pk_bf16_f32 v196, v156, v157
    v_cvt_pk_bf16_f32 v197, v158, v159
    v_cvt_pk_bf16_f32 v198, v160, v161
    s_waitcnt vmcnt(18)
    v_mfma_f32_16x16x32_bf16 v[48:51], a[224:227], a[64:67], 0
    v_mfma_f32_16x16x32_bf16 v[48:51], a[228:231], a[68:71], v[48:51]
    v_mfma_f32_16x16x32_bf16 v[52:55], a[224:227], a[72:75], 0
    v_mfma_f32_16x16x32_bf16 v[52:55], a[228:231], a[76:79], v[52:55]
    s_waitcnt vmcnt(14)
    v_mfma_f32_16x16x32_bf16 v[48:51], a[224:227], a[80:83], v[48:51]
    v_mfma_f32_16x16x32_bf16 v[48:51], a[228:231], a[84:87], v[48:51]
    v_mfma_f32_16x16x32_bf16 v[52:55], a[224:227], a[88:91], v[52:55]
    v_mfma_f32_16x16x32_bf16 v[52:55], a[228:231], a[92:95], v[52:55]
    s_waitcnt vmcnt(10)
    v_mfma_f32_16x16x32_bf16 v[48:51], a[224:227], a[96:99], v[48:51]
    v_mfma_f32_16x16x32_bf16 v[48:51], a[228:231], a[100:103], v[48:51]
    v_mfma_f32_16x16x32_bf16 v[52:55], a[224:227], a[104:107], v[52:55]
    v_mfma_f32_16x16x32_bf16 v[52:55], a[228:231], a[108:111], v[52:55]
    s_waitcnt vmcnt(6)
    v_mfma_f32_16x16x32_bf16 v[48:51], a[224:227], a[112:115], v[48:51]
    v_mfma_f32_16x16x32_bf16 v[48:51], a[228:231], a[116:119], v[48:51]
    v_mfma_f32_16x16x32_bf16 v[52:55], a[224:227], a[120:123], v[52:55]
    v_mfma_f32_16x16x32_bf16 v[52:55], a[228:231], a[124:127], v[52:55]
    s_mul_i32 s36, s35, 36864
    s_add_u32 s36, s36, 40894464
    s_lshl_b32 s37, s31, 7
    s_add_u32 s37, s37, s36
    s_add_u32 s39, s37, 18432
    s_lshl_b32 s38, s31, 10
    s_add_u32 s36, s36, s38
    s_add_u32 s38, s36, 18432
    s_lshl_b32 s53, s32, 13
    s_add_u32 s53, s53, 46145536
    v_cvt_pk_bf16_f32 v16, v48, v49
    v_cvt_pk_bf16_f32 v17, v50, v51
    v_cvt_pk_bf16_f32 v18, v52, v53
    v_cvt_pk_bf16_f32 v19, v54, v55
    ds_write_b64 v135, v[16:17]
    ds_write_b64 v136, v[18:19]
    s_waitcnt lgkmcnt(0)
    s_barrier
    ds_read_b128 a[8:11], v134 offset:0
    ds_read_b128 a[0:3], v133 offset:0
    ds_read_b128 a[4:7], v119 offset:0
    ds_read_b128 a[20:23], v134 offset:16
    ds_read_b128 a[12:15], v133 offset:16
    ds_read_b128 a[16:19], v119 offset:16
    ds_read_b128 a[32:35], v134 offset:32
    ds_read_b128 a[24:27], v133 offset:32
    ds_read_b128 a[28:31], v119 offset:32
    s_waitcnt lgkmcnt(6)
    v_mfma_f32_16x16x32_bf16 v[96:99], a[8:11], v[176:179], 0
    v_mfma_f32_16x16x32_bf16 v[108:111], a[8:11], v[188:191], 0
    v_mfma_f32_16x16x32_bf16 v[88:91], a[0:3], v[176:179], 0
    v_mfma_f32_16x16x32_bf16 v[100:103], a[0:3], v[188:191], 0
    v_mfma_f32_16x16x32_bf16 v[92:95], a[4:7], v[176:179], 0
    v_mfma_f32_16x16x32_bf16 v[104:107], a[4:7], v[188:191], 0
    s_waitcnt lgkmcnt(3)
    v_mfma_f32_16x16x32_bf16 v[96:99], a[20:23], v[180:183], v[96:99]
    v_mfma_f32_16x16x32_bf16 v[108:111], a[20:23], v[192:195], v[108:111]
    v_mfma_f32_16x16x32_bf16 v[88:91], a[12:15], v[180:183], v[88:91]
    v_mfma_f32_16x16x32_bf16 v[100:103], a[12:15], v[192:195], v[100:103]
    v_mfma_f32_16x16x32_bf16 v[92:95], a[16:19], v[180:183], v[92:95]
    v_mfma_f32_16x16x32_bf16 v[104:107], a[16:19], v[192:195], v[104:107]
    s_waitcnt lgkmcnt(0)
    v_mfma_f32_16x16x32_bf16 v[96:99], a[32:35], v[184:187], v[96:99]
    v_mfma_f32_16x16x32_bf16 v[108:111], a[32:35], v[196:199], v[108:111]
    v_mfma_f32_16x16x32_bf16 v[88:91], a[24:27], v[184:187], v[88:91]
    v_mfma_f32_16x16x32_bf16 v[100:103], a[24:27], v[196:199], v[100:103]
    v_mfma_f32_16x16x32_bf16 v[92:95], a[28:31], v[184:187], v[92:95]
    v_mfma_f32_16x16x32_bf16 v[104:107], a[28:31], v[196:199], v[104:107]
    s_nop 2
    v_add_f32 v98, 0x358637bd, v98
    v_add_f32 v110, 0x358637bd, v110
    v_rcp_f32 v98, v98
    v_rcp_f32 v110, v110
    v_pk_mul_f32 v[88:89], v[88:89], v[98:99] op_sel_hi:[1,0]
    v_pk_mul_f32 v[90:91], v[90:91], v[98:99] op_sel_hi:[1,0]
    v_pk_mul_f32 v[92:93], v[92:93], v[98:99] op_sel_hi:[1,0]
    v_pk_mul_f32 v[94:95], v[94:95], v[98:99] op_sel_hi:[1,0]
    v_pk_mul_f32 v[96:97], v[96:97], v[98:99] op_sel_hi:[1,0]
    v_cvt_pk_bf16_f32 v16, v88, v89
    v_cvt_pk_bf16_f32 v17, v90, v91
    v_cvt_pk_bf16_f32 v18, v92, v93
    v_cvt_pk_bf16_f32 v19, v94, v95
    v_cvt_pk_bf16_f32 v20, v96, v97
    buffer_store_dwordx4 v[16:19], v5, s[20:23], s36 offen sc1
    buffer_store_dword v20, v137, s[20:23], s37 offen sc1
    v_pk_mul_f32 v[100:101], v[100:101], v[110:111] op_sel_hi:[1,0]
    v_pk_mul_f32 v[102:103], v[102:103], v[110:111] op_sel_hi:[1,0]
    v_pk_mul_f32 v[104:105], v[104:105], v[110:111] op_sel_hi:[1,0]
    v_pk_mul_f32 v[106:107], v[106:107], v[110:111] op_sel_hi:[1,0]
    v_pk_mul_f32 v[108:109], v[108:109], v[110:111] op_sel_hi:[1,0]
    v_cvt_pk_bf16_f32 v24, v100, v101
    v_cvt_pk_bf16_f32 v25, v102, v103
    v_cvt_pk_bf16_f32 v26, v104, v105
    v_cvt_pk_bf16_f32 v27, v106, v107
    v_cvt_pk_bf16_f32 v28, v108, v109
    buffer_store_dwordx4 v[24:27], v5, s[20:23], s38 offen sc1
    buffer_store_dword v28, v137, s[20:23], s39 offen sc1
    s_waitcnt vmcnt(7)
    v_pk_mul_f32 v[230:231], v[88:89], v[220:221]
    v_pk_mul_f32 v[232:233], v[100:101], v[220:221]
    v_pk_fma_f32 v[230:231], v[90:91], v[222:223], v[230:231]
    v_pk_fma_f32 v[232:233], v[102:103], v[222:223], v[232:233]
    v_pk_fma_f32 v[230:231], v[92:93], v[224:225], v[230:231]
    v_pk_fma_f32 v[232:233], v[104:105], v[224:225], v[232:233]
    v_pk_fma_f32 v[230:231], v[94:95], v[226:227], v[230:231]
    v_pk_fma_f32 v[232:233], v[106:107], v[226:227], v[232:233]
    v_pk_fma_f32 v[230:231], v[96:97], v[228:229], v[230:231]
    v_pk_fma_f32 v[232:233], v[108:109], v[228:229], v[232:233]
    v_add_f32 v230, v230, v231
    v_add_f32 v232, v232, v233
    s_lshl_b32 s92, s35, 4
    s_add_u32 s92, s92, s31
    s_lshl_b32 s92, s92, 7
    s_add_u32 s92, s92, 46989312
    v_permlane16_swap_b32 v230, v232
    v_add_f32 v230, v230, v232
    v_mov_b32 v231, v230
    v_lshlrev_b32 v229, 2, v15
    s_nop 0
    v_permlane32_swap_b32 v230, v231
    v_add_f32 v230, v230, v231
    s_mov_b32 exec_hi, 0
    buffer_store_dword v230, v229, s[20:23], s92 offen sc1
    s_mov_b64 exec, -1
    s_waitcnt vmcnt(0)
    s_barrier
    s_cmp_lg_u32 s30, 0
    s_cbranch_scc1 Ksig_15
    s_mov_b32 s98, 1
    s_atomic_add s98, s[20:21], s53
Ksig_15:
    s_lshr_b32 s53, s27, 1
    s_and_b32 s53, s53, 15
    s_lshl_b32 s53, s53, 13
    s_add_u32 s53, s53, 46145536
    s_cmp_lg_u32 s30, 0
    s_cbranch_scc1 Kps_16
    s_mov_b32 s96, 0
    s_atomic_add s96, s[20:21], s53 glc
Kps_16:
    s_lshl_b32 s35, s27, 2
    s_add_u32 s35, s35, s30
    s_mul_i32 s36, s35, 18432
    s_mul_i32 s37, s26, 192
    s_add_u32 s36, s36, s37
    buffer_load_dwordx2 v[208:209], v174, s[12:15], s36 offen offset:0
    buffer_load_dwordx2 v[210:211], v174, s[12:15], s36 offen offset:32
    buffer_load_dwordx2 v[212:213], v174, s[12:15], s36 offen offset:64
    buffer_load_dwordx2 v[214:215], v174, s[12:15], s36 offen offset:96
    buffer_load_dwordx2 v[216:217], v174, s[12:15], s36 offen offset:128
    buffer_load_dwordx2 v[218:219], v174, s[12:15], s36 offen offset:160
    v_mov_b32 v30, v15
    s_lshl_b32 s31, s29, 1
    s_and_b32 s33, s28, 1
    s_add_u32 s31, s31, s33
    s_lshr_b32 s32, s28, 1
    s_and_b32 s33, s30, 1
    s_lshr_b32 s34, s30, 1
    v_lshlrev_b32 v15, 4, v30
    s_movk_i32 s3, 12288
    buffer_load_dwordx4 v[0:3], v15, s[88:91], s3 offen offset:1024
    s_movk_i32 s3, 12288
    buffer_load_dwordx4 v[4:7], v15, s[88:91], s3 offen offset:2048
    s_movk_i32 s3, 12288
    buffer_load_dwordx4 v[8:11], v15, s[88:91], s3 offen offset:3072
    s_movk_i32 s3, 16384
    buffer_load_dwordx4 v[16:19], v15, s[88:91], s3 offen offset:0
    s_movk_i32 s3, 16384
    buffer_load_dwordx4 v[24:27], v15, s[88:91], s3 offen offset:1024
    s_movk_i32 s3, 16384
    buffer_load_dwordx4 a[236:239], v15, s[88:91], s3 offen offset:2048
    s_movk_i32 s3, 16384
    buffer_load_dwordx4 a[240:243], v15, s[88:91], s3 offen offset:3072
    s_movk_i32 s3, 20480
    buffer_load_dwordx4 a[244:247], v15, s[88:91], s3 offen offset:0
    s_cmp_eq_u32 s34, 0
    s_cselect_b32 s12, s4, s6
    s_cselect_b32 s13, s5, s7
    s_sub_u32 s12, s12, 3072
    s_subb_u32 s13, s13, 0
    s_mov_b32 s14, 5311488
    s_mov_b32 s15, 0x20000
    s_mov_b32 s16, s8
    s_mov_b32 s17, s9
    s_mov_b32 s18, 5308416
    s_mov_b32 s19, 0x20000
    s_mul_i32 s36, s31, 576
    s_mul_i32 s39, s33, 147456
    s_add_u32 s36, s36, s39
    s_mul_i32 s37, s30, 9216
    s_cmp_ge_u32 s28, 24
    s_cbranch_scc1 K_idle
    s_mul_i32 s48, s35, 18432
    s_add_u32 s48, s48, 40894464
    s_add_u32 s38, s48, 16384
    v_lshlrev_b32 v169, 2, v30
    s_lshr_b32 s49, s35, 1
    s_lshl_b32 s49, s49, 11
    s_and_b32 s50, s35, 1
    s_lshl_b32 s50, s50, 6
    s_add_u32 s49, s49, s50
    s_add_u32 s49, s49, 46989312
    s_lshl_b32 s50, s35, 6
    s_add_u32 s50, s50, 46927872
    v_lshrrev_b32 v176, 4, v30
    v_and_b32 v177, 15, v30
    v_lshlrev_b32 v177, 2, v177
    v_lshl_add_u32 v176, v176, 7, v177
    s_cmp_lg_u32 s30, 0
    s_cbranch_scc1 Kpf_17
    s_mov_b32 s97, 0
Kpfl_18:
    s_waitcnt lgkmcnt(0)
    s_cmp_ge_u32 s96, 16
    s_cbranch_scc1 Kpf_17
    s_mov_b32 s96, 0
    s_atomic_add s96, s[20:21], s53 glc
    s_add_u32 s97, s97, 1
    s_cmp_lt_u32 s97, 0x100000
    s_cbranch_scc1 Kpfl_18
    s_waitcnt lgkmcnt(0)
Kpf_17:
    s_barrier
    buffer_load_dword v178, v176, s[20:23], s49 offen offset:0 sc1
    buffer_load_dword v179, v176, s[20:23], s49 offen offset:512 sc1
    buffer_load_dword v180, v176, s[20:23], s49 offen offset:1024 sc1
    buffer_load_dword v181, v176, s[20:23], s49 offen offset:1536 sc1
    buffer_load_dword v182, v177, s[20:23], s50 offen sc1
    buffer_load_dwordx4 a[64:67], v15, s[20:23], s48 offen offset:0 sc1
    buffer_load_dwordx4 a[68:71], v15, s[20:23], s48 offen offset:1024 sc1
    buffer_load_dwordx4 a[72:75], v15, s[20:23], s48 offen offset:2048 sc1
    buffer_load_dwordx4 a[76:79], v15, s[20:23], s48 offen offset:3072 sc1
    s_add_u32 s48, s48, 4096
    buffer_load_dwordx4 a[80:83], v15, s[20:23], s48 offen offset:0 sc1
    buffer_load_dwordx4 a[84:87], v15, s[20:23], s48 offen offset:1024 sc1
    buffer_load_dwordx4 a[88:91], v15, s[20:23], s48 offen offset:2048 sc1
    buffer_load_dwordx4 a[92:95], v15, s[20:23], s48 offen offset:3072 sc1
    s_add_u32 s48, s48, 4096
    buffer_load_dwordx4 a[96:99], v15, s[20:23], s48 offen offset:0 sc1
    buffer_load_dwordx4 a[100:103], v15, s[20:23], s48 offen offset:1024 sc1
    buffer_load_dwordx4 a[104:107], v15, s[20:23], s48 offen offset:2048 sc1
    buffer_load_dwordx4 a[108:111], v15, s[20:23], s48 offen offset:3072 sc1
    s_add_u32 s48, s48, 4096
    buffer_load_dwordx4 a[112:115], v15, s[20:23], s48 offen offset:0 sc1
    buffer_load_dwordx4 a[116:119], v15, s[20:23], s48 offen offset:1024 sc1
    buffer_load_dwordx4 a[120:123], v15, s[20:23], s48 offen offset:2048 sc1
    buffer_load_dwordx4 a[124:127], v15, s[20:23], s48 offen offset:3072 sc1
    buffer_load_dword a128, v175, s[20:23], s38 offen offset:0 sc1
    buffer_load_dword a129, v175, s[20:23], s38 offen offset:64 sc1
    buffer_load_dword a130, v175, s[20:23], s38 offen offset:128 sc1
    buffer_load_dword a131, v175, s[20:23], s38 offen offset:192 sc1
    buffer_load_dword a132, v175, s[20:23], s38 offen offset:1024 sc1
    buffer_load_dword a133, v175, s[20:23], s38 offen offset:1088 sc1
    buffer_load_dword a134, v175, s[20:23], s38 offen offset:1152 sc1
    buffer_load_dword a135, v175, s[20:23], s38 offen offset:1216 sc1
    ds_read_b64_tr_b16 a[0:1], v170 offset:0
    ds_read_b64_tr_b16 a[2:3], v170 offset:768
    ds_read_b64_tr_b16 a[4:5], v171 offset:32
    ds_read_b64_tr_b16 a[6:7], v171 offset:800
    ds_read_b64_tr_b16 a[8:9], v170 offset:64
    ds_read_b64_tr_b16 a[10:11], v170 offset:832
    ds_read_b64_tr_b16 a[12:13], v171 offset:96
    ds_read_b64_tr_b16 a[14:15], v171 offset:864
    ds_read_b64_tr_b16 a[16:17], v170 offset:128
    ds_read_b64_tr_b16 a[18:19], v170 offset:896
    ds_read_b64_tr_b16 a[20:21], v171 offset:160
    ds_read_b64_tr_b16 a[22:23], v171 offset:928
    ds_read_b64_tr_b16 a[24:25], v170 offset:6144
    ds_read_b64_tr_b16 a[26:27], v170 offset:6912
    s_waitcnt vmcnt(24)
    v_add_f32 v178, v178, v179
    v_add_f32 v180, v180, v181
    v_add_f32 v178, v178, v180
    v_mov_b32 v179, v178
    s_nop 1
    v_permlane16_swap_b32 v178, v179
    v_add_f32 v178, v178, v179
    v_mov_b32 v179, v178
    s_nop 1
    v_permlane32_swap_b32 v178, v179
    v_add_f32 v178, v178, v179
    v_add_f32 v178, v178, v182
    s_mov_b32 s50, 0x3f80
    s_mov_b32 s51, 0x3f800000
    v_sub_f32 v180, 0, v178
    v_dot2_f32_bf16 v220, v208, s50, v180
    v_dot2_f32_bf16 v221, v208, s51, v180
    v_dot2_f32_bf16 v222, v209, s50, v180
    v_dot2_f32_bf16 v223, v209, s51, v180
    v_dot2_f32_bf16 v224, v210, s50, v180
    v_dot2_f32_bf16 v225, v210, s51, v180
    v_dot2_f32_bf16 v226, v211, s50, v180
    v_dot2_f32_bf16 v227, v211, s51, v180
    v_dot2_f32_bf16 v228, v212, s50, v180
    v_dot2_f32_bf16 v229, v212, s51, v180
    v_dot2_f32_bf16 v230, v213, s50, v180
    v_dot2_f32_bf16 v231, v213, s51, v180
    v_dot2_f32_bf16 v232, v214, s50, v180
    v_dot2_f32_bf16 v233, v214, s51, v180
    v_dot2_f32_bf16 v234, v215, s50, v180
    v_dot2_f32_bf16 v235, v215, s51, v180
    v_dot2_f32_bf16 v236, v216, s50, v180
    v_dot2_f32_bf16 v237, v216, s51, v180
    v_dot2_f32_bf16 v238, v217, s50, v180
    v_dot2_f32_bf16 v239, v217, s51, v180
    v_dot2_f32_bf16 v240, v218, s50, v180
    v_dot2_f32_bf16 v241, v218, s51, v180
    v_dot2_f32_bf16 v242, v219, s50, v180
    v_dot2_f32_bf16 v243, v219, s51, v180
    s_lshr_b32 s49, s35, 1
    s_mul_i32 s48, s49, 36864
    s_and_b32 s38, s35, 1
    s_lshl_b32 s38, s38, 10
    s_add_u32 s48, s48, s38
    s_mul_i32 s38, s26, 6144
    s_add_u32 s48, s48, s38
    s_mul_i32 s39, s35, 768
    s_lshl_b32 s38, s26, 7
    s_add_u32 s39, s39, s38
    s_add_u32 s39, s39, 2359296
    s_add_u32 s53, s53, 256
    s_mov_b32 s50, 0x3f80
    s_mov_b32 s51, 0x3f800000
    s_waitcnt vmcnt(23) lgkmcnt(12)
    v_mfma_f32_16x16x32_bf16 v[220:223], a[0:3], a[64:67], v[220:223]
    s_waitcnt lgkmcnt(8)
    ds_read_b64_tr_b16 a[28:29], v171 offset:6176
    ds_read_b64_tr_b16 a[30:31], v171 offset:6944
    v_mfma_f32_16x16x32_bf16 v[224:227], a[4:7], a[64:67], v[224:227]
    ds_read_b64_tr_b16 a[32:33], v170 offset:6208
    ds_read_b64_tr_b16 a[34:35], v170 offset:6976
    v_mfma_f32_16x16x32_bf16 v[228:231], a[8:11], a[64:67], v[228:231]
    s_waitcnt lgkmcnt(8)
    ds_read_b64_tr_b16 a[36:37], v171 offset:6240
    ds_read_b64_tr_b16 a[38:39], v171 offset:7008
    v_mfma_f32_16x16x32_bf16 v[232:235], a[12:15], a[64:67], v[232:235]
    ds_read_b64_tr_b16 a[40:41], v170 offset:6272
    ds_read_b64_tr_b16 a[42:43], v170 offset:7040
    v_mfma_f32_16x16x32_bf16 v[236:239], a[16:19], a[64:67], v[236:239]
    s_waitcnt lgkmcnt(8)
    ds_read_b64_tr_b16 a[44:45], v171 offset:6304
    ds_read_b64_tr_b16 a[46:47], v171 offset:7072
    v_mfma_f32_16x16x32_bf16 v[240:243], a[20:23], a[64:67], v[240:243]
    ds_read_b64_tr_b16 a[0:1], v170 offset:12288
    ds_read_b64_tr_b16 a[2:3], v170 offset:13056
    s_waitcnt vmcnt(22)
    v_mfma_f32_16x16x32_bf16 v[220:223], a[24:27], a[68:71], v[220:223]
    s_waitcnt lgkmcnt(8)
    ds_read_b64_tr_b16 a[4:5], v171 offset:12320
    ds_read_b64_tr_b16 a[6:7], v171 offset:13088
    v_mfma_f32_16x16x32_bf16 v[224:227], a[28:31], a[68:71], v[224:227]
    ds_read_b64_tr_b16 a[8:9], v170 offset:12352
    ds_read_b64_tr_b16 a[10:11], v170 offset:13120
    v_mfma_f32_16x16x32_bf16 v[228:231], a[32:35], a[68:71], v[228:231]
    s_waitcnt lgkmcnt(8)
    ds_read_b64_tr_b16 a[12:13], v171 offset:12384
    ds_read_b64_tr_b16 a[14:15], v171 offset:13152
    v_mfma_f32_16x16x32_bf16 v[232:235], a[36:39], a[68:71], v[232:235]
    ds_read_b64_tr_b16 a[16:17], v170 offset:12416
    ds_read_b64_tr_b16 a[18:19], v170 offset:13184
    v_mfma_f32_16x16x32_bf16 v[236:239], a[40:43], a[68:71], v[236:239]
    s_waitcnt lgkmcnt(8)
    ds_read_b64_tr_b16 a[20:21], v171 offset:12448
    ds_read_b64_tr_b16 a[22:23], v171 offset:13216
    v_mfma_f32_16x16x32_bf16 v[240:243], a[44:47], a[68:71], v[240:243]
    ds_read_b64_tr_b16 a[24:25], v170 offset:18432
    ds_read_b64_tr_b16 a[26:27], v170 offset:19200
    s_waitcnt vmcnt(21)
    v_mfma_f32_16x16x32_bf16 v[220:223], a[0:3], a[72:75], v[220:223]
    s_waitcnt lgkmcnt(8)
    ds_read_b64_tr_b16 a[28:29], v171 offset:18464
    ds_read_b64_tr_b16 a[30:31], v171 offset:19232
    v_mfma_f32_16x16x32_bf16 v[224:227], a[4:7], a[72:75], v[224:227]
    ds_read_b64_tr_b16 a[32:33], v170 offset:18496
    ds_read_b64_tr_b16 a[34:35], v170 offset:19264
    v_mfma_f32_16x16x32_bf16 v[228:231], a[8:11], a[72:75], v[228:231]
    s_waitcnt lgkmcnt(8)
    ds_read_b64_tr_b16 a[36:37], v171 offset:18528
    ds_read_b64_tr_b16 a[38:39], v171 offset:19296
    v_mfma_f32_16x16x32_bf16 v[232:235], a[12:15], a[72:75], v[232:235]
    ds_read_b64_tr_b16 a[40:41], v170 offset:18560
    ds_read_b64_tr_b16 a[42:43], v170 offset:19328
    v_mfma_f32_16x16x32_bf16 v[236:239], a[16:19], a[72:75], v[236:239]
    s_waitcnt lgkmcnt(8)
    ds_read_b64_tr_b16 a[44:45], v171 offset:18592
    ds_read_b64_tr_b16 a[46:47], v171 offset:19360
    v_mfma_f32_16x16x32_bf16 v[240:243], a[20:23], a[72:75], v[240:243]
    ds_read_b64_tr_b16 a[0:1], v170 offset:24576
    ds_read_b64_tr_b16 a[2:3], v170 offset:25344
    s_waitcnt vmcnt(20)
    v_mfma_f32_16x16x32_bf16 v[220:223], a[24:27], a[76:79], v[220:223]
    s_waitcnt lgkmcnt(8)
    ds_read_b64_tr_b16 a[4:5], v171 offset:24608
    ds_read_b64_tr_b16 a[6:7], v171 offset:25376
    v_mfma_f32_16x16x32_bf16 v[224:227], a[28:31], a[76:79], v[224:227]
    ds_read_b64_tr_b16 a[8:9], v170 offset:24640
    ds_read_b64_tr_b16 a[10:11], v170 offset:25408
    v_mfma_f32_16x16x32_bf16 v[228:231], a[32:35], a[76:79], v[228:231]
    s_waitcnt lgkmcnt(8)
    ds_read_b64_tr_b16 a[12:13], v171 offset:24672
    ds_read_b64_tr_b16 a[14:15], v171 offset:25440
    v_mfma_f32_16x16x32_bf16 v[232:235], a[36:39], a[76:79], v[232:235]
    ds_read_b64_tr_b16 a[16:17], v170 offset:24704
    ds_read_b64_tr_b16 a[18:19], v170 offset:25472
    v_mfma_f32_16x16x32_bf16 v[236:239], a[40:43], a[76:79], v[236:239]
    s_waitcnt lgkmcnt(8)
    ds_read_b64_tr_b16 a[20:21], v171 offset:24736
    ds_read_b64_tr_b16 a[22:23], v171 offset:25504
    v_mfma_f32_16x16x32_bf16 v[240:243], a[44:47], a[76:79], v[240:243]
    ds_read_b64_tr_b16 a[24:25], v170 offset:30720
    ds_read_b64_tr_b16 a[26:27], v170 offset:31488
    s_waitcnt vmcnt(19)
    v_mfma_f32_16x16x32_bf16 v[220:223], a[0:3], a[80:83], v[220:223]
    s_waitcnt lgkmcnt(8)
    ds_read_b64_tr_b16 a[28:29], v171 offset:30752
    ds_read_b64_tr_b16 a[30:31], v171 offset:31520
    v_mfma_f32_16x16x32_bf16 v[224:227], a[4:7], a[80:83], v[224:227]
    ds_read_b64_tr_b16 a[32:33], v170 offset:30784
    ds_read_b64_tr_b16 a[34:35], v170 offset:31552
    v_mfma_f32_16x16x32_bf16 v[228:231], a[8:11], a[80:83], v[228:231]
    s_waitcnt lgkmcnt(8)
    ds_read_b64_tr_b16 a[36:37], v171 offset:30816
    ds_read_b64_tr_b16 a[38:39], v171 offset:31584
    v_mfma_f32_16x16x32_bf16 v[232:235], a[12:15], a[80:83], v[232:235]
    ds_read_b64_tr_b16 a[40:41], v170 offset:30848
    ds_read_b64_tr_b16 a[42:43], v170 offset:31616
    v_mfma_f32_16x16x32_bf16 v[236:239], a[16:19], a[80:83], v[236:239]
    s_waitcnt lgkmcnt(8)
    ds_read_b64_tr_b16 a[44:45], v171 offset:30880
    ds_read_b64_tr_b16 a[46:47], v171 offset:31648
    v_mfma_f32_16x16x32_bf16 v[240:243], a[20:23], a[80:83], v[240:243]
    ds_read_b64_tr_b16 a[0:1], v170 offset:36864
    ds_read_b64_tr_b16 a[2:3], v170 offset:37632
    s_waitcnt vmcnt(18)
    v_mfma_f32_16x16x32_bf16 v[220:223], a[24:27], a[84:87], v[220:223]
    s_waitcnt lgkmcnt(8)
    ds_read_b64_tr_b16 a[4:5], v171 offset:36896
    ds_read_b64_tr_b16 a[6:7], v171 offset:37664
    v_mfma_f32_16x16x32_bf16 v[224:227], a[28:31], a[84:87], v[224:227]
    ds_read_b64_tr_b16 a[8:9], v170 offset:36928
    ds_read_b64_tr_b16 a[10:11], v170 offset:37696
    v_mfma_f32_16x16x32_bf16 v[228:231], a[32:35], a[84:87], v[228:231]
    s_waitcnt lgkmcnt(8)
    ds_read_b64_tr_b16 a[12:13], v171 offset:36960
    ds_read_b64_tr_b16 a[14:15], v171 offset:37728
    v_mfma_f32_16x16x32_bf16 v[232:235], a[36:39], a[84:87], v[232:235]
    ds_read_b64_tr_b16 a[16:17], v170 offset:36992
    ds_read_b64_tr_b16 a[18:19], v170 offset:37760
    v_mfma_f32_16x16x32_bf16 v[236:239], a[40:43], a[84:87], v[236:239]
    s_waitcnt lgkmcnt(8)
    ds_read_b64_tr_b16 a[20:21], v171 offset:37024
    ds_read_b64_tr_b16 a[22:23], v171 offset:37792
    v_mfma_f32_16x16x32_bf16 v[240:243], a[44:47], a[84:87], v[240:243]
    ds_read_b64_tr_b16 a[24:25], v170 offset:43008
    ds_read_b64_tr_b16 a[26:27], v170 offset:43776
    s_waitcnt vmcnt(17)
    v_mfma_f32_16x16x32_bf16 v[220:223], a[0:3], a[88:91], v[220:223]
    s_waitcnt lgkmcnt(8)
    ds_read_b64_tr_b16 a[28:29], v171 offset:43040
    ds_read_b64_tr_b16 a[30:31], v171 offset:43808
    v_mfma_f32_16x16x32_bf16 v[224:227], a[4:7], a[88:91], v[224:227]
    ds_read_b64_tr_b16 a[32:33], v170 offset:43072
    ds_read_b64_tr_b16 a[34:35], v170 offset:43840
    v_mfma_f32_16x16x32_bf16 v[228:231], a[8:11], a[88:91], v[228:231]
    s_waitcnt lgkmcnt(8)
    ds_read_b64_tr_b16 a[36:37], v171 offset:43104
    ds_read_b64_tr_b16 a[38:39], v171 offset:43872
    v_mfma_f32_16x16x32_bf16 v[232:235], a[12:15], a[88:91], v[232:235]
    ds_read_b64_tr_b16 a[40:41], v170 offset:43136
    ds_read_b64_tr_b16 a[42:43], v170 offset:43904
    v_mfma_f32_16x16x32_bf16 v[236:239], a[16:19], a[88:91], v[236:239]
    s_waitcnt lgkmcnt(8)
    ds_read_b64_tr_b16 a[44:45], v171 offset:43168
    ds_read_b64_tr_b16 a[46:47], v171 offset:43936
    v_mfma_f32_16x16x32_bf16 v[240:243], a[20:23], a[88:91], v[240:243]
    ds_read_b64_tr_b16 a[0:1], v170 offset:49152
    ds_read_b64_tr_b16 a[2:3], v170 offset:49920
    s_waitcnt vmcnt(16)
    v_mfma_f32_16x16x32_bf16 v[220:223], a[24:27], a[92:95], v[220:223]
    s_waitcnt lgkmcnt(8)
    ds_read_b64_tr_b16 a[4:5], v171 offset:49184
    ds_read_b64_tr_b16 a[6:7], v171 offset:49952
    v_mfma_f32_16x16x32_bf16 v[224:227], a[28:31], a[92:95], v[224:227]
    ds_read_b64_tr_b16 a[8:9], v170 offset:49216
    ds_read_b64_tr_b16 a[10:11], v170 offset:49984
    v_mfma_f32_16x16x32_bf16 v[228:231], a[32:35], a[92:95], v[228:231]
    s_waitcnt lgkmcnt(8)
    ds_read_b64_tr_b16 a[12:13], v171 offset:49248
    ds_read_b64_tr_b16 a[14:15], v171 offset:50016
    v_mfma_f32_16x16x32_bf16 v[232:235], a[36:39], a[92:95], v[232:235]
    ds_read_b64_tr_b16 a[16:17], v170 offset:49280
    ds_read_b64_tr_b16 a[18:19], v170 offset:50048
    v_mfma_f32_16x16x32_bf16 v[236:239], a[40:43], a[92:95], v[236:239]
    s_waitcnt lgkmcnt(8)
    ds_read_b64_tr_b16 a[20:21], v171 offset:49312
    ds_read_b64_tr_b16 a[22:23], v171 offset:50080
    v_mfma_f32_16x16x32_bf16 v[240:243], a[44:47], a[92:95], v[240:243]
    ds_read_b64_tr_b16 a[24:25], v172 offset:0
    ds_read_b64_tr_b16 a[26:27], v172 offset:768
    s_waitcnt vmcnt(15)
    v_mfma_f32_16x16x32_bf16 v[220:223], a[0:3], a[96:99], v[220:223]
    s_waitcnt lgkmcnt(8)
    ds_read_b64_tr_b16 a[28:29], v173 offset:32
    ds_read_b64_tr_b16 a[30:31], v173 offset:800
    v_mfma_f32_16x16x32_bf16 v[224:227], a[4:7], a[96:99], v[224:227]
    ds_read_b64_tr_b16 a[32:33], v172 offset:64
    ds_read_b64_tr_b16 a[34:35], v172 offset:832
    v_mfma_f32_16x16x32_bf16 v[228:231], a[8:11], a[96:99], v[228:231]
    s_waitcnt lgkmcnt(8)
    ds_read_b64_tr_b16 a[36:37], v173 offset:96
    ds_read_b64_tr_b16 a[38:39], v173 offset:864
    v_mfma_f32_16x16x32_bf16 v[232:235], a[12:15], a[96:99], v[232:235]
    ds_read_b64_tr_b16 a[40:41], v172 offset:128
    ds_read_b64_tr_b16 a[42:43], v172 offset:896
    v_mfma_f32_16x16x32_bf16 v[236:239], a[16:19], a[96:99], v[236:239]
    s_waitcnt lgkmcnt(8)
    ds_read_b64_tr_b16 a[44:45], v173 offset:160
    ds_read_b64_tr_b16 a[46:47], v173 offset:928
    v_mfma_f32_16x16x32_bf16 v[240:243], a[20:23], a[96:99], v[240:243]
    ds_read_b64_tr_b16 a[0:1], v172 offset:6144
    ds_read_b64_tr_b16 a[2:3], v172 offset:6912
    s_waitcnt vmcnt(14)
    v_mfma_f32_16x16x32_bf16 v[220:223], a[24:27], a[100:103], v[220:223]
    s_waitcnt lgkmcnt(8)
    ds_read_b64_tr_b16 a[4:5], v173 offset:6176
    ds_read_b64_tr_b16 a[6:7], v173 offset:6944
    v_mfma_f32_16x16x32_bf16 v[224:227], a[28:31], a[100:103], v[224:227]
    ds_read_b64_tr_b16 a[8:9], v172 offset:6208
    ds_read_b64_tr_b16 a[10:11], v172 offset:6976
    v_mfma_f32_16x16x32_bf16 v[228:231], a[32:35], a[100:103], v[228:231]
    s_waitcnt lgkmcnt(8)
    ds_read_b64_tr_b16 a[12:13], v173 offset:6240
    ds_read_b64_tr_b16 a[14:15], v173 offset:7008
    v_mfma_f32_16x16x32_bf16 v[232:235], a[36:39], a[100:103], v[232:235]
    ds_read_b64_tr_b16 a[16:17], v172 offset:6272
    ds_read_b64_tr_b16 a[18:19], v172 offset:7040
    v_mfma_f32_16x16x32_bf16 v[236:239], a[40:43], a[100:103], v[236:239]
    s_waitcnt lgkmcnt(8)
    ds_read_b64_tr_b16 a[20:21], v173 offset:6304
    ds_read_b64_tr_b16 a[22:23], v173 offset:7072
    v_mfma_f32_16x16x32_bf16 v[240:243], a[44:47], a[100:103], v[240:243]
    ds_read_b64_tr_b16 a[24:25], v172 offset:12288
    ds_read_b64_tr_b16 a[26:27], v172 offset:13056
    s_waitcnt vmcnt(13)
    v_mfma_f32_16x16x32_bf16 v[220:223], a[0:3], a[104:107], v[220:223]
    s_waitcnt lgkmcnt(8)
    ds_read_b64_tr_b16 a[28:29], v173 offset:12320
    ds_read_b64_tr_b16 a[30:31], v173 offset:13088
    v_mfma_f32_16x16x32_bf16 v[224:227], a[4:7], a[104:107], v[224:227]
    ds_read_b64_tr_b16 a[32:33], v172 offset:12352
    ds_read_b64_tr_b16 a[34:35], v172 offset:13120
    v_mfma_f32_16x16x32_bf16 v[228:231], a[8:11], a[104:107], v[228:231]
    s_waitcnt lgkmcnt(8)
    ds_read_b64_tr_b16 a[36:37], v173 offset:12384
    ds_read_b64_tr_b16 a[38:39], v173 offset:13152
    v_mfma_f32_16x16x32_bf16 v[232:235], a[12:15], a[104:107], v[232:235]
    ds_read_b64_tr_b16 a[40:41], v172 offset:12416
    ds_read_b64_tr_b16 a[42:43], v172 offset:13184
    v_mfma_f32_16x16x32_bf16 v[236:239], a[16:19], a[104:107], v[236:239]
    s_waitcnt lgkmcnt(8)
    ds_read_b64_tr_b16 a[44:45], v173 offset:12448
    ds_read_b64_tr_b16 a[46:47], v173 offset:13216
    v_mfma_f32_16x16x32_bf16 v[240:243], a[20:23], a[104:107], v[240:243]
    ds_read_b64_tr_b16 a[0:1], v172 offset:18432
    ds_read_b64_tr_b16 a[2:3], v172 offset:19200
    s_waitcnt vmcnt(12)
    v_mfma_f32_16x16x32_bf16 v[220:223], a[24:27], a[108:111], v[220:223]
    s_waitcnt lgkmcnt(8)
    ds_read_b64_tr_b16 a[4:5], v173 offset:18464
    ds_read_b64_tr_b16 a[6:7], v173 offset:19232
    v_mfma_f32_16x16x32_bf16 v[224:227], a[28:31], a[108:111], v[224:227]
    ds_read_b64_tr_b16 a[8:9], v172 offset:18496
    ds_read_b64_tr_b16 a[10:11], v172 offset:19264
    v_mfma_f32_16x16x32_bf16 v[228:231], a[32:35], a[108:111], v[228:231]
    s_waitcnt lgkmcnt(8)
    ds_read_b64_tr_b16 a[12:13], v173 offset:18528
    ds_read_b64_tr_b16 a[14:15], v173 offset:19296
    v_mfma_f32_16x16x32_bf16 v[232:235], a[36:39], a[108:111], v[232:235]
    ds_read_b64_tr_b16 a[16:17], v172 offset:18560
    ds_read_b64_tr_b16 a[18:19], v172 offset:19328
    v_mfma_f32_16x16x32_bf16 v[236:239], a[40:43], a[108:111], v[236:239]
    s_waitcnt lgkmcnt(8)
    ds_read_b64_tr_b16 a[20:21], v173 offset:18592
    ds_read_b64_tr_b16 a[22:23], v173 offset:19360
    v_mfma_f32_16x16x32_bf16 v[240:243], a[44:47], a[108:111], v[240:243]
    ds_read_b64_tr_b16 a[24:25], v172 offset:24576
    ds_read_b64_tr_b16 a[26:27], v172 offset:25344
    s_waitcnt vmcnt(11)
    v_mfma_f32_16x16x32_bf16 v[220:223], a[0:3], a[112:115], v[220:223]
    s_waitcnt lgkmcnt(8)
    ds_read_b64_tr_b16 a[28:29], v173 offset:24608
    ds_read_b64_tr_b16 a[30:31], v173 offset:25376
    v_mfma_f32_16x16x32_bf16 v[224:227], a[4:7], a[112:115], v[224:227]
    ds_read_b64_tr_b16 a[32:33], v172 offset:24640
    ds_read_b64_tr_b16 a[34:35], v172 offset:25408
    v_mfma_f32_16x16x32_bf16 v[228:231], a[8:11], a[112:115], v[228:231]
    s_waitcnt lgkmcnt(8)
    ds_read_b64_tr_b16 a[36:37], v173 offset:24672
    ds_read_b64_tr_b16 a[38:39], v173 offset:25440
    v_mfma_f32_16x16x32_bf16 v[232:235], a[12:15], a[112:115], v[232:235]
    ds_read_b64_tr_b16 a[40:41], v172 offset:24704
    ds_read_b64_tr_b16 a[42:43], v172 offset:25472
    v_mfma_f32_16x16x32_bf16 v[236:239], a[16:19], a[112:115], v[236:239]
    s_waitcnt lgkmcnt(8)
    ds_read_b64_tr_b16 a[44:45], v173 offset:24736
    ds_read_b64_tr_b16 a[46:47], v173 offset:25504
    v_mfma_f32_16x16x32_bf16 v[240:243], a[20:23], a[112:115], v[240:243]
    ds_read_b64_tr_b16 a[0:1], v172 offset:30720
    ds_read_b64_tr_b16 a[2:3], v172 offset:31488
    s_waitcnt vmcnt(10)
    v_mfma_f32_16x16x32_bf16 v[220:223], a[24:27], a[116:119], v[220:223]
    s_waitcnt lgkmcnt(8)
    ds_read_b64_tr_b16 a[4:5], v173 offset:30752
    ds_read_b64_tr_b16 a[6:7], v173 offset:31520
    v_mfma_f32_16x16x32_bf16 v[224:227], a[28:31], a[116:119], v[224:227]
    ds_read_b64_tr_b16 a[8:9], v172 offset:30784
    ds_read_b64_tr_b16 a[10:11], v172 offset:31552
    v_mfma_f32_16x16x32_bf16 v[228:231], a[32:35], a[116:119], v[228:231]
    s_waitcnt lgkmcnt(8)
    ds_read_b64_tr_b16 a[12:13], v173 offset:30816
    ds_read_b64_tr_b16 a[14:15], v173 offset:31584
    v_mfma_f32_16x16x32_bf16 v[232:235], a[36:39], a[116:119], v[232:235]
    ds_read_b64_tr_b16 a[16:17], v172 offset:30848
    ds_read_b64_tr_b16 a[18:19], v172 offset:31616
    v_mfma_f32_16x16x32_bf16 v[236:239], a[40:43], a[116:119], v[236:239]
    s_waitcnt lgkmcnt(8)
    ds_read_b64_tr_b16 a[20:21], v173 offset:30880
    ds_read_b64_tr_b16 a[22:23], v173 offset:31648
    v_mfma_f32_16x16x32_bf16 v[240:243], a[44:47], a[116:119], v[240:243]
    ds_read_b64_tr_b16 a[24:25], v172 offset:36864
    ds_read_b64_tr_b16 a[26:27], v172 offset:37632
    s_waitcnt vmcnt(9)
    v_mfma_f32_16x16x32_bf16 v[220:223], a[0:3], a[120:123], v[220:223]
    s_waitcnt lgkmcnt(8)
    ds_read_b64_tr_b16 a[28:29], v173 offset:36896
    ds_read_b64_tr_b16 a[30:31], v173 offset:37664
    v_mfma_f32_16x16x32_bf16 v[224:227], a[4:7], a[120:123], v[224:227]
    ds_read_b64_tr_b16 a[32:33], v172 offset:36928
    ds_read_b64_tr_b16 a[34:35], v172 offset:37696
    v_mfma_f32_16x16x32_bf16 v[228:231], a[8:11], a[120:123], v[228:231]
    s_waitcnt lgkmcnt(8)
    ds_read_b64_tr_b16 a[36:37], v173 offset:36960
    ds_read_b64_tr_b16 a[38:39], v173 offset:37728
    v_mfma_f32_16x16x32_bf16 v[232:235], a[12:15], a[120:123], v[232:235]
    ds_read_b64_tr_b16 a[40:41], v172 offset:36992
    ds_read_b64_tr_b16 a[42:43], v172 offset:37760
    v_mfma_f32_16x16x32_bf16 v[236:239], a[16:19], a[120:123], v[236:239]
    s_waitcnt lgkmcnt(8)
    ds_read_b64_tr_b16 a[44:45], v173 offset:37024
    ds_read_b64_tr_b16 a[46:47], v173 offset:37792
    v_mfma_f32_16x16x32_bf16 v[240:243], a[20:23], a[120:123], v[240:243]
    ds_read_b64_tr_b16 a[0:1], v172 offset:43008
    ds_read_b64_tr_b16 a[2:3], v172 offset:43776
    s_waitcnt vmcnt(8)
    v_mfma_f32_16x16x32_bf16 v[220:223], a[24:27], a[124:127], v[220:223]
    s_waitcnt lgkmcnt(8)
    ds_read_b64_tr_b16 a[4:5], v173 offset:43040
    ds_read_b64_tr_b16 a[6:7], v173 offset:43808
    v_mfma_f32_16x16x32_bf16 v[224:227], a[28:31], a[124:127], v[224:227]
    ds_read_b64_tr_b16 a[8:9], v172 offset:43072
    ds_read_b64_tr_b16 a[10:11], v172 offset:43840
    v_mfma_f32_16x16x32_bf16 v[228:231], a[32:35], a[124:127], v[228:231]
    s_waitcnt lgkmcnt(8)
    ds_read_b64_tr_b16 a[12:13], v173 offset:43104
    ds_read_b64_tr_b16 a[14:15], v173 offset:43872
    v_mfma_f32_16x16x32_bf16 v[232:235], a[36:39], a[124:127], v[232:235]
    ds_read_b64_tr_b16 a[16:17], v172 offset:43136
    ds_read_b64_tr_b16 a[18:19], v172 offset:43904
    v_mfma_f32_16x16x32_bf16 v[236:239], a[40:43], a[124:127], v[236:239]
    s_waitcnt lgkmcnt(8)
    ds_read_b64_tr_b16 a[20:21], v173 offset:43168
    ds_read_b64_tr_b16 a[22:23], v173 offset:43936
    v_mfma_f32_16x16x32_bf16 v[240:243], a[44:47], a[124:127], v[240:243]
    ds_read_b64_tr_b16 a[24:25], v172 offset:49152
    ds_read_b64_tr_b16 a[26:27], v172 offset:49920
    s_waitcnt vmcnt(4)
    v_mfma_f32_16x16x32_bf16 v[220:223], a[0:3], a[128:131], v[220:223]
    s_waitcnt lgkmcnt(8)
    ds_read_b64_tr_b16 a[28:29], v173 offset:49184
    ds_read_b64_tr_b16 a[30:31], v173 offset:49952
    v_mfma_f32_16x16x32_bf16 v[224:227], a[4:7], a[128:131], v[224:227]
    ds_read_b64_tr_b16 a[32:33], v172 offset:49216
    ds_read_b64_tr_b16 a[34:35], v172 offset:49984
    v_mfma_f32_16x16x32_bf16 v[228:231], a[8:11], a[128:131], v[228:231]
    s_waitcnt lgkmcnt(8)
    ds_read_b64_tr_b16 a[36:37], v173 offset:49248
    ds_read_b64_tr_b16 a[38:39], v173 offset:50016
    v_mfma_f32_16x16x32_bf16 v[232:235], a[12:15], a[128:131], v[232:235]
    ds_read_b64_tr_b16 a[40:41], v172 offset:49280
    ds_read_b64_tr_b16 a[42:43], v172 offset:50048
    v_mfma_f32_16x16x32_bf16 v[236:239], a[16:19], a[128:131], v[236:239]
    s_waitcnt lgkmcnt(8)
    ds_read_b64_tr_b16 a[44:45], v173 offset:49312
    ds_read_b64_tr_b16 a[46:47], v173 offset:50080
    v_mfma_f32_16x16x32_bf16 v[240:243], a[20:23], a[128:131], v[240:243]
    s_waitcnt vmcnt(0)
    v_mfma_f32_16x16x32_bf16 v[220:223], a[24:27], a[132:135], v[220:223]
    s_waitcnt lgkmcnt(6)
    v_mfma_f32_16x16x32_bf16 v[224:227], a[28:31], a[132:135], v[224:227]
    v_mfma_f32_16x16x32_bf16 v[228:231], a[32:35], a[132:135], v[228:231]
    s_waitcnt lgkmcnt(2)
    v_mfma_f32_16x16x32_bf16 v[232:235], a[36:39], a[132:135], v[232:235]
    v_mfma_f32_16x16x32_bf16 v[236:239], a[40:43], a[132:135], v[236:239]
    s_waitcnt lgkmcnt(0)
    v_mfma_f32_16x16x32_bf16 v[240:243], a[44:47], a[132:135], v[240:243]
    v_cvt_pk_bf16_f32 v244, v220, v221
    v_cvt_pk_bf16_f32 v245, v222, v223
    v_cvt_pk_bf16_f32 v246, v224, v225
    v_cvt_pk_bf16_f32 v247, v226, v227
    buffer_store_dwordx4 v[244:247], v15, s[20:23], s48 offen offset:0 sc1
    v_cvt_pk_bf16_f32 v248, v228, v229
    v_cvt_pk_bf16_f32 v249, v230, v231
    v_cvt_pk_bf16_f32 v250, v232, v233
    v_cvt_pk_bf16_f32 v251, v234, v235
    buffer_store_dwordx4 v[248:251], v15, s[20:23], s48 offen offset:2048 sc1
    v_cvt_pk_bf16_f32 v252, v236, v237
    v_cvt_pk_bf16_f32 v253, v238, v239
    v_cvt_pk_bf16_f32 v254, v240, v241
    v_cvt_pk_bf16_f32 v255, v242, v243
    s_add_u32 s48, s48, 4096
    buffer_store_dwordx4 v[252:255], v15, s[20:23], s48 offen offset:0 sc1
    s_mov_b32 s50, 0x3f803f80
    v_dot2_f32_bf16 v221, v244, v244, 0
    v_dot2_f32_bf16 v223, v245, v245, 0
    v_dot2_f32_bf16 v221, v246, v246, v221
    v_dot2_f32_bf16 v223, v247, v247, v223
    v_dot2_f32_bf16 v221, v248, v248, v221
    v_dot2_f32_bf16 v223, v249, v249, v223
    v_dot2_f32_bf16 v221, v250, v250, v221
    v_dot2_f32_bf16 v223, v251, v251, v223
    v_dot2_f32_bf16 v221, v252, v252, v221
    v_dot2_f32_bf16 v223, v253, v253, v223
    v_dot2_f32_bf16 v221, v254, v254, v221
    v_dot2_f32_bf16 v223, v255, v255, v223
    v_mul_f32 v220, 0.5, v178
    v_mul_f32 v220, 0.5, v220
    v_mov_b32 v222, 0
    v_add_f32 v220, v220, v222
    v_add_f32 v221, v221, v223
    s_nop 1
    v_permlane16_swap_b32 v220, v221
    v_add_f32 v220, v220, v221
    v_mov_b32 v221, v220
    s_nop 1
    v_permlane32_swap_b32 v220, v221
    v_add_f32 v220, v220, v221
    s_mov_b32 exec_hi, 0
    buffer_store_dword v220, v169, s[20:23], s39 offen sc1
    s_mov_b64 exec, -1
    s_waitcnt vmcnt(0)
    s_barrier
    s_cmp_lg_u32 s30, 0
    s_cbranch_scc1 Ksig_19
    s_mov_b32 s98, 1
    s_atomic_add s98, s[20:21], s53
Ksig_19:
    s_add_u32 m0, s37, 0
    s_nop 0
    buffer_load_dwordx4 v0, s[12:15], s36 offen offset:0 lds
    buffer_load_dwordx4 v1, s[12:15], s36 offen offset:1024 lds
    buffer_load_dwordx4 v2, s[12:15], s36 offen offset:2048 lds
    buffer_load_dwordx4 v3, s[12:15], s36 offen offset:3072 lds
    s_add_u32 m0, s37, 4096
    s_nop 0
    buffer_load_dwordx4 v4, s[12:15], s36 offen offset:0 lds
    buffer_load_dwordx4 v5, s[12:15], s36 offen offset:1024 lds
    buffer_load_dwordx4 v6, s[12:15], s36 offen offset:2048 lds
    buffer_load_dwordx4 v7, s[12:15], s36 offen offset:3072 lds
    s_add_u32 m0, s37, 8192
    s_nop 0
    buffer_load_dwordx4 v8, s[12:15], s36 offen offset:0 lds
    s_add_u32 s36, s36, 294912
    s_add_u32 m0, s37, 36864
    s_nop 0
    buffer_load_dwordx4 v0, s[12:15], s36 offen offset:0 lds
    buffer_load_dwordx4 v1, s[12:15], s36 offen offset:1024 lds
    buffer_load_dwordx4 v2, s[12:15], s36 offen offset:2048 lds
    buffer_load_dwordx4 v3, s[12:15], s36 offen offset:3072 lds
    s_add_u32 m0, s37, 40960
    s_nop 0
    buffer_load_dwordx4 v4, s[12:15], s36 offen offset:0 lds
    buffer_load_dwordx4 v5, s[12:15], s36 offen offset:1024 lds
    buffer_load_dwordx4 v6, s[12:15], s36 offen offset:2048 lds
    buffer_load_dwordx4 v7, s[12:15], s36 offen offset:3072 lds
    s_add_u32 m0, s37, 45056
    s_nop 0
    buffer_load_dwordx4 v8, s[12:15], s36 offen offset:0 lds
    s_add_u32 s36, s36, 294912
    s_branch K_ffn
K_idle:
    v_lshlrev_b32 v40, 6, v30
    v_lshrrev_b32 v40, 6, v40
    s_lshl_b32 s48, s30, 6
    v_add_u32 v40, s48, v30
    s_sub_u32 s49, s28, 24
    s_mul_i32 s48, s49, 221184
    s_mul_i32 s38, s29, 1152
    s_add_u32 s48, s48, s38
    s_add_u32 s48, s48, 589824
    v_add_u32 v41, 0, v40
    v_mul_u32_u24 v42, 7282, v41
    v_lshrrev_b32 v42, 16, v42
    v_mul_u32_u24 v43, 9, v42
    v_sub_u32 v43, v41, v43
    v_mul_u32_u24 v42, 9216, v42
    v_lshl_add_u32 v42, v43, 7, v42
    v_mov_b32 v43, 2147483392
    v_cmp_gt_u32 vcc, 216, v41
    s_nop 1
    v_cndmask_b32 v42, v43, v42, vcc
    s_mov_b32 s92, s4
    s_mov_b32 s93, s5
    s_mov_b32 s94, 5308416
    s_mov_b32 s95, 0x20000
    buffer_load_dword a2, v42, s[92:95], s48 offen
    s_mov_b32 s92, s6
    s_mov_b32 s93, s7
    s_mov_b32 s94, 5308416
    s_mov_b32 s95, 0x20000
    buffer_load_dword a3, v42, s[92:95], s48 offen
    s_waitcnt vmcnt(2)
    s_add_u32 m0, s37, 0
    s_nop 0
    buffer_load_dwordx4 v0, s[12:15], s36 offen offset:0 lds
    buffer_load_dwordx4 v1, s[12:15], s36 offen offset:1024 lds
    buffer_load_dwordx4 v2, s[12:15], s36 offen offset:2048 lds
    buffer_load_dwordx4 v3, s[12:15], s36 offen offset:3072 lds
    s_add_u32 m0, s37, 4096
    s_nop 0
    buffer_load_dwordx4 v4, s[12:15], s36 offen offset:0 lds
    buffer_load_dwordx4 v5, s[12:15], s36 offen offset:1024 lds
    buffer_load_dwordx4 v6, s[12:15], s36 offen offset:2048 lds
    buffer_load_dwordx4 v7, s[12:15], s36 offen offset:3072 lds
    s_add_u32 m0, s37, 8192
    s_nop 0
    buffer_load_dwordx4 v8, s[12:15], s36 offen offset:0 lds
    s_add_u32 s36, s36, 294912
    s_add_u32 m0, s37, 36864
    s_nop 0
    buffer_load_dwordx4 v0, s[12:15], s36 offen offset:0 lds
    buffer_load_dwordx4 v1, s[12:15], s36 offen offset:1024 lds
    buffer_load_dwordx4 v2, s[12:15], s36 offen offset:2048 lds
    buffer_load_dwordx4 v3, s[12:15], s36 offen offset:3072 lds
    s_add_u32 m0, s37, 40960
    s_nop 0
    buffer_load_dwordx4 v4, s[12:15], s36 offen offset:0 lds
    buffer_load_dwordx4 v5, s[12:15], s36 offen offset:1024 lds
    buffer_load_dwordx4 v6, s[12:15], s36 offen offset:2048 lds
    buffer_load_dwordx4 v7, s[12:15], s36 offen offset:3072 lds
    s_add_u32 m0, s37, 45056
    s_nop 0
    buffer_load_dwordx4 v8, s[12:15], s36 offen offset:0 lds
    s_add_u32 s36, s36, 294912
    s_waitcnt lgkmcnt(0)
K_ffn:
    s_lshl_b32 s53, s32, 13
    s_add_u32 s53, s53, 46145792
    s_cmp_lg_u32 s30, 0
    s_cbranch_scc1 Kps_20
    s_mov_b32 s96, 0
    s_atomic_add s96, s[20:21], s53 glc
Kps_20:
    v_mov_b32 v64, 0
    v_mov_b32 v65, 0
    v_mov_b32 v66, 0
    v_mov_b32 v67, 0
    v_mov_b32 v68, 0
    v_mov_b32 v69, 0
    v_mov_b32 v70, 0
    v_mov_b32 v71, 0
    v_mov_b32 v72, 0
    v_mov_b32 v73, 0
    v_mov_b32 v74, 0
    v_mov_b32 v75, 0
    v_mov_b32 v76, 0
    v_mov_b32 v77, 0
    v_mov_b32 v78, 0
    v_mov_b32 v79, 0
    v_mov_b32 v80, 0
    v_mov_b32 v81, 0
    v_mov_b32 v82, 0
    v_mov_b32 v83, 0
    v_mov_b32 v84, 0
    v_mov_b32 v85, 0
    v_mov_b32 v86, 0
    v_mov_b32 v87, 0
    v_mov_b32 v88, 0
    v_mov_b32 v89, 0
    v_mov_b32 v90, 0
    v_mov_b32 v91, 0
    v_mov_b32 v92, 0
    v_mov_b32 v93, 0
    v_mov_b32 v94, 0
    v_mov_b32 v95, 0
    v_mov_b32 v96, 0
    v_mov_b32 v97, 0
    v_mov_b32 v98, 0
    v_mov_b32 v99, 0
    v_mov_b32 v100, 0
    v_mov_b32 v101, 0
    v_mov_b32 v102, 0
    v_mov_b32 v103, 0
    v_mov_b32 v104, 0
    v_mov_b32 v105, 0
    v_mov_b32 v106, 0
    v_mov_b32 v107, 0
    v_mov_b32 v108, 0
    v_mov_b32 v109, 0
    v_mov_b32 v110, 0
    v_mov_b32 v111, 0
    v_mov_b32 v112, 0
    v_mov_b32 v32, 0
    v_mov_b32 v113, 0
    v_mov_b32 v33, 0
    v_mov_b32 v114, 0
    v_mov_b32 v34, 0
    v_mov_b32 v115, 0
    v_mov_b32 v35, 0
    v_mov_b32 v116, 0
    v_mov_b32 v36, 0
    v_mov_b32 v117, 0
    v_mov_b32 v37, 0
    v_mov_b32 v118, 0
    v_mov_b32 v38, 0
    v_mov_b32 v119, 0
    v_mov_b32 v39, 0
    v_mov_b32 v120, 0
    v_mov_b32 v40, 0
    v_mov_b32 v121, 0
    v_mov_b32 v41, 0
    v_mov_b32 v122, 0
    v_mov_b32 v42, 0
    v_mov_b32 v123, 0
    v_mov_b32 v43, 0
    v_mov_b32 v124, 0
    v_mov_b32 v44, 0
    v_mov_b32 v125, 0
    v_mov_b32 v45, 0
    v_mov_b32 v126, 0
    v_mov_b32 v46, 0
    v_mov_b32 v127, 0
    v_mov_b32 v47, 0
    v_mov_b32 v128, 0
    v_mov_b32 v48, 0
    v_mov_b32 v129, 0
    v_mov_b32 v49, 0
    v_mov_b32 v130, 0
    v_mov_b32 v50, 0
    v_mov_b32 v131, 0
    v_mov_b32 v51, 0
    v_mov_b32 v132, 0
    v_mov_b32 v52, 0
    v_mov_b32 v133, 0
    v_mov_b32 v53, 0
    v_mov_b32 v134, 0
    v_mov_b32 v54, 0
    v_mov_b32 v135, 0
    v_mov_b32 v55, 0
    v_mov_b32 v136, 0
    v_mov_b32 v56, 0
    v_mov_b32 v137, 0
    v_mov_b32 v57, 0
    v_mov_b32 v138, 0
    v_mov_b32 v58, 0
    v_mov_b32 v139, 0
    v_mov_b32 v59, 0
    v_mov_b32 v140, 0
    v_mov_b32 v60, 0
    v_mov_b32 v141, 0
    v_mov_b32 v61, 0
    v_mov_b32 v142, 0
    v_mov_b32 v62, 0
    v_mov_b32 v143, 0
    v_mov_b32 v63, 0
    v_mov_b32 v144, 0
    v_mov_b32 v145, 0
    v_mov_b32 v146, 0
    v_mov_b32 v147, 0
    v_mov_b32 v148, 0
    v_mov_b32 v149, 0
    v_mov_b32 v150, 0
    v_mov_b32 v151, 0
    v_mov_b32 v152, 0
    v_mov_b32 v153, 0
    v_mov_b32 v154, 0
    v_mov_b32 v155, 0
    v_mov_b32 v156, 0
    v_mov_b32 v157, 0
    v_mov_b32 v158, 0
    v_mov_b32 v159, 0
    v_mov_b32 v160, 0
    v_mov_b32 v161, 0
    v_mov_b32 v162, 0
    v_mov_b32 v163, 0
    v_mov_b32 v164, 0
    v_mov_b32 v165, 0
    v_mov_b32 v166, 0
    v_mov_b32 v167, 0
    v_accvgpr_write_b32 a136, 0
    v_accvgpr_write_b32 a137, 0
    v_accvgpr_write_b32 a138, 0
    v_accvgpr_write_b32 a139, 0
    v_accvgpr_write_b32 a140, 0
    v_accvgpr_write_b32 a141, 0
    v_accvgpr_write_b32 a142, 0
    v_accvgpr_write_b32 a143, 0
    v_accvgpr_write_b32 a144, 0
    v_accvgpr_write_b32 a145, 0
    v_accvgpr_write_b32 a146, 0
    v_accvgpr_write_b32 a147, 0
    v_accvgpr_write_b32 a148, 0
    v_accvgpr_write_b32 a149, 0
    v_accvgpr_write_b32 a150, 0
    v_accvgpr_write_b32 a151, 0
    v_accvgpr_write_b32 a152, 0
    v_accvgpr_write_b32 a153, 0
    v_accvgpr_write_b32 a154, 0
    v_accvgpr_write_b32 a155, 0
    v_accvgpr_write_b32 a156, 0
    v_accvgpr_write_b32 a157, 0
    v_accvgpr_write_b32 a158, 0
    v_accvgpr_write_b32 a159, 0
    v_mov_b32 v31, v24
    v_mov_b32 v14, v25
    s_lshl_b32 s50, s28, 1
    s_add_u32 s50, s50, s33
    s_mul_i32 s50, s50, 18432
    s_mul_i32 s51, s29, 1152
    s_add_u32 s50, s50, s51
    s_add_u32 s50, s50, 2362368
    s_lshl_b32 s51, s28, 2
    s_add_u32 s51, s51, s30
    s_mul_i32 s51, s51, 1408
    s_mul_i32 s52, s29, 663552
    s_add_u32 s51, s51, s52
    s_lshl_b32 s35, s32, 2
    s_add_u32 s35, s35, s30
    s_mul_i32 s43, s35, 1536
    s_mul_i32 s35, s35, 36864
    s_add_u32 s43, s43, 2359296
    s_mul_i32 s38, s31, 331776
    s_mul_i32 s39, s30, 9216
    s_add_u32 s38, s38, s39
    s_add_u32 s101, s38, 512
    s_and_b32 s39, s31, 1
    s_mul_i32 s100, s39, 640
    s_add_u32 s38, s38, s100
    s_mul_i32 s39, s39, 663552
    s_add_u32 s100, s38, 331776
    s_sub_u32 s100, s100, s39
    s_lshl_b32 s40, s30, 10
    s_mov_b32 s47, 0xffff0000
    s_lshl_b32 s53, s32, 13
    s_add_u32 s53, s53, 46145792
    v_mov_b32 v29, v26
    s_cmp_lg_u32 s30, 0
    s_cbranch_scc1 Kpf_21
    s_mov_b32 s97, 0
Kpfl_22:
    s_waitcnt lgkmcnt(0)
    s_cmp_ge_u32 s96, 12
    s_cbranch_scc1 Kpf_21
    s_mov_b32 s96, 0
    s_atomic_add s96, s[20:21], s53 glc
    s_add_u32 s97, s97, 1
    s_cmp_lt_u32 s97, 0x100000
    s_cbranch_scc1 Kpfl_22
    s_waitcnt lgkmcnt(0)
Kpf_21:
    s_barrier
    buffer_load_dwordx4 a[0:3], v15, s[20:23], s35 offen offset:0 sc1
    buffer_load_dwordx4 a[4:7], v15, s[20:23], s35 offen offset:1024 sc1
    s_add_u32 s35, s35, 2048
    buffer_load_dwordx4 a[8:11], v15, s[20:23], s35 offen offset:0 sc1
    buffer_load_dwordx4 a[12:15], v15, s[20:23], s35 offen offset:1024 sc1
    s_add_u32 s35, s35, 2048
    v_mov_b32 v208, 0
    v_mov_b32 v209, 0
    v_mov_b32 v210, 0
    v_mov_b32 v211, 0
    v_mov_b32 v212, 0
    v_mov_b32 v213, 0
    v_mov_b32 v214, 0
    v_mov_b32 v215, 0
    v_mov_b32 v216, 0
    v_mov_b32 v217, 0
    v_mov_b32 v218, 0
    v_mov_b32 v219, 0
    v_mov_b32 v220, 0
    v_mov_b32 v221, 0
    v_mov_b32 v222, 0
    v_mov_b32 v223, 0
    v_mov_b32 v224, 0
    v_mov_b32 v225, 0
    v_mov_b32 v226, 0
    v_mov_b32 v227, 0
    v_mov_b32 v228, 0
    v_mov_b32 v229, 0
    v_mov_b32 v230, 0
    v_mov_b32 v231, 0
    v_mov_b32 v232, 0
    v_mov_b32 v233, 0
    v_mov_b32 v234, 0
    v_mov_b32 v235, 0
    v_mov_b32 v236, 0
    v_mov_b32 v237, 0
    v_mov_b32 v238, 0
    v_mov_b32 v239, 0
    v_mov_b32 v240, 0
    v_mov_b32 v241, 0
    v_mov_b32 v242, 0
    v_mov_b32 v243, 0
    v_mov_b32 v244, 0
    v_mov_b32 v245, 0
    v_mov_b32 v246, 0
    v_mov_b32 v247, 0
    v_mov_b32 v248, 0
    v_mov_b32 v249, 0
    v_mov_b32 v250, 0
    v_mov_b32 v251, 0
    v_mov_b32 v252, 0
    v_mov_b32 v253, 0
    v_mov_b32 v254, 0
    v_mov_b32 v255, 0
    v_accvgpr_write_b32 a96, 0
    v_accvgpr_write_b32 a97, 0
    v_accvgpr_write_b32 a98, 0
    v_accvgpr_write_b32 a99, 0
    v_accvgpr_write_b32 a100, 0
    v_accvgpr_write_b32 a101, 0
    v_accvgpr_write_b32 a102, 0
    v_accvgpr_write_b32 a103, 0
    v_accvgpr_write_b32 a104, 0
    v_accvgpr_write_b32 a105, 0
    v_accvgpr_write_b32 a106, 0
    v_accvgpr_write_b32 a107, 0
    v_accvgpr_write_b32 a108, 0
    v_accvgpr_write_b32 a109, 0
    v_accvgpr_write_b32 a110, 0
    v_accvgpr_write_b32 a111, 0
    v_accvgpr_write_b32 a112, 0
    v_accvgpr_write_b32 a113, 0
    v_accvgpr_write_b32 a114, 0
    v_accvgpr_write_b32 a115, 0
    v_accvgpr_write_b32 a116, 0
    v_accvgpr_write_b32 a117, 0
    v_accvgpr_write_b32 a118, 0
    v_accvgpr_write_b32 a119, 0
    v_mov_b32 v168, 0
    v_accvgpr_write_b32 a120, 0
    v_mov_b32 v169, 0
    v_accvgpr_write_b32 a121, 0
    v_mov_b32 v170, 0
    v_accvgpr_write_b32 a122, 0
    v_mov_b32 v171, 0
    v_accvgpr_write_b32 a123, 0
    v_mov_b32 v172, 0
    v_accvgpr_write_b32 a124, 0
    v_mov_b32 v173, 0
    v_accvgpr_write_b32 a125, 0
    v_mov_b32 v174, 0
    v_accvgpr_write_b32 a126, 0
    v_mov_b32 v175, 0
    v_accvgpr_write_b32 a127, 0
    v_mov_b32 v176, 0
    v_accvgpr_write_b32 a128, 0
    v_mov_b32 v177, 0
    v_accvgpr_write_b32 a129, 0
    v_mov_b32 v178, 0
    v_accvgpr_write_b32 a130, 0
    v_mov_b32 v179, 0
    v_accvgpr_write_b32 a131, 0
    v_mov_b32 v180, 0
    v_accvgpr_write_b32 a132, 0
    v_mov_b32 v181, 0
    v_accvgpr_write_b32 a133, 0
    v_mov_b32 v182, 0
    v_accvgpr_write_b32 a134, 0
    v_mov_b32 v183, 0
    v_accvgpr_write_b32 a135, 0
    v_mov_b32 v184, 0
    v_mov_b32 v185, 0
    v_mov_b32 v186, 0
    v_mov_b32 v187, 0
    v_mov_b32 v188, 0
    v_mov_b32 v189, 0
    v_mov_b32 v190, 0
    v_mov_b32 v191, 0
    v_mov_b32 v192, 0
    v_mov_b32 v193, 0
    v_mov_b32 v194, 0
    v_mov_b32 v195, 0
    v_mov_b32 v196, 0
    v_mov_b32 v197, 0
    v_mov_b32 v198, 0
    v_mov_b32 v199, 0
    v_mov_b32 v200, 0
    v_mov_b32 v201, 0
    v_mov_b32 v202, 0
    v_mov_b32 v203, 0
    v_mov_b32 v204, 0
    v_mov_b32 v205, 0
    v_mov_b32 v206, 0
    v_mov_b32 v207, 0
    s_waitcnt vmcnt(2)
    s_waitcnt vmcnt(0)
    s_barrier
    ds_read_b64_tr_b16 a[192:193], v9 offset:0
    ds_read_b64_tr_b16 a[194:195], v9 offset:9216
    ds_read_b64_tr_b16 a[196:197], v9 offset:18432
    ds_read_b64_tr_b16 a[198:199], v9 offset:27648
    ds_read_b64_tr_b16 a[200:201], v16 offset:32
    ds_read_b64_tr_b16 a[202:203], v16 offset:9248
    ds_read_b64_tr_b16 a[204:205], v16 offset:18464
    ds_read_b64_tr_b16 a[206:207], v16 offset:27680
    s_waitcnt lgkmcnt(6)
    s_mov_b32 s41, 0
    .p2align 6
Kloop_35:
    v_mfma_f32_16x16x32_bf16 v[64:67], a[192:195], a[0:3], v[64:67]
    ds_read_b64_tr_b16 a[208:209], v9 offset:64
    buffer_load_dwordx4 a[16:19], v15, s[20:23], s35 offen offset:0 sc1
    v_mfma_f32_16x16x32_bf16 v[68:71], a[192:195], a[4:7], v[68:71]
    s_waitcnt lgkmcnt(5)
    ds_read_b64_tr_b16 a[210:211], v9 offset:9280
    v_mfma_f32_16x16x32_bf16 v[208:211], a[196:199], a[0:3], v[208:211]
    ds_read_b64_tr_b16 a[212:213], v9 offset:18496
    v_mfma_f32_16x16x32_bf16 v[212:215], a[196:199], a[4:7], v[212:215]
    s_waitcnt lgkmcnt(5)
    ds_read_b64_tr_b16 a[214:215], v9 offset:27712
    v_mfma_f32_16x16x32_bf16 v[72:75], a[200:203], a[0:3], v[72:75]
    ds_read_b64_tr_b16 a[192:193], v16 offset:96
    v_mfma_f32_16x16x32_bf16 v[76:79], a[200:203], a[4:7], v[76:79]
    s_waitcnt lgkmcnt(5)
    ds_read_b64_tr_b16 a[194:195], v16 offset:9312
    v_mfma_f32_16x16x32_bf16 v[216:219], a[204:207], a[0:3], v[216:219]
    ds_read_b64_tr_b16 a[196:197], v16 offset:18528
    buffer_load_dwordx4 a[20:23], v15, s[20:23], s35 offen offset:1024 sc1
    v_mfma_f32_16x16x32_bf16 v[220:223], a[204:207], a[4:7], v[220:223]
    s_waitcnt lgkmcnt(5)
    ds_read_b64_tr_b16 a[198:199], v16 offset:27744
    v_mfma_f32_16x16x32_bf16 v[80:83], a[208:211], a[0:3], v[80:83]
    s_add_u32 s35, s35, 2048
    ds_read_b64_tr_b16 a[200:201], v9 offset:128
    v_mfma_f32_16x16x32_bf16 v[84:87], a[208:211], a[4:7], v[84:87]
    s_waitcnt lgkmcnt(5)
    ds_read_b64_tr_b16 a[202:203], v9 offset:9344
    v_mfma_f32_16x16x32_bf16 v[224:227], a[212:215], a[0:3], v[224:227]
    s_add_u32 m0, s37, 73728
    ds_read_b64_tr_b16 a[204:205], v9 offset:18560
    v_mfma_f32_16x16x32_bf16 v[228:231], a[212:215], a[4:7], v[228:231]
    s_waitcnt lgkmcnt(5)
    ds_read_b64_tr_b16 a[206:207], v9 offset:27776
    v_mfma_f32_16x16x32_bf16 v[88:91], a[192:195], a[0:3], v[88:91]
    ds_read_b64_tr_b16 a[208:209], v16 offset:160
    buffer_load_dwordx4 v0, s[12:15], s36 offen offset:0 lds
    v_mfma_f32_16x16x32_bf16 v[92:95], a[192:195], a[4:7], v[92:95]
    s_waitcnt lgkmcnt(5)
    ds_read_b64_tr_b16 a[210:211], v16 offset:9376
    v_mfma_f32_16x16x32_bf16 v[232:235], a[196:199], a[0:3], v[232:235]
    ds_read_b64_tr_b16 a[212:213], v16 offset:18592
    v_mfma_f32_16x16x32_bf16 v[236:239], a[196:199], a[4:7], v[236:239]
    s_waitcnt lgkmcnt(5)
    ds_read_b64_tr_b16 a[214:215], v16 offset:27808
    v_mfma_f32_16x16x32_bf16 v[96:99], a[200:203], a[0:3], v[96:99]
    ds_read_b64_tr_b16 a[192:193], v9 offset:192
    v_mfma_f32_16x16x32_bf16 v[100:103], a[200:203], a[4:7], v[100:103]
    s_waitcnt lgkmcnt(5)
    ds_read_b64_tr_b16 a[194:195], v9 offset:9408
    v_mfma_f32_16x16x32_bf16 v[240:243], a[204:207], a[0:3], v[240:243]
    ds_read_b64_tr_b16 a[196:197], v9 offset:18624
    buffer_load_dwordx4 v1, s[12:15], s36 offen offset:1024 lds
    v_mfma_f32_16x16x32_bf16 v[244:247], a[204:207], a[4:7], v[244:247]
    s_waitcnt lgkmcnt(5)
    ds_read_b64_tr_b16 a[198:199], v9 offset:27840
    v_mfma_f32_16x16x32_bf16 v[104:107], a[208:211], a[0:3], v[104:107]
    ds_read_b64_tr_b16 a[200:201], v16 offset:224
    v_mfma_f32_16x16x32_bf16 v[108:111], a[208:211], a[4:7], v[108:111]
    s_waitcnt lgkmcnt(5)
    ds_read_b64_tr_b16 a[202:203], v16 offset:9440
    v_mfma_f32_16x16x32_bf16 v[248:251], a[212:215], a[0:3], v[248:251]
    ds_read_b64_tr_b16 a[204:205], v16 offset:18656
    v_mfma_f32_16x16x32_bf16 v[252:255], a[212:215], a[4:7], v[252:255]
    s_waitcnt lgkmcnt(5)
    ds_read_b64_tr_b16 a[206:207], v16 offset:27872
    v_mfma_f32_16x16x32_bf16 v[112:115], a[192:195], a[0:3], v[112:115]
    ds_read_b64_tr_b16 a[208:209], v9 offset:256
    buffer_load_dwordx4 v2, s[12:15], s36 offen offset:2048 lds
    v_mfma_f32_16x16x32_bf16 v[116:119], a[192:195], a[4:7], v[116:119]
    s_waitcnt lgkmcnt(5)
    ds_read_b64_tr_b16 a[210:211], v9 offset:9472
    v_mfma_f32_16x16x32_bf16 v[32:35], a[196:199], a[0:3], v[32:35]
    ds_read_b64_tr_b16 a[212:213], v9 offset:18688
    v_mfma_f32_16x16x32_bf16 v[36:39], a[196:199], a[4:7], v[36:39]
    s_waitcnt lgkmcnt(5)
    ds_read_b64_tr_b16 a[214:215], v9 offset:27904
    v_mfma_f32_16x16x32_bf16 v[120:123], a[200:203], a[0:3], v[120:123]
    ds_read_b64_tr_b16 a[192:193], v16 offset:288
    v_mfma_f32_16x16x32_bf16 v[124:127], a[200:203], a[4:7], v[124:127]
    s_waitcnt lgkmcnt(5)
    ds_read_b64_tr_b16 a[194:195], v16 offset:9504
    v_mfma_f32_16x16x32_bf16 v[40:43], a[204:207], a[0:3], v[40:43]
    ds_read_b64_tr_b16 a[196:197], v16 offset:18720
    buffer_load_dwordx4 v3, s[12:15], s36 offen offset:3072 lds
    v_mfma_f32_16x16x32_bf16 v[44:47], a[204:207], a[4:7], v[44:47]
    s_waitcnt lgkmcnt(5)
    ds_read_b64_tr_b16 a[198:199], v16 offset:27936
    v_mfma_f32_16x16x32_bf16 v[128:131], a[208:211], a[0:3], v[128:131]
    s_add_u32 m0, s37, 77824
    ds_read_b64_tr_b16 a[200:201], v9 offset:320
    v_mfma_f32_16x16x32_bf16 v[132:135], a[208:211], a[4:7], v[132:135]
    s_waitcnt lgkmcnt(5)
    ds_read_b64_tr_b16 a[202:203], v9 offset:9536
    v_mfma_f32_16x16x32_bf16 v[48:51], a[212:215], a[0:3], v[48:51]
    ds_read_b64_tr_b16 a[204:205], v9 offset:18752
    v_mfma_f32_16x16x32_bf16 v[52:55], a[212:215], a[4:7], v[52:55]
    s_waitcnt lgkmcnt(5)
    ds_read_b64_tr_b16 a[206:207], v9 offset:27968
    v_mfma_f32_16x16x32_bf16 v[136:139], a[192:195], a[0:3], v[136:139]
    ds_read_b64_tr_b16 a[208:209], v16 offset:352
    buffer_load_dwordx4 v4, s[12:15], s36 offen offset:0 lds
    v_mfma_f32_16x16x32_bf16 v[140:143], a[192:195], a[4:7], v[140:143]
    s_waitcnt lgkmcnt(5)
    ds_read_b64_tr_b16 a[210:211], v16 offset:9568
    v_mfma_f32_16x16x32_bf16 v[56:59], a[196:199], a[0:3], v[56:59]
    ds_read_b64_tr_b16 a[212:213], v16 offset:18784
    v_mfma_f32_16x16x32_bf16 v[60:63], a[196:199], a[4:7], v[60:63]
    s_waitcnt lgkmcnt(5)
    ds_read_b64_tr_b16 a[214:215], v16 offset:28000
    v_mfma_f32_16x16x32_bf16 v[144:147], a[200:203], a[0:3], v[144:147]
    ds_read_b64_tr_b16 a[192:193], v9 offset:384
    v_mfma_f32_16x16x32_bf16 v[148:151], a[200:203], a[4:7], v[148:151]
    s_waitcnt lgkmcnt(5)
    ds_read_b64_tr_b16 a[194:195], v9 offset:9600
    v_mfma_f32_16x16x32_bf16 a[96:99], a[204:207], a[0:3], a[96:99]
    ds_read_b64_tr_b16 a[196:197], v9 offset:18816
    buffer_load_dwordx4 v5, s[12:15], s36 offen offset:1024 lds
    v_mfma_f32_16x16x32_bf16 a[100:103], a[204:207], a[4:7], a[100:103]
    s_waitcnt lgkmcnt(5)
    ds_read_b64_tr_b16 a[198:199], v9 offset:28032
    v_mfma_f32_16x16x32_bf16 v[152:155], a[208:211], a[0:3], v[152:155]
    ds_read_b64_tr_b16 a[200:201], v16 offset:416
    v_mfma_f32_16x16x32_bf16 v[156:159], a[208:211], a[4:7], v[156:159]
    s_waitcnt lgkmcnt(5)
    ds_read_b64_tr_b16 a[202:203], v16 offset:9632
    v_mfma_f32_16x16x32_bf16 a[104:107], a[212:215], a[0:3], a[104:107]
    ds_read_b64_tr_b16 a[204:205], v16 offset:18848
    v_mfma_f32_16x16x32_bf16 a[108:111], a[212:215], a[4:7], a[108:111]
    s_waitcnt lgkmcnt(5)
    ds_read_b64_tr_b16 a[206:207], v16 offset:28064
    v_mfma_f32_16x16x32_bf16 v[160:163], a[192:195], a[0:3], v[160:163]
    ds_read_b64_tr_b16 a[208:209], v9 offset:448
    buffer_load_dwordx4 v6, s[12:15], s36 offen offset:2048 lds
    v_mfma_f32_16x16x32_bf16 v[164:167], a[192:195], a[4:7], v[164:167]
    s_waitcnt lgkmcnt(5)
    ds_read_b64_tr_b16 a[210:211], v9 offset:9664
    v_mfma_f32_16x16x32_bf16 a[112:115], a[196:199], a[0:3], a[112:115]
    ds_read_b64_tr_b16 a[212:213], v9 offset:18880
    v_mfma_f32_16x16x32_bf16 a[116:119], a[196:199], a[4:7], a[116:119]
    s_waitcnt lgkmcnt(5)
    ds_read_b64_tr_b16 a[214:215], v9 offset:28096
    v_mfma_f32_16x16x32_bf16 v[168:171], a[200:203], a[0:3], v[168:171]
    ds_read_b64_tr_b16 a[192:193], v16 offset:480
    v_mfma_f32_16x16x32_bf16 v[172:175], a[200:203], a[4:7], v[172:175]
    s_waitcnt lgkmcnt(5)
    ds_read_b64_tr_b16 a[194:195], v16 offset:9696
    v_mfma_f32_16x16x32_bf16 a[120:123], a[204:207], a[0:3], a[120:123]
    ds_read_b64_tr_b16 a[196:197], v16 offset:18912
    buffer_load_dwordx4 v7, s[12:15], s36 offen offset:3072 lds
    v_mfma_f32_16x16x32_bf16 a[124:127], a[204:207], a[4:7], a[124:127]
    s_waitcnt lgkmcnt(5)
    ds_read_b64_tr_b16 a[198:199], v16 offset:28128
    v_mfma_f32_16x16x32_bf16 v[176:179], a[208:211], a[0:3], v[176:179]
    s_add_u32 m0, s37, 81920
    ds_read_b64_tr_b16 a[200:201], v9 offset:512
    v_mfma_f32_16x16x32_bf16 v[180:183], a[208:211], a[4:7], v[180:183]
    s_waitcnt lgkmcnt(5)
    ds_read_b64_tr_b16 a[202:203], v9 offset:9728
    v_mfma_f32_16x16x32_bf16 a[128:131], a[212:215], a[0:3], a[128:131]
    ds_read_b64_tr_b16 a[204:205], v9 offset:18944
    v_mfma_f32_16x16x32_bf16 a[132:135], a[212:215], a[4:7], a[132:135]
    s_waitcnt lgkmcnt(5)
    ds_read_b64_tr_b16 a[206:207], v9 offset:28160
    v_mfma_f32_16x16x32_bf16 v[184:187], a[192:195], a[0:3], v[184:187]
    s_waitcnt vmcnt(19)
    ds_read_b64_tr_b16 a[208:209], v16 offset:544
    buffer_load_dwordx4 v8, s[12:15], s36 offen offset:0 lds
    v_mfma_f32_16x16x32_bf16 v[188:191], a[192:195], a[4:7], v[188:191]
    s_waitcnt lgkmcnt(5)
    ds_read_b64_tr_b16 a[210:211], v16 offset:9760
    v_mfma_f32_16x16x32_bf16 a[136:139], a[196:199], a[0:3], a[136:139]
    s_add_u32 s36, s36, 294912
    ds_read_b64_tr_b16 a[212:213], v16 offset:18976
    v_mfma_f32_16x16x32_bf16 a[140:143], a[196:199], a[4:7], a[140:143]
    s_waitcnt lgkmcnt(5)
    ds_read_b64_tr_b16 a[214:215], v16 offset:28192
    v_mfma_f32_16x16x32_bf16 v[192:195], a[200:203], a[0:3], v[192:195]
    s_waitcnt vmcnt(11)
    s_barrier
    ds_read_b64_tr_b16 a[192:193], v9 offset:36864
    v_mfma_f32_16x16x32_bf16 v[196:199], a[200:203], a[4:7], v[196:199]
    s_waitcnt lgkmcnt(5)
    ds_read_b64_tr_b16 a[194:195], v9 offset:46080
    v_mfma_f32_16x16x32_bf16 a[144:147], a[204:207], a[0:3], a[144:147]
    ds_read_b64_tr_b16 a[196:197], v10 offset:0
    buffer_load_dword a232, v31, s[12:15], s50 offen
    v_mfma_f32_16x16x32_bf16 a[148:151], a[204:207], a[4:7], a[148:151]
    s_waitcnt lgkmcnt(5)
    ds_read_b64_tr_b16 a[198:199], v10 offset:9216
    v_mfma_f32_16x16x32_bf16 v[200:203], a[208:211], a[0:3], v[200:203]
    s_add_u32 s50, s50, 1179648
    ds_read_b64_tr_b16 a[200:201], v16 offset:36896
    v_mfma_f32_16x16x32_bf16 v[204:207], a[208:211], a[4:7], v[204:207]
    s_waitcnt lgkmcnt(5)
    ds_read_b64_tr_b16 a[202:203], v16 offset:46112
    v_mfma_f32_16x16x32_bf16 a[152:155], a[212:215], a[0:3], a[152:155]
    ds_read_b64_tr_b16 a[204:205], v17 offset:32
    v_mfma_f32_16x16x32_bf16 a[156:159], a[212:215], a[4:7], a[156:159]
    s_waitcnt lgkmcnt(5)
    ds_read_b64_tr_b16 a[206:207], v17 offset:9248
    v_mfma_f32_16x16x32_bf16 v[64:67], a[192:195], a[8:11], v[64:67]
    ds_read_b64_tr_b16 a[208:209], v9 offset:36928
    buffer_load_dwordx4 a[24:27], v15, s[20:23], s35 offen offset:0 sc1
    v_mfma_f32_16x16x32_bf16 v[68:71], a[192:195], a[12:15], v[68:71]
    s_waitcnt lgkmcnt(5)
    ds_read_b64_tr_b16 a[210:211], v9 offset:46144
    v_mfma_f32_16x16x32_bf16 v[208:211], a[196:199], a[8:11], v[208:211]
    ds_read_b64_tr_b16 a[212:213], v10 offset:64
    v_mfma_f32_16x16x32_bf16 v[212:215], a[196:199], a[12:15], v[212:215]
    s_waitcnt lgkmcnt(5)
    ds_read_b64_tr_b16 a[214:215], v10 offset:9280
    v_mfma_f32_16x16x32_bf16 v[72:75], a[200:203], a[8:11], v[72:75]
    ds_read_b64_tr_b16 a[192:193], v16 offset:36960
    v_mfma_f32_16x16x32_bf16 v[76:79], a[200:203], a[12:15], v[76:79]
    s_waitcnt lgkmcnt(5)
    ds_read_b64_tr_b16 a[194:195], v16 offset:46176
    v_mfma_f32_16x16x32_bf16 v[216:219], a[204:207], a[8:11], v[216:219]
    ds_read_b64_tr_b16 a[196:197], v17 offset:96
    buffer_load_dwordx4 a[28:31], v15, s[20:23], s35 offen offset:1024 sc1
    v_mfma_f32_16x16x32_bf16 v[220:223], a[204:207], a[12:15], v[220:223]
    s_waitcnt lgkmcnt(5)
    ds_read_b64_tr_b16 a[198:199], v17 offset:9312
    v_mfma_f32_16x16x32_bf16 v[80:83], a[208:211], a[8:11], v[80:83]
    s_add_u32 s35, s35, 2048
    ds_read_b64_tr_b16 a[200:201], v9 offset:36992
    v_mfma_f32_16x16x32_bf16 v[84:87], a[208:211], a[12:15], v[84:87]
    s_waitcnt lgkmcnt(5)
    ds_read_b64_tr_b16 a[202:203], v9 offset:46208
    v_mfma_f32_16x16x32_bf16 v[224:227], a[212:215], a[8:11], v[224:227]
    s_add_u32 m0, s37, 110592
    ds_read_b64_tr_b16 a[204:205], v10 offset:128
    v_mfma_f32_16x16x32_bf16 v[228:231], a[212:215], a[12:15], v[228:231]
    s_waitcnt lgkmcnt(5)
    ds_read_b64_tr_b16 a[206:207], v10 offset:9344
    v_mfma_f32_16x16x32_bf16 v[88:91], a[192:195], a[8:11], v[88:91]
    ds_read_b64_tr_b16 a[208:209], v16 offset:37024
    buffer_load_dwordx4 v0, s[12:15], s36 offen offset:0 lds
    v_mfma_f32_16x16x32_bf16 v[92:95], a[192:195], a[12:15], v[92:95]
    s_waitcnt lgkmcnt(5)
    ds_read_b64_tr_b16 a[210:211], v16 offset:46240
    v_mfma_f32_16x16x32_bf16 v[232:235], a[196:199], a[8:11], v[232:235]
    ds_read_b64_tr_b16 a[212:213], v17 offset:160
    v_mfma_f32_16x16x32_bf16 v[236:239], a[196:199], a[12:15], v[236:239]
    s_waitcnt lgkmcnt(5)
    ds_read_b64_tr_b16 a[214:215], v17 offset:9376
    v_mfma_f32_16x16x32_bf16 v[96:99], a[200:203], a[8:11], v[96:99]
    ds_read_b64_tr_b16 a[192:193], v9 offset:37056
    v_mfma_f32_16x16x32_bf16 v[100:103], a[200:203], a[12:15], v[100:103]
    s_waitcnt lgkmcnt(5)
    ds_read_b64_tr_b16 a[194:195], v9 offset:46272
    v_mfma_f32_16x16x32_bf16 v[240:243], a[204:207], a[8:11], v[240:243]
    ds_read_b64_tr_b16 a[196:197], v10 offset:192
    buffer_load_dwordx4 v1, s[12:15], s36 offen offset:1024 lds
    v_mfma_f32_16x16x32_bf16 v[244:247], a[204:207], a[12:15], v[244:247]
    s_waitcnt lgkmcnt(5)
    ds_read_b64_tr_b16 a[198:199], v10 offset:9408
    v_mfma_f32_16x16x32_bf16 v[104:107], a[208:211], a[8:11], v[104:107]
    ds_read_b64_tr_b16 a[200:201], v16 offset:37088
    v_mfma_f32_16x16x32_bf16 v[108:111], a[208:211], a[12:15], v[108:111]
    s_waitcnt lgkmcnt(5)
    ds_read_b64_tr_b16 a[202:203], v16 offset:46304
    v_mfma_f32_16x16x32_bf16 v[248:251], a[212:215], a[8:11], v[248:251]
    ds_read_b64_tr_b16 a[204:205], v17 offset:224
    v_mfma_f32_16x16x32_bf16 v[252:255], a[212:215], a[12:15], v[252:255]
    s_waitcnt lgkmcnt(5)
    ds_read_b64_tr_b16 a[206:207], v17 offset:9440
    v_mfma_f32_16x16x32_bf16 v[112:115], a[192:195], a[8:11], v[112:115]
    ds_read_b64_tr_b16 a[208:209], v9 offset:37120
    buffer_load_dwordx4 v2, s[12:15], s36 offen offset:2048 lds
    v_mfma_f32_16x16x32_bf16 v[116:119], a[192:195], a[12:15], v[116:119]
    s_waitcnt lgkmcnt(5)
    ds_read_b64_tr_b16 a[210:211], v9 offset:46336
    v_mfma_f32_16x16x32_bf16 v[32:35], a[196:199], a[8:11], v[32:35]
    ds_read_b64_tr_b16 a[212:213], v10 offset:256
    v_mfma_f32_16x16x32_bf16 v[36:39], a[196:199], a[12:15], v[36:39]
    s_waitcnt lgkmcnt(5)
    ds_read_b64_tr_b16 a[214:215], v10 offset:9472
    v_mfma_f32_16x16x32_bf16 v[120:123], a[200:203], a[8:11], v[120:123]
    ds_read_b64_tr_b16 a[192:193], v16 offset:37152
    v_mfma_f32_16x16x32_bf16 v[124:127], a[200:203], a[12:15], v[124:127]
    s_waitcnt lgkmcnt(5)
    ds_read_b64_tr_b16 a[194:195], v16 offset:46368
    v_mfma_f32_16x16x32_bf16 v[40:43], a[204:207], a[8:11], v[40:43]
    ds_read_b64_tr_b16 a[196:197], v17 offset:288
    buffer_load_dwordx4 v3, s[12:15], s36 offen offset:3072 lds
    v_mfma_f32_16x16x32_bf16 v[44:47], a[204:207], a[12:15], v[44:47]
    s_waitcnt lgkmcnt(5)
    ds_read_b64_tr_b16 a[198:199], v17 offset:9504
    v_mfma_f32_16x16x32_bf16 v[128:131], a[208:211], a[8:11], v[128:131]
    s_add_u32 m0, s37, 114688
    ds_read_b64_tr_b16 a[200:201], v9 offset:37184
    v_mfma_f32_16x16x32_bf16 v[132:135], a[208:211], a[12:15], v[132:135]
    s_waitcnt lgkmcnt(5)
    ds_read_b64_tr_b16 a[202:203], v9 offset:46400
    v_mfma_f32_16x16x32_bf16 v[48:51], a[212:215], a[8:11], v[48:51]
    ds_read_b64_tr_b16 a[204:205], v10 offset:320
    v_mfma_f32_16x16x32_bf16 v[52:55], a[212:215], a[12:15], v[52:55]
    s_waitcnt lgkmcnt(5)
    ds_read_b64_tr_b16 a[206:207], v10 offset:9536
    v_mfma_f32_16x16x32_bf16 v[136:139], a[192:195], a[8:11], v[136:139]
    ds_read_b64_tr_b16 a[208:209], v16 offset:37216
    buffer_load_dwordx4 v4, s[12:15], s36 offen offset:0 lds
    v_mfma_f32_16x16x32_bf16 v[140:143], a[192:195], a[12:15], v[140:143]
    s_waitcnt lgkmcnt(5)
    ds_read_b64_tr_b16 a[210:211], v16 offset:46432
    v_mfma_f32_16x16x32_bf16 v[56:59], a[196:199], a[8:11], v[56:59]
    ds_read_b64_tr_b16 a[212:213], v17 offset:352
    v_mfma_f32_16x16x32_bf16 v[60:63], a[196:199], a[12:15], v[60:63]
    s_waitcnt lgkmcnt(5)
    ds_read_b64_tr_b16 a[214:215], v17 offset:9568
    v_mfma_f32_16x16x32_bf16 v[144:147], a[200:203], a[8:11], v[144:147]
    ds_read_b64_tr_b16 a[192:193], v9 offset:37248
    v_mfma_f32_16x16x32_bf16 v[148:151], a[200:203], a[12:15], v[148:151]
    s_waitcnt lgkmcnt(5)
    ds_read_b64_tr_b16 a[194:195], v9 offset:46464
    v_mfma_f32_16x16x32_bf16 a[96:99], a[204:207], a[8:11], a[96:99]
    ds_read_b64_tr_b16 a[196:197], v10 offset:384
    buffer_load_dwordx4 v5, s[12:15], s36 offen offset:1024 lds
    v_mfma_f32_16x16x32_bf16 a[100:103], a[204:207], a[12:15], a[100:103]
    s_waitcnt lgkmcnt(5)
    ds_read_b64_tr_b16 a[198:199], v10 offset:9600
    v_mfma_f32_16x16x32_bf16 v[152:155], a[208:211], a[8:11], v[152:155]
    ds_read_b64_tr_b16 a[200:201], v16 offset:37280
    v_mfma_f32_16x16x32_bf16 v[156:159], a[208:211], a[12:15], v[156:159]
    s_waitcnt lgkmcnt(5)
    ds_read_b64_tr_b16 a[202:203], v16 offset:46496
    v_mfma_f32_16x16x32_bf16 a[104:107], a[212:215], a[8:11], a[104:107]
    ds_read_b64_tr_b16 a[204:205], v17 offset:416
    v_mfma_f32_16x16x32_bf16 a[108:111], a[212:215], a[12:15], a[108:111]
    s_waitcnt lgkmcnt(5)
    ds_read_b64_tr_b16 a[206:207], v17 offset:9632
    v_mfma_f32_16x16x32_bf16 v[160:163], a[192:195], a[8:11], v[160:163]
    ds_read_b64_tr_b16 a[208:209], v9 offset:37312
    buffer_load_dwordx4 v6, s[12:15], s36 offen offset:2048 lds
    v_mfma_f32_16x16x32_bf16 v[164:167], a[192:195], a[12:15], v[164:167]
    s_waitcnt lgkmcnt(5)
    ds_read_b64_tr_b16 a[210:211], v9 offset:46528
    v_mfma_f32_16x16x32_bf16 a[112:115], a[196:199], a[8:11], a[112:115]
    ds_read_b64_tr_b16 a[212:213], v10 offset:448
    v_mfma_f32_16x16x32_bf16 a[116:119], a[196:199], a[12:15], a[116:119]
    s_waitcnt lgkmcnt(5)
    ds_read_b64_tr_b16 a[214:215], v10 offset:9664
    v_mfma_f32_16x16x32_bf16 v[168:171], a[200:203], a[8:11], v[168:171]
    ds_read_b64_tr_b16 a[192:193], v16 offset:37344
    v_mfma_f32_16x16x32_bf16 v[172:175], a[200:203], a[12:15], v[172:175]
    s_waitcnt lgkmcnt(5)
    ds_read_b64_tr_b16 a[194:195], v16 offset:46560
    v_mfma_f32_16x16x32_bf16 a[120:123], a[204:207], a[8:11], a[120:123]
    ds_read_b64_tr_b16 a[196:197], v17 offset:480
    buffer_load_dwordx4 v7, s[12:15], s36 offen offset:3072 lds
    v_mfma_f32_16x16x32_bf16 a[124:127], a[204:207], a[12:15], a[124:127]
    s_waitcnt lgkmcnt(5)
    ds_read_b64_tr_b16 a[198:199], v17 offset:9696
    v_mfma_f32_16x16x32_bf16 v[176:179], a[208:211], a[8:11], v[176:179]
    s_add_u32 m0, s37, 118784
    ds_read_b64_tr_b16 a[200:201], v9 offset:37376
    v_mfma_f32_16x16x32_bf16 v[180:183], a[208:211], a[12:15], v[180:183]
    s_waitcnt lgkmcnt(5)
    ds_read_b64_tr_b16 a[202:203], v9 offset:46592
    v_mfma_f32_16x16x32_bf16 a[128:131], a[212:215], a[8:11], a[128:131]
    ds_read_b64_tr_b16 a[204:205], v10 offset:512
    v_mfma_f32_16x16x32_bf16 a[132:135], a[212:215], a[12:15], a[132:135]
    s_waitcnt lgkmcnt(5)
    ds_read_b64_tr_b16 a[206:207], v10 offset:9728
    v_mfma_f32_16x16x32_bf16 v[184:187], a[192:195], a[8:11], v[184:187]
    s_waitcnt vmcnt(20)
    ds_read_b64_tr_b16 a[208:209], v16 offset:37408
    buffer_load_dwordx4 v8, s[12:15], s36 offen offset:0 lds
    v_mfma_f32_16x16x32_bf16 v[188:191], a[192:195], a[12:15], v[188:191]
    s_waitcnt lgkmcnt(5)
    ds_read_b64_tr_b16 a[210:211], v16 offset:46624
    v_mfma_f32_16x16x32_bf16 a[136:139], a[196:199], a[8:11], a[136:139]
    s_add_u32 s36, s36, 294912
    ds_read_b64_tr_b16 a[212:213], v17 offset:544
    v_mfma_f32_16x16x32_bf16 a[140:143], a[196:199], a[12:15], a[140:143]
    s_waitcnt lgkmcnt(5)
    ds_read_b64_tr_b16 a[214:215], v17 offset:9760
    v_mfma_f32_16x16x32_bf16 v[192:195], a[200:203], a[8:11], v[192:195]
    s_waitcnt vmcnt(12)
    s_barrier
    ds_read_b64_tr_b16 a[192:193], v10 offset:18432
    v_mfma_f32_16x16x32_bf16 v[196:199], a[200:203], a[12:15], v[196:199]
    s_waitcnt lgkmcnt(5)
    ds_read_b64_tr_b16 a[194:195], v10 offset:27648
    v_mfma_f32_16x16x32_bf16 a[144:147], a[204:207], a[8:11], a[144:147]
    ds_read_b64_tr_b16 a[196:197], v10 offset:36864
    v_mfma_f32_16x16x32_bf16 a[148:151], a[204:207], a[12:15], a[148:151]
    s_waitcnt lgkmcnt(5)
    ds_read_b64_tr_b16 a[198:199], v10 offset:46080
    v_mfma_f32_16x16x32_bf16 v[200:203], a[208:211], a[8:11], v[200:203]
    ds_read_b64_tr_b16 a[200:201], v17 offset:18464
    v_mfma_f32_16x16x32_bf16 v[204:207], a[208:211], a[12:15], v[204:207]
    s_waitcnt lgkmcnt(5)
    ds_read_b64_tr_b16 a[202:203], v17 offset:27680
    v_mfma_f32_16x16x32_bf16 a[152:155], a[212:215], a[8:11], a[152:155]
    ds_read_b64_tr_b16 a[204:205], v17 offset:36896
    v_mfma_f32_16x16x32_bf16 a[156:159], a[212:215], a[12:15], a[156:159]
    s_waitcnt lgkmcnt(5)
    ds_read_b64_tr_b16 a[206:207], v17 offset:46112
    v_mfma_f32_16x16x32_bf16 v[64:67], a[192:195], a[16:19], v[64:67]
    ds_read_b64_tr_b16 a[208:209], v10 offset:18496
    buffer_load_dwordx4 a[0:3], v15, s[20:23], s35 offen offset:0 sc1
    v_mfma_f32_16x16x32_bf16 v[68:71], a[192:195], a[20:23], v[68:71]
    s_waitcnt lgkmcnt(5)
    ds_read_b64_tr_b16 a[210:211], v10 offset:27712
    v_mfma_f32_16x16x32_bf16 v[208:211], a[196:199], a[16:19], v[208:211]
    ds_read_b64_tr_b16 a[212:213], v10 offset:36928
    v_mfma_f32_16x16x32_bf16 v[212:215], a[196:199], a[20:23], v[212:215]
    s_waitcnt lgkmcnt(5)
    ds_read_b64_tr_b16 a[214:215], v10 offset:46144
    v_mfma_f32_16x16x32_bf16 v[72:75], a[200:203], a[16:19], v[72:75]
    ds_read_b64_tr_b16 a[192:193], v17 offset:18528
    v_mfma_f32_16x16x32_bf16 v[76:79], a[200:203], a[20:23], v[76:79]
    s_waitcnt lgkmcnt(5)
    ds_read_b64_tr_b16 a[194:195], v17 offset:27744
    v_mfma_f32_16x16x32_bf16 v[216:219], a[204:207], a[16:19], v[216:219]
    ds_read_b64_tr_b16 a[196:197], v17 offset:36960
    buffer_load_dwordx4 a[4:7], v15, s[20:23], s35 offen offset:1024 sc1
    v_mfma_f32_16x16x32_bf16 v[220:223], a[204:207], a[20:23], v[220:223]
    s_waitcnt lgkmcnt(5)
    ds_read_b64_tr_b16 a[198:199], v17 offset:46176
    v_mfma_f32_16x16x32_bf16 v[80:83], a[208:211], a[16:19], v[80:83]
    s_add_u32 s35, s35, 2048
    ds_read_b64_tr_b16 a[200:201], v10 offset:18560
    v_mfma_f32_16x16x32_bf16 v[84:87], a[208:211], a[20:23], v[84:87]
    s_waitcnt lgkmcnt(5)
    ds_read_b64_tr_b16 a[202:203], v10 offset:27776
    v_mfma_f32_16x16x32_bf16 v[224:227], a[212:215], a[16:19], v[224:227]
    s_add_u32 m0, s37, 0
    ds_read_b64_tr_b16 a[204:205], v10 offset:36992
    v_mfma_f32_16x16x32_bf16 v[228:231], a[212:215], a[20:23], v[228:231]
    s_waitcnt lgkmcnt(5)
    ds_read_b64_tr_b16 a[206:207], v10 offset:46208
    v_mfma_f32_16x16x32_bf16 v[88:91], a[192:195], a[16:19], v[88:91]
    ds_read_b64_tr_b16 a[208:209], v17 offset:18592
    buffer_load_dwordx4 v0, s[12:15], s36 offen offset:0 lds
    v_mfma_f32_16x16x32_bf16 v[92:95], a[192:195], a[20:23], v[92:95]
    s_waitcnt lgkmcnt(5)
    ds_read_b64_tr_b16 a[210:211], v17 offset:27808
    v_mfma_f32_16x16x32_bf16 v[232:235], a[196:199], a[16:19], v[232:235]
    ds_read_b64_tr_b16 a[212:213], v17 offset:37024
    v_mfma_f32_16x16x32_bf16 v[236:239], a[196:199], a[20:23], v[236:239]
    s_waitcnt lgkmcnt(5)
    ds_read_b64_tr_b16 a[214:215], v17 offset:46240
    v_mfma_f32_16x16x32_bf16 v[96:99], a[200:203], a[16:19], v[96:99]
    ds_read_b64_tr_b16 a[192:193], v10 offset:18624
    v_mfma_f32_16x16x32_bf16 v[100:103], a[200:203], a[20:23], v[100:103]
    s_waitcnt lgkmcnt(5)
    ds_read_b64_tr_b16 a[194:195], v10 offset:27840
    v_mfma_f32_16x16x32_bf16 v[240:243], a[204:207], a[16:19], v[240:243]
    ds_read_b64_tr_b16 a[196:197], v10 offset:37056
    buffer_load_dwordx4 v1, s[12:15], s36 offen offset:1024 lds
    v_mfma_f32_16x16x32_bf16 v[244:247], a[204:207], a[20:23], v[244:247]
    s_waitcnt lgkmcnt(5)
    ds_read_b64_tr_b16 a[198:199], v10 offset:46272
    v_mfma_f32_16x16x32_bf16 v[104:107], a[208:211], a[16:19], v[104:107]
    ds_read_b64_tr_b16 a[200:201], v17 offset:18656
    v_mfma_f32_16x16x32_bf16 v[108:111], a[208:211], a[20:23], v[108:111]
    s_waitcnt lgkmcnt(5)
    ds_read_b64_tr_b16 a[202:203], v17 offset:27872
    v_mfma_f32_16x16x32_bf16 v[248:251], a[212:215], a[16:19], v[248:251]
    ds_read_b64_tr_b16 a[204:205], v17 offset:37088
    v_mfma_f32_16x16x32_bf16 v[252:255], a[212:215], a[20:23], v[252:255]
    s_waitcnt lgkmcnt(5)
    ds_read_b64_tr_b16 a[206:207], v17 offset:46304
    v_mfma_f32_16x16x32_bf16 v[112:115], a[192:195], a[16:19], v[112:115]
    ds_read_b64_tr_b16 a[208:209], v10 offset:18688
    buffer_load_dwordx4 v2, s[12:15], s36 offen offset:2048 lds
    v_mfma_f32_16x16x32_bf16 v[116:119], a[192:195], a[20:23], v[116:119]
    s_waitcnt lgkmcnt(5)
    ds_read_b64_tr_b16 a[210:211], v10 offset:27904
    v_mfma_f32_16x16x32_bf16 v[32:35], a[196:199], a[16:19], v[32:35]
    ds_read_b64_tr_b16 a[212:213], v10 offset:37120
    v_mfma_f32_16x16x32_bf16 v[36:39], a[196:199], a[20:23], v[36:39]
    s_waitcnt lgkmcnt(5)
    ds_read_b64_tr_b16 a[214:215], v10 offset:46336
    v_mfma_f32_16x16x32_bf16 v[120:123], a[200:203], a[16:19], v[120:123]
    ds_read_b64_tr_b16 a[192:193], v17 offset:18720
    v_mfma_f32_16x16x32_bf16 v[124:127], a[200:203], a[20:23], v[124:127]
    s_waitcnt lgkmcnt(5)
    ds_read_b64_tr_b16 a[194:195], v17 offset:27936
    v_mfma_f32_16x16x32_bf16 v[40:43], a[204:207], a[16:19], v[40:43]
    ds_read_b64_tr_b16 a[196:197], v17 offset:37152
    buffer_load_dwordx4 v3, s[12:15], s36 offen offset:3072 lds
    v_mfma_f32_16x16x32_bf16 v[44:47], a[204:207], a[20:23], v[44:47]
    s_waitcnt lgkmcnt(5)
    ds_read_b64_tr_b16 a[198:199], v17 offset:46368
    v_mfma_f32_16x16x32_bf16 v[128:131], a[208:211], a[16:19], v[128:131]
    s_add_u32 m0, s37, 4096
    ds_read_b64_tr_b16 a[200:201], v10 offset:18752
    v_mfma_f32_16x16x32_bf16 v[132:135], a[208:211], a[20:23], v[132:135]
    s_waitcnt lgkmcnt(5)
    ds_read_b64_tr_b16 a[202:203], v10 offset:27968
    v_mfma_f32_16x16x32_bf16 v[48:51], a[212:215], a[16:19], v[48:51]
    ds_read_b64_tr_b16 a[204:205], v10 offset:37184
    v_mfma_f32_16x16x32_bf16 v[52:55], a[212:215], a[20:23], v[52:55]
    s_waitcnt lgkmcnt(5)
    ds_read_b64_tr_b16 a[206:207], v10 offset:46400
    v_mfma_f32_16x16x32_bf16 v[136:139], a[192:195], a[16:19], v[136:139]
    ds_read_b64_tr_b16 a[208:209], v17 offset:18784
    buffer_load_dwordx4 v4, s[12:15], s36 offen offset:0 lds
    v_mfma_f32_16x16x32_bf16 v[140:143], a[192:195], a[20:23], v[140:143]
    s_waitcnt lgkmcnt(5)
    ds_read_b64_tr_b16 a[210:211], v17 offset:28000
    v_mfma_f32_16x16x32_bf16 v[56:59], a[196:199], a[16:19], v[56:59]
    ds_read_b64_tr_b16 a[212:213], v17 offset:37216
    v_mfma_f32_16x16x32_bf16 v[60:63], a[196:199], a[20:23], v[60:63]
    s_waitcnt lgkmcnt(5)
    ds_read_b64_tr_b16 a[214:215], v17 offset:46432
    v_mfma_f32_16x16x32_bf16 v[144:147], a[200:203], a[16:19], v[144:147]
    ds_read_b64_tr_b16 a[192:193], v10 offset:18816
    v_mfma_f32_16x16x32_bf16 v[148:151], a[200:203], a[20:23], v[148:151]
    s_waitcnt lgkmcnt(5)
    ds_read_b64_tr_b16 a[194:195], v10 offset:28032
    v_mfma_f32_16x16x32_bf16 a[96:99], a[204:207], a[16:19], a[96:99]
    ds_read_b64_tr_b16 a[196:197], v10 offset:37248
    buffer_load_dwordx4 v5, s[12:15], s36 offen offset:1024 lds
    v_mfma_f32_16x16x32_bf16 a[100:103], a[204:207], a[20:23], a[100:103]
    s_waitcnt lgkmcnt(5)
    ds_read_b64_tr_b16 a[198:199], v10 offset:46464
    v_mfma_f32_16x16x32_bf16 v[152:155], a[208:211], a[16:19], v[152:155]
    ds_read_b64_tr_b16 a[200:201], v17 offset:18848
    v_mfma_f32_16x16x32_bf16 v[156:159], a[208:211], a[20:23], v[156:159]
    s_waitcnt lgkmcnt(5)
    ds_read_b64_tr_b16 a[202:203], v17 offset:28064
    v_mfma_f32_16x16x32_bf16 a[104:107], a[212:215], a[16:19], a[104:107]
    ds_read_b64_tr_b16 a[204:205], v17 offset:37280
    v_mfma_f32_16x16x32_bf16 a[108:111], a[212:215], a[20:23], a[108:111]
    s_waitcnt lgkmcnt(5)
    ds_read_b64_tr_b16 a[206:207], v17 offset:46496
    v_mfma_f32_16x16x32_bf16 v[160:163], a[192:195], a[16:19], v[160:163]
    ds_read_b64_tr_b16 a[208:209], v10 offset:18880
    buffer_load_dwordx4 v6, s[12:15], s36 offen offset:2048 lds
    v_mfma_f32_16x16x32_bf16 v[164:167], a[192:195], a[20:23], v[164:167]
    s_waitcnt lgkmcnt(5)
    ds_read_b64_tr_b16 a[210:211], v10 offset:28096
    v_mfma_f32_16x16x32_bf16 a[112:115], a[196:199], a[16:19], a[112:115]
    ds_read_b64_tr_b16 a[212:213], v10 offset:37312
    v_mfma_f32_16x16x32_bf16 a[116:119], a[196:199], a[20:23], a[116:119]
    s_waitcnt lgkmcnt(5)
    ds_read_b64_tr_b16 a[214:215], v10 offset:46528
    v_mfma_f32_16x16x32_bf16 v[168:171], a[200:203], a[16:19], v[168:171]
    ds_read_b64_tr_b16 a[192:193], v17 offset:18912
    v_mfma_f32_16x16x32_bf16 v[172:175], a[200:203], a[20:23], v[172:175]
    s_waitcnt lgkmcnt(5)
    ds_read_b64_tr_b16 a[194:195], v17 offset:28128
    v_mfma_f32_16x16x32_bf16 a[120:123], a[204:207], a[16:19], a[120:123]
    ds_read_b64_tr_b16 a[196:197], v17 offset:37344
    buffer_load_dwordx4 v7, s[12:15], s36 offen offset:3072 lds
    v_mfma_f32_16x16x32_bf16 a[124:127], a[204:207], a[20:23], a[124:127]
    s_waitcnt lgkmcnt(5)
    ds_read_b64_tr_b16 a[198:199], v17 offset:46560
    v_mfma_f32_16x16x32_bf16 v[176:179], a[208:211], a[16:19], v[176:179]
    s_add_u32 m0, s37, 8192
    ds_read_b64_tr_b16 a[200:201], v10 offset:18944
    v_mfma_f32_16x16x32_bf16 v[180:183], a[208:211], a[20:23], v[180:183]
    s_waitcnt lgkmcnt(5)
    ds_read_b64_tr_b16 a[202:203], v10 offset:28160
    v_mfma_f32_16x16x32_bf16 a[128:131], a[212:215], a[16:19], a[128:131]
    ds_read_b64_tr_b16 a[204:205], v10 offset:37376
    v_mfma_f32_16x16x32_bf16 a[132:135], a[212:215], a[20:23], a[132:135]
    s_waitcnt lgkmcnt(5)
    ds_read_b64_tr_b16 a[206:207], v10 offset:46592
    v_mfma_f32_16x16x32_bf16 v[184:187], a[192:195], a[16:19], v[184:187]
    s_waitcnt vmcnt(19)
    ds_read_b64_tr_b16 a[208:209], v17 offset:18976
    buffer_load_dwordx4 v8, s[12:15], s36 offen offset:0 lds
    v_mfma_f32_16x16x32_bf16 v[188:191], a[192:195], a[20:23], v[188:191]
    s_waitcnt lgkmcnt(5)
    ds_read_b64_tr_b16 a[210:211], v17 offset:28192
    v_mfma_f32_16x16x32_bf16 a[136:139], a[196:199], a[16:19], a[136:139]
    s_add_u32 s36, s36, 294912
    ds_read_b64_tr_b16 a[212:213], v17 offset:37408
    v_mfma_f32_16x16x32_bf16 a[140:143], a[196:199], a[20:23], a[140:143]
    s_waitcnt lgkmcnt(5)
    ds_read_b64_tr_b16 a[214:215], v17 offset:46624
    v_mfma_f32_16x16x32_bf16 v[192:195], a[200:203], a[16:19], v[192:195]
    s_waitcnt vmcnt(11)
    s_barrier
    ds_read_b64_tr_b16 a[192:193], v11 offset:0
    v_mfma_f32_16x16x32_bf16 v[196:199], a[200:203], a[20:23], v[196:199]
    s_waitcnt lgkmcnt(5)
    ds_read_b64_tr_b16 a[194:195], v11 offset:9216
    v_mfma_f32_16x16x32_bf16 a[144:147], a[204:207], a[16:19], a[144:147]
    ds_read_b64_tr_b16 a[196:197], v11 offset:18432
    buffer_load_dword a233, v14, s[16:19], s51 offen
    v_mfma_f32_16x16x32_bf16 a[148:151], a[204:207], a[20:23], a[148:151]
    s_waitcnt lgkmcnt(5)
    ds_read_b64_tr_b16 a[198:199], v11 offset:27648
    v_mfma_f32_16x16x32_bf16 v[200:203], a[208:211], a[16:19], v[200:203]
    s_add_u32 s51, s51, 180224
    ds_read_b64_tr_b16 a[200:201], v18 offset:32
    v_mfma_f32_16x16x32_bf16 v[204:207], a[208:211], a[20:23], v[204:207]
    s_waitcnt lgkmcnt(5)
    ds_read_b64_tr_b16 a[202:203], v18 offset:9248
    v_mfma_f32_16x16x32_bf16 a[152:155], a[212:215], a[16:19], a[152:155]
    ds_read_b64_tr_b16 a[204:205], v18 offset:18464
    v_mfma_f32_16x16x32_bf16 a[156:159], a[212:215], a[20:23], a[156:159]
    s_waitcnt lgkmcnt(5)
    ds_read_b64_tr_b16 a[206:207], v18 offset:27680
    v_mfma_f32_16x16x32_bf16 v[64:67], a[192:195], a[24:27], v[64:67]
    ds_read_b64_tr_b16 a[208:209], v11 offset:64
    buffer_load_dwordx4 a[8:11], v15, s[20:23], s35 offen offset:0 sc1
    v_mfma_f32_16x16x32_bf16 v[68:71], a[192:195], a[28:31], v[68:71]
    s_waitcnt lgkmcnt(5)
    ds_read_b64_tr_b16 a[210:211], v11 offset:9280
    v_mfma_f32_16x16x32_bf16 v[208:211], a[196:199], a[24:27], v[208:211]
    ds_read_b64_tr_b16 a[212:213], v11 offset:18496
    v_mfma_f32_16x16x32_bf16 v[212:215], a[196:199], a[28:31], v[212:215]
    s_waitcnt lgkmcnt(5)
    ds_read_b64_tr_b16 a[214:215], v11 offset:27712
    v_mfma_f32_16x16x32_bf16 v[72:75], a[200:203], a[24:27], v[72:75]
    ds_read_b64_tr_b16 a[192:193], v18 offset:96
    v_mfma_f32_16x16x32_bf16 v[76:79], a[200:203], a[28:31], v[76:79]
    s_waitcnt lgkmcnt(5)
    ds_read_b64_tr_b16 a[194:195], v18 offset:9312
    v_mfma_f32_16x16x32_bf16 v[216:219], a[204:207], a[24:27], v[216:219]
    ds_read_b64_tr_b16 a[196:197], v18 offset:18528
    buffer_load_dwordx4 a[12:15], v15, s[20:23], s35 offen offset:1024 sc1
    v_mfma_f32_16x16x32_bf16 v[220:223], a[204:207], a[28:31], v[220:223]
    s_waitcnt lgkmcnt(5)
    ds_read_b64_tr_b16 a[198:199], v18 offset:27744
    v_mfma_f32_16x16x32_bf16 v[80:83], a[208:211], a[24:27], v[80:83]
    s_add_u32 s35, s35, 2048
    ds_read_b64_tr_b16 a[200:201], v11 offset:128
    v_mfma_f32_16x16x32_bf16 v[84:87], a[208:211], a[28:31], v[84:87]
    s_waitcnt lgkmcnt(5)
    ds_read_b64_tr_b16 a[202:203], v11 offset:9344
    v_mfma_f32_16x16x32_bf16 v[224:227], a[212:215], a[24:27], v[224:227]
    s_add_u32 m0, s37, 36864
    ds_read_b64_tr_b16 a[204:205], v11 offset:18560
    v_mfma_f32_16x16x32_bf16 v[228:231], a[212:215], a[28:31], v[228:231]
    s_waitcnt lgkmcnt(5)
    ds_read_b64_tr_b16 a[206:207], v11 offset:27776
    v_mfma_f32_16x16x32_bf16 v[88:91], a[192:195], a[24:27], v[88:91]
    ds_read_b64_tr_b16 a[208:209], v18 offset:160
    buffer_load_dwordx4 v0, s[12:15], s36 offen offset:0 lds
    v_mfma_f32_16x16x32_bf16 v[92:95], a[192:195], a[28:31], v[92:95]
    s_waitcnt lgkmcnt(5)
    ds_read_b64_tr_b16 a[210:211], v18 offset:9376
    v_mfma_f32_16x16x32_bf16 v[232:235], a[196:199], a[24:27], v[232:235]
    ds_read_b64_tr_b16 a[212:213], v18 offset:18592
    v_mfma_f32_16x16x32_bf16 v[236:239], a[196:199], a[28:31], v[236:239]
    s_waitcnt lgkmcnt(5)
    ds_read_b64_tr_b16 a[214:215], v18 offset:27808
    v_mfma_f32_16x16x32_bf16 v[96:99], a[200:203], a[24:27], v[96:99]
    ds_read_b64_tr_b16 a[192:193], v11 offset:192
    v_mfma_f32_16x16x32_bf16 v[100:103], a[200:203], a[28:31], v[100:103]
    s_waitcnt lgkmcnt(5)
    ds_read_b64_tr_b16 a[194:195], v11 offset:9408
    v_mfma_f32_16x16x32_bf16 v[240:243], a[204:207], a[24:27], v[240:243]
    ds_read_b64_tr_b16 a[196:197], v11 offset:18624
    buffer_load_dwordx4 v1, s[12:15], s36 offen offset:1024 lds
    v_mfma_f32_16x16x32_bf16 v[244:247], a[204:207], a[28:31], v[244:247]
    s_waitcnt lgkmcnt(5)
    ds_read_b64_tr_b16 a[198:199], v11 offset:27840
    v_mfma_f32_16x16x32_bf16 v[104:107], a[208:211], a[24:27], v[104:107]
    ds_read_b64_tr_b16 a[200:201], v18 offset:224
    v_mfma_f32_16x16x32_bf16 v[108:111], a[208:211], a[28:31], v[108:111]
    s_waitcnt lgkmcnt(5)
    ds_read_b64_tr_b16 a[202:203], v18 offset:9440
    v_mfma_f32_16x16x32_bf16 v[248:251], a[212:215], a[24:27], v[248:251]
    ds_read_b64_tr_b16 a[204:205], v18 offset:18656
    v_mfma_f32_16x16x32_bf16 v[252:255], a[212:215], a[28:31], v[252:255]
    s_waitcnt lgkmcnt(5)
    ds_read_b64_tr_b16 a[206:207], v18 offset:27872
    v_mfma_f32_16x16x32_bf16 v[112:115], a[192:195], a[24:27], v[112:115]
    ds_read_b64_tr_b16 a[208:209], v11 offset:256
    buffer_load_dwordx4 v2, s[12:15], s36 offen offset:2048 lds
    v_mfma_f32_16x16x32_bf16 v[116:119], a[192:195], a[28:31], v[116:119]
    s_waitcnt lgkmcnt(5)
    ds_read_b64_tr_b16 a[210:211], v11 offset:9472
    v_mfma_f32_16x16x32_bf16 v[32:35], a[196:199], a[24:27], v[32:35]
    ds_read_b64_tr_b16 a[212:213], v11 offset:18688
    v_mfma_f32_16x16x32_bf16 v[36:39], a[196:199], a[28:31], v[36:39]
    s_waitcnt lgkmcnt(5)
    ds_read_b64_tr_b16 a[214:215], v11 offset:27904
    v_mfma_f32_16x16x32_bf16 v[120:123], a[200:203], a[24:27], v[120:123]
    ds_read_b64_tr_b16 a[192:193], v18 offset:288
    v_mfma_f32_16x16x32_bf16 v[124:127], a[200:203], a[28:31], v[124:127]
    s_waitcnt lgkmcnt(5)
    ds_read_b64_tr_b16 a[194:195], v18 offset:9504
    v_mfma_f32_16x16x32_bf16 v[40:43], a[204:207], a[24:27], v[40:43]
    ds_read_b64_tr_b16 a[196:197], v18 offset:18720
    buffer_load_dwordx4 v3, s[12:15], s36 offen offset:3072 lds
    v_mfma_f32_16x16x32_bf16 v[44:47], a[204:207], a[28:31], v[44:47]
    s_waitcnt lgkmcnt(5)
    ds_read_b64_tr_b16 a[198:199], v18 offset:27936
    v_mfma_f32_16x16x32_bf16 v[128:131], a[208:211], a[24:27], v[128:131]
    s_add_u32 m0, s37, 40960
    ds_read_b64_tr_b16 a[200:201], v11 offset:320
    v_mfma_f32_16x16x32_bf16 v[132:135], a[208:211], a[28:31], v[132:135]
    s_waitcnt lgkmcnt(5)
    ds_read_b64_tr_b16 a[202:203], v11 offset:9536
    v_mfma_f32_16x16x32_bf16 v[48:51], a[212:215], a[24:27], v[48:51]
    ds_read_b64_tr_b16 a[204:205], v11 offset:18752
    v_mfma_f32_16x16x32_bf16 v[52:55], a[212:215], a[28:31], v[52:55]
    s_waitcnt lgkmcnt(5)
    ds_read_b64_tr_b16 a[206:207], v11 offset:27968
    v_mfma_f32_16x16x32_bf16 v[136:139], a[192:195], a[24:27], v[136:139]
    ds_read_b64_tr_b16 a[208:209], v18 offset:352
    buffer_load_dwordx4 v4, s[12:15], s36 offen offset:0 lds
    v_mfma_f32_16x16x32_bf16 v[140:143], a[192:195], a[28:31], v[140:143]
    s_waitcnt lgkmcnt(5)
    ds_read_b64_tr_b16 a[210:211], v18 offset:9568
    v_mfma_f32_16x16x32_bf16 v[56:59], a[196:199], a[24:27], v[56:59]
    ds_read_b64_tr_b16 a[212:213], v18 offset:18784
    v_mfma_f32_16x16x32_bf16 v[60:63], a[196:199], a[28:31], v[60:63]
    s_waitcnt lgkmcnt(5)
    ds_read_b64_tr_b16 a[214:215], v18 offset:28000
    v_mfma_f32_16x16x32_bf16 v[144:147], a[200:203], a[24:27], v[144:147]
    ds_read_b64_tr_b16 a[192:193], v11 offset:384
    v_mfma_f32_16x16x32_bf16 v[148:151], a[200:203], a[28:31], v[148:151]
    s_waitcnt lgkmcnt(5)
    ds_read_b64_tr_b16 a[194:195], v11 offset:9600
    v_mfma_f32_16x16x32_bf16 a[96:99], a[204:207], a[24:27], a[96:99]
    ds_read_b64_tr_b16 a[196:197], v11 offset:18816
    buffer_load_dwordx4 v5, s[12:15], s36 offen offset:1024 lds
    v_mfma_f32_16x16x32_bf16 a[100:103], a[204:207], a[28:31], a[100:103]
    s_waitcnt lgkmcnt(5)
    ds_read_b64_tr_b16 a[198:199], v11 offset:28032
    v_mfma_f32_16x16x32_bf16 v[152:155], a[208:211], a[24:27], v[152:155]
    ds_read_b64_tr_b16 a[200:201], v18 offset:416
    v_mfma_f32_16x16x32_bf16 v[156:159], a[208:211], a[28:31], v[156:159]
    s_waitcnt lgkmcnt(5)
    ds_read_b64_tr_b16 a[202:203], v18 offset:9632
    v_mfma_f32_16x16x32_bf16 a[104:107], a[212:215], a[24:27], a[104:107]
    ds_read_b64_tr_b16 a[204:205], v18 offset:18848
    v_mfma_f32_16x16x32_bf16 a[108:111], a[212:215], a[28:31], a[108:111]
    s_waitcnt lgkmcnt(5)
    ds_read_b64_tr_b16 a[206:207], v18 offset:28064
    v_mfma_f32_16x16x32_bf16 v[160:163], a[192:195], a[24:27], v[160:163]
    ds_read_b64_tr_b16 a[208:209], v11 offset:448
    buffer_load_dwordx4 v6, s[12:15], s36 offen offset:2048 lds
    v_mfma_f32_16x16x32_bf16 v[164:167], a[192:195], a[28:31], v[164:167]
    s_waitcnt lgkmcnt(5)
    ds_read_b64_tr_b16 a[210:211], v11 offset:9664
    v_mfma_f32_16x16x32_bf16 a[112:115], a[196:199], a[24:27], a[112:115]
    ds_read_b64_tr_b16 a[212:213], v11 offset:18880
    v_mfma_f32_16x16x32_bf16 a[116:119], a[196:199], a[28:31], a[116:119]
    s_waitcnt lgkmcnt(5)
    ds_read_b64_tr_b16 a[214:215], v11 offset:28096
    v_mfma_f32_16x16x32_bf16 v[168:171], a[200:203], a[24:27], v[168:171]
    ds_read_b64_tr_b16 a[192:193], v18 offset:480
    v_mfma_f32_16x16x32_bf16 v[172:175], a[200:203], a[28:31], v[172:175]
    s_waitcnt lgkmcnt(5)
    ds_read_b64_tr_b16 a[194:195], v18 offset:9696
    v_mfma_f32_16x16x32_bf16 a[120:123], a[204:207], a[24:27], a[120:123]
    ds_read_b64_tr_b16 a[196:197], v18 offset:18912
    buffer_load_dwordx4 v7, s[12:15], s36 offen offset:3072 lds
    v_mfma_f32_16x16x32_bf16 a[124:127], a[204:207], a[28:31], a[124:127]
    s_waitcnt lgkmcnt(5)
    ds_read_b64_tr_b16 a[198:199], v18 offset:28128
    v_mfma_f32_16x16x32_bf16 v[176:179], a[208:211], a[24:27], v[176:179]
    s_add_u32 m0, s37, 45056
    ds_read_b64_tr_b16 a[200:201], v11 offset:512
    v_mfma_f32_16x16x32_bf16 v[180:183], a[208:211], a[28:31], v[180:183]
    s_waitcnt lgkmcnt(5)
    ds_read_b64_tr_b16 a[202:203], v11 offset:9728
    v_mfma_f32_16x16x32_bf16 a[128:131], a[212:215], a[24:27], a[128:131]
    ds_read_b64_tr_b16 a[204:205], v11 offset:18944
    v_mfma_f32_16x16x32_bf16 a[132:135], a[212:215], a[28:31], a[132:135]
    s_waitcnt lgkmcnt(5)
    ds_read_b64_tr_b16 a[206:207], v11 offset:28160
    v_mfma_f32_16x16x32_bf16 v[184:187], a[192:195], a[24:27], v[184:187]
    s_waitcnt vmcnt(20)
    ds_read_b64_tr_b16 a[208:209], v18 offset:544
    buffer_load_dwordx4 v8, s[12:15], s36 offen offset:0 lds
    v_mfma_f32_16x16x32_bf16 v[188:191], a[192:195], a[28:31], v[188:191]
    s_waitcnt lgkmcnt(5)
    ds_read_b64_tr_b16 a[210:211], v18 offset:9760
    v_mfma_f32_16x16x32_bf16 a[136:139], a[196:199], a[24:27], a[136:139]
    s_add_u32 s36, s36, 294912
    ds_read_b64_tr_b16 a[212:213], v18 offset:18976
    v_mfma_f32_16x16x32_bf16 a[140:143], a[196:199], a[28:31], a[140:143]
    s_waitcnt lgkmcnt(5)
    ds_read_b64_tr_b16 a[214:215], v18 offset:28192
    v_mfma_f32_16x16x32_bf16 v[192:195], a[200:203], a[24:27], v[192:195]
    s_waitcnt vmcnt(12)
    s_barrier
    ds_read_b64_tr_b16 a[192:193], v9 offset:0
    v_mfma_f32_16x16x32_bf16 v[196:199], a[200:203], a[28:31], v[196:199]
    s_waitcnt lgkmcnt(5)
    ds_read_b64_tr_b16 a[194:195], v9 offset:9216
    v_mfma_f32_16x16x32_bf16 a[144:147], a[204:207], a[24:27], a[144:147]
    ds_read_b64_tr_b16 a[196:197], v9 offset:18432
    v_mfma_f32_16x16x32_bf16 a[148:151], a[204:207], a[28:31], a[148:151]
    s_waitcnt lgkmcnt(5)
    ds_read_b64_tr_b16 a[198:199], v9 offset:27648
    v_mfma_f32_16x16x32_bf16 v[200:203], a[208:211], a[24:27], v[200:203]
    ds_read_b64_tr_b16 a[200:201], v16 offset:32
    v_mfma_f32_16x16x32_bf16 v[204:207], a[208:211], a[28:31], v[204:207]
    s_waitcnt lgkmcnt(5)
    ds_read_b64_tr_b16 a[202:203], v16 offset:9248
    v_mfma_f32_16x16x32_bf16 a[152:155], a[212:215], a[24:27], a[152:155]
    ds_read_b64_tr_b16 a[204:205], v16 offset:18464
    v_mfma_f32_16x16x32_bf16 a[156:159], a[212:215], a[28:31], a[156:159]
    s_waitcnt lgkmcnt(5)
    ds_read_b64_tr_b16 a[206:207], v16 offset:27680
    s_add_u32 s41, s41, 1
    s_cmp_lt_u32 s41, 4
    s_cbranch_scc1 Kloop_35
    v_mfma_f32_16x16x32_bf16 v[64:67], a[192:195], a[0:3], v[64:67]
    ds_read_b64_tr_b16 a[208:209], v9 offset:64
    v_accvgpr_read_b32 v0, a236
    v_mfma_f32_16x16x32_bf16 v[68:71], a[192:195], a[4:7], v[68:71]
    s_waitcnt lgkmcnt(5)
    ds_read_b64_tr_b16 a[210:211], v9 offset:9280
    v_mfma_f32_16x16x32_bf16 v[208:211], a[196:199], a[0:3], v[208:211]
    s_add_u32 m0, s40, 73728
    ds_read_b64_tr_b16 a[212:213], v9 offset:18496
    v_mfma_f32_16x16x32_bf16 v[212:215], a[196:199], a[4:7], v[212:215]
    s_waitcnt lgkmcnt(5)
    ds_read_b64_tr_b16 a[214:215], v9 offset:27712
    v_mfma_f32_16x16x32_bf16 v[72:75], a[200:203], a[0:3], v[72:75]
    s_add_u32 s39, s38, 0
    ds_read_b64_tr_b16 a[192:193], v16 offset:96
    v_mfma_f32_16x16x32_bf16 v[76:79], a[200:203], a[4:7], v[76:79]
    s_waitcnt lgkmcnt(5)
    ds_read_b64_tr_b16 a[194:195], v16 offset:9312
    v_mfma_f32_16x16x32_bf16 v[216:219], a[204:207], a[0:3], v[216:219]
    ds_read_b64_tr_b16 a[196:197], v16 offset:18528
    buffer_load_dwordx4 v0, s[16:19], s39 offen lds
    v_mfma_f32_16x16x32_bf16 v[220:223], a[204:207], a[4:7], v[220:223]
    s_waitcnt lgkmcnt(5)
    ds_read_b64_tr_b16 a[198:199], v16 offset:27744
    v_mfma_f32_16x16x32_bf16 v[80:83], a[208:211], a[0:3], v[80:83]
    s_add_u32 m0, s40, 77824
    ds_read_b64_tr_b16 a[200:201], v9 offset:128
    v_mfma_f32_16x16x32_bf16 v[84:87], a[208:211], a[4:7], v[84:87]
    s_waitcnt lgkmcnt(5)
    ds_read_b64_tr_b16 a[202:203], v9 offset:9344
    v_mfma_f32_16x16x32_bf16 v[224:227], a[212:215], a[0:3], v[224:227]
    s_add_u32 s39, s38, 128
    ds_read_b64_tr_b16 a[204:205], v9 offset:18560
    v_mfma_f32_16x16x32_bf16 v[228:231], a[212:215], a[4:7], v[228:231]
    s_waitcnt lgkmcnt(5)
    ds_read_b64_tr_b16 a[206:207], v9 offset:27776
    v_mfma_f32_16x16x32_bf16 v[88:91], a[192:195], a[0:3], v[88:91]
    ds_read_b64_tr_b16 a[208:209], v16 offset:160
    buffer_load_dwordx4 v0, s[16:19], s39 offen lds
    v_mfma_f32_16x16x32_bf16 v[92:95], a[192:195], a[4:7], v[92:95]
    s_waitcnt lgkmcnt(5)
    ds_read_b64_tr_b16 a[210:211], v16 offset:9376
    v_mfma_f32_16x16x32_bf16 v[232:235], a[196:199], a[0:3], v[232:235]
    s_add_u32 m0, s40, 81920
    ds_read_b64_tr_b16 a[212:213], v16 offset:18592
    v_mfma_f32_16x16x32_bf16 v[236:239], a[196:199], a[4:7], v[236:239]
    s_waitcnt lgkmcnt(5)
    ds_read_b64_tr_b16 a[214:215], v16 offset:27808
    v_mfma_f32_16x16x32_bf16 v[96:99], a[200:203], a[0:3], v[96:99]
    s_add_u32 s39, s38, 36864
    ds_read_b64_tr_b16 a[192:193], v9 offset:192
    v_mfma_f32_16x16x32_bf16 v[100:103], a[200:203], a[4:7], v[100:103]
    s_waitcnt lgkmcnt(5)
    ds_read_b64_tr_b16 a[194:195], v9 offset:9408
    v_mfma_f32_16x16x32_bf16 v[240:243], a[204:207], a[0:3], v[240:243]
    ds_read_b64_tr_b16 a[196:197], v9 offset:18624
    buffer_load_dwordx4 v0, s[16:19], s39 offen lds
    v_mfma_f32_16x16x32_bf16 v[244:247], a[204:207], a[4:7], v[244:247]
    s_waitcnt lgkmcnt(5)
    ds_read_b64_tr_b16 a[198:199], v9 offset:27840
    v_mfma_f32_16x16x32_bf16 v[104:107], a[208:211], a[0:3], v[104:107]
    s_add_u32 m0, s40, 86016
    ds_read_b64_tr_b16 a[200:201], v16 offset:224
    v_mfma_f32_16x16x32_bf16 v[108:111], a[208:211], a[4:7], v[108:111]
    s_waitcnt lgkmcnt(5)
    ds_read_b64_tr_b16 a[202:203], v16 offset:9440
    v_mfma_f32_16x16x32_bf16 v[248:251], a[212:215], a[0:3], v[248:251]
    s_add_u32 s39, s38, 36992
    ds_read_b64_tr_b16 a[204:205], v16 offset:18656
    v_mfma_f32_16x16x32_bf16 v[252:255], a[212:215], a[4:7], v[252:255]
    s_waitcnt lgkmcnt(5)
    ds_read_b64_tr_b16 a[206:207], v16 offset:27872
    v_mfma_f32_16x16x32_bf16 v[112:115], a[192:195], a[0:3], v[112:115]
    ds_read_b64_tr_b16 a[208:209], v9 offset:256
    buffer_load_dwordx4 v0, s[16:19], s39 offen lds
    v_mfma_f32_16x16x32_bf16 v[116:119], a[192:195], a[4:7], v[116:119]
    s_waitcnt lgkmcnt(5)
    ds_read_b64_tr_b16 a[210:211], v9 offset:9472
    v_mfma_f32_16x16x32_bf16 v[32:35], a[196:199], a[0:3], v[32:35]
    s_add_u32 m0, s40, 90112
    ds_read_b64_tr_b16 a[212:213], v9 offset:18688
    v_mfma_f32_16x16x32_bf16 v[36:39], a[196:199], a[4:7], v[36:39]
    s_waitcnt lgkmcnt(5)
    ds_read_b64_tr_b16 a[214:215], v9 offset:27904
    v_mfma_f32_16x16x32_bf16 v[120:123], a[200:203], a[0:3], v[120:123]
    s_add_u32 s39, s38, 73728
    ds_read_b64_tr_b16 a[192:193], v16 offset:288
    v_mfma_f32_16x16x32_bf16 v[124:127], a[200:203], a[4:7], v[124:127]
    s_waitcnt lgkmcnt(5)
    ds_read_b64_tr_b16 a[194:195], v16 offset:9504
    v_mfma_f32_16x16x32_bf16 v[40:43], a[204:207], a[0:3], v[40:43]
    ds_read_b64_tr_b16 a[196:197], v16 offset:18720
    buffer_load_dwordx4 v0, s[16:19], s39 offen lds
    v_mfma_f32_16x16x32_bf16 v[44:47], a[204:207], a[4:7], v[44:47]
    s_waitcnt lgkmcnt(5)
    ds_read_b64_tr_b16 a[198:199], v16 offset:27936
    v_mfma_f32_16x16x32_bf16 v[128:131], a[208:211], a[0:3], v[128:131]
    s_add_u32 m0, s40, 94208
    ds_read_b64_tr_b16 a[200:201], v9 offset:320
    v_mfma_f32_16x16x32_bf16 v[132:135], a[208:211], a[4:7], v[132:135]
    s_waitcnt lgkmcnt(5)
    ds_read_b64_tr_b16 a[202:203], v9 offset:9536
    v_mfma_f32_16x16x32_bf16 v[48:51], a[212:215], a[0:3], v[48:51]
    s_add_u32 s39, s38, 73856
    ds_read_b64_tr_b16 a[204:205], v9 offset:18752
    v_mfma_f32_16x16x32_bf16 v[52:55], a[212:215], a[4:7], v[52:55]
    s_waitcnt lgkmcnt(5)
    ds_read_b64_tr_b16 a[206:207], v9 offset:27968
    v_mfma_f32_16x16x32_bf16 v[136:139], a[192:195], a[0:3], v[136:139]
    ds_read_b64_tr_b16 a[208:209], v16 offset:352
    buffer_load_dwordx4 v0, s[16:19], s39 offen lds
    v_mfma_f32_16x16x32_bf16 v[140:143], a[192:195], a[4:7], v[140:143]
    s_waitcnt lgkmcnt(5)
    ds_read_b64_tr_b16 a[210:211], v16 offset:9568
    v_mfma_f32_16x16x32_bf16 v[56:59], a[196:199], a[0:3], v[56:59]
    s_add_u32 m0, s40, 98304
    ds_read_b64_tr_b16 a[212:213], v16 offset:18784
    v_mfma_f32_16x16x32_bf16 v[60:63], a[196:199], a[4:7], v[60:63]
    s_waitcnt lgkmcnt(5)
    ds_read_b64_tr_b16 a[214:215], v16 offset:28000
    v_mfma_f32_16x16x32_bf16 v[144:147], a[200:203], a[0:3], v[144:147]
    s_add_u32 s39, s38, 110592
    ds_read_b64_tr_b16 a[192:193], v9 offset:384
    v_mfma_f32_16x16x32_bf16 v[148:151], a[200:203], a[4:7], v[148:151]
    s_waitcnt lgkmcnt(5)
    ds_read_b64_tr_b16 a[194:195], v9 offset:9600
    v_mfma_f32_16x16x32_bf16 a[96:99], a[204:207], a[0:3], a[96:99]
    ds_read_b64_tr_b16 a[196:197], v9 offset:18816
    buffer_load_dwordx4 v0, s[16:19], s39 offen lds
    v_mfma_f32_16x16x32_bf16 a[100:103], a[204:207], a[4:7], a[100:103]
    s_waitcnt lgkmcnt(5)
    ds_read_b64_tr_b16 a[198:199], v9 offset:28032
    v_mfma_f32_16x16x32_bf16 v[152:155], a[208:211], a[0:3], v[152:155]
    s_add_u32 m0, s40, 102400
    ds_read_b64_tr_b16 a[200:201], v16 offset:416
    v_mfma_f32_16x16x32_bf16 v[156:159], a[208:211], a[4:7], v[156:159]
    s_waitcnt lgkmcnt(5)
    ds_read_b64_tr_b16 a[202:203], v16 offset:9632
    v_mfma_f32_16x16x32_bf16 a[104:107], a[212:215], a[0:3], a[104:107]
    s_add_u32 s39, s38, 110720
    ds_read_b64_tr_b16 a[204:205], v16 offset:18848
    v_mfma_f32_16x16x32_bf16 a[108:111], a[212:215], a[4:7], a[108:111]
    s_waitcnt lgkmcnt(5)
    ds_read_b64_tr_b16 a[206:207], v16 offset:28064
    v_mfma_f32_16x16x32_bf16 v[160:163], a[192:195], a[0:3], v[160:163]
    ds_read_b64_tr_b16 a[208:209], v9 offset:448
    buffer_load_dwordx4 v0, s[16:19], s39 offen lds
    v_mfma_f32_16x16x32_bf16 v[164:167], a[192:195], a[4:7], v[164:167]
    s_waitcnt lgkmcnt(5)
    ds_read_b64_tr_b16 a[210:211], v9 offset:9664
    v_mfma_f32_16x16x32_bf16 a[112:115], a[196:199], a[0:3], a[112:115]
    s_add_u32 m0, s40, 106496
    ds_read_b64_tr_b16 a[212:213], v9 offset:18880
    v_mfma_f32_16x16x32_bf16 a[116:119], a[196:199], a[4:7], a[116:119]
    s_waitcnt lgkmcnt(5)
    ds_read_b64_tr_b16 a[214:215], v9 offset:28096
    v_mfma_f32_16x16x32_bf16 v[168:171], a[200:203], a[0:3], v[168:171]
    s_add_u32 s39, s38, 147456
    ds_read_b64_tr_b16 a[192:193], v16 offset:480
    v_mfma_f32_16x16x32_bf16 v[172:175], a[200:203], a[4:7], v[172:175]
    s_waitcnt lgkmcnt(5)
    ds_read_b64_tr_b16 a[194:195], v16 offset:9696
    v_mfma_f32_16x16x32_bf16 a[120:123], a[204:207], a[0:3], a[120:123]
    ds_read_b64_tr_b16 a[196:197], v16 offset:18912
    buffer_load_dwordx4 v0, s[16:19], s39 offen lds
    v_mfma_f32_16x16x32_bf16 a[124:127], a[204:207], a[4:7], a[124:127]
    s_waitcnt lgkmcnt(5)
    ds_read_b64_tr_b16 a[198:199], v16 offset:28128
    v_accvgpr_read_b32 v1, a237
    v_mfma_f32_16x16x32_bf16 v[176:179], a[208:211], a[0:3], v[176:179]
    ds_read_b64_tr_b16 a[200:201], v9 offset:512
    v_accvgpr_read_b32 v2, a238
    v_mfma_f32_16x16x32_bf16 v[180:183], a[208:211], a[4:7], v[180:183]
    s_waitcnt lgkmcnt(5)
    ds_read_b64_tr_b16 a[202:203], v9 offset:9728
    v_accvgpr_read_b32 v3, a239
    v_mfma_f32_16x16x32_bf16 a[128:131], a[212:215], a[0:3], a[128:131]
    ds_read_b64_tr_b16 a[204:205], v9 offset:18944
    v_accvgpr_read_b32 v4, a240
    v_mfma_f32_16x16x32_bf16 a[132:135], a[212:215], a[4:7], a[132:135]
    s_waitcnt lgkmcnt(5)
    ds_read_b64_tr_b16 a[206:207], v9 offset:28160
    v_lshlrev_b32 v29, 4, v30
    v_mfma_f32_16x16x32_bf16 v[184:187], a[192:195], a[0:3], v[184:187]
    s_lshl_b32 s43, s2, 2
    ds_read_b64_tr_b16 a[208:209], v16 offset:544
    v_mfma_f32_16x16x32_bf16 v[188:191], a[192:195], a[4:7], v[188:191]
    s_waitcnt lgkmcnt(5)
    ds_read_b64_tr_b16 a[210:211], v16 offset:9760
    v_mfma_f32_16x16x32_bf16 a[136:139], a[196:199], a[0:3], a[136:139]
    s_add_u32 s43, s43, s30
    ds_read_b64_tr_b16 a[212:213], v16 offset:18976
    v_mfma_f32_16x16x32_bf16 a[140:143], a[196:199], a[4:7], a[140:143]
    s_waitcnt lgkmcnt(5)
    ds_read_b64_tr_b16 a[214:215], v16 offset:28192
    s_mul_i32 s43, s43, 18432
    s_add_u32 s43, s43, 54525952
    s_xor_b32 s52, s2, 8
    s_lshl_b32 s52, s52, 2
    s_add_u32 s52, s52, s30
    s_mul_i32 s52, s52, 18432
    s_add_u32 s52, s52, 54525952
    s_lshr_b32 s50, s31, 1
    s_lshl_b32 s51, s32, 4
    s_add_u32 s50, s50, s51
    s_lshl_b32 s50, s50, 9
    s_add_u32 s50, s50, 46149632
    v_mfma_f32_16x16x32_bf16 v[192:195], a[200:203], a[0:3], v[192:195]
    s_waitcnt vmcnt(9)
    s_barrier
    ds_read_b64_tr_b16 a[192:193], v9 offset:36864
    v_mfma_f32_16x16x32_bf16 v[196:199], a[200:203], a[4:7], v[196:199]
    s_waitcnt lgkmcnt(5)
    ds_read_b64_tr_b16 a[194:195], v9 offset:46080
    v_mfma_f32_16x16x32_bf16 a[144:147], a[204:207], a[0:3], a[144:147]
    ds_read_b64_tr_b16 a[196:197], v10 offset:0
    v_mfma_f32_16x16x32_bf16 a[148:151], a[204:207], a[4:7], a[148:151]
    s_waitcnt lgkmcnt(5)
    ds_read_b64_tr_b16 a[198:199], v10 offset:9216
    v_mfma_f32_16x16x32_bf16 v[200:203], a[208:211], a[0:3], v[200:203]
    ds_read_b64_tr_b16 a[200:201], v16 offset:36896
    v_mfma_f32_16x16x32_bf16 v[204:207], a[208:211], a[4:7], v[204:207]
    s_waitcnt lgkmcnt(5)
    ds_read_b64_tr_b16 a[202:203], v16 offset:46112
    v_mfma_f32_16x16x32_bf16 a[152:155], a[212:215], a[0:3], a[152:155]
    ds_read_b64_tr_b16 a[204:205], v17 offset:32
    v_mfma_f32_16x16x32_bf16 a[156:159], a[212:215], a[4:7], a[156:159]
    s_waitcnt lgkmcnt(5)
    ds_read_b64_tr_b16 a[206:207], v17 offset:9248
    v_mfma_f32_16x16x32_bf16 v[64:67], a[192:195], a[8:11], v[64:67]
    s_add_u32 m0, s40, 110592
    ds_read_b64_tr_b16 a[208:209], v9 offset:36928
    v_mfma_f32_16x16x32_bf16 v[68:71], a[192:195], a[12:15], v[68:71]
    s_waitcnt lgkmcnt(5)
    ds_read_b64_tr_b16 a[210:211], v9 offset:46144
    v_mfma_f32_16x16x32_bf16 v[208:211], a[196:199], a[8:11], v[208:211]
    s_add_u32 s39, s38, 147584
    ds_read_b64_tr_b16 a[212:213], v10 offset:64
    v_mfma_f32_16x16x32_bf16 v[212:215], a[196:199], a[12:15], v[212:215]
    s_waitcnt lgkmcnt(5)
    ds_read_b64_tr_b16 a[214:215], v10 offset:9280
    buffer_load_dwordx4 v0, s[16:19], s39 offen lds
    v_mfma_f32_16x16x32_bf16 v[72:75], a[200:203], a[8:11], v[72:75]
    s_add_u32 m0, s40, 114688
    ds_read_b64_tr_b16 a[192:193], v16 offset:36960
    v_mfma_f32_16x16x32_bf16 v[76:79], a[200:203], a[12:15], v[76:79]
    s_waitcnt lgkmcnt(5)
    ds_read_b64_tr_b16 a[194:195], v16 offset:46176
    v_mfma_f32_16x16x32_bf16 v[216:219], a[204:207], a[8:11], v[216:219]
    s_add_u32 s39, s38, 184320
    ds_read_b64_tr_b16 a[196:197], v17 offset:96
    buffer_load_dwordx4 v0, s[16:19], s39 offen lds
    v_mfma_f32_16x16x32_bf16 v[220:223], a[204:207], a[12:15], v[220:223]
    s_waitcnt lgkmcnt(5)
    ds_read_b64_tr_b16 a[198:199], v17 offset:9312
    v_mfma_f32_16x16x32_bf16 v[80:83], a[208:211], a[8:11], v[80:83]
    s_add_u32 m0, s40, 118784
    ds_read_b64_tr_b16 a[200:201], v9 offset:36992
    v_mfma_f32_16x16x32_bf16 v[84:87], a[208:211], a[12:15], v[84:87]
    s_waitcnt lgkmcnt(5)
    ds_read_b64_tr_b16 a[202:203], v9 offset:46208
    v_mfma_f32_16x16x32_bf16 v[224:227], a[212:215], a[8:11], v[224:227]
    s_add_u32 s39, s38, 184448
    ds_read_b64_tr_b16 a[204:205], v10 offset:128
    v_mfma_f32_16x16x32_bf16 v[228:231], a[212:215], a[12:15], v[228:231]
    s_waitcnt lgkmcnt(5)
    ds_read_b64_tr_b16 a[206:207], v10 offset:9344
    v_mfma_f32_16x16x32_bf16 v[88:91], a[192:195], a[8:11], v[88:91]
    ds_read_b64_tr_b16 a[208:209], v16 offset:37024
    buffer_load_dwordx4 v0, s[16:19], s39 offen lds
    v_mfma_f32_16x16x32_bf16 v[92:95], a[192:195], a[12:15], v[92:95]
    s_waitcnt lgkmcnt(5)
    ds_read_b64_tr_b16 a[210:211], v16 offset:46240
    v_max_f32_e32 v64, 0, v64
    v_mfma_f32_16x16x32_bf16 v[232:235], a[196:199], a[8:11], v[232:235]
    s_add_u32 m0, s40, 122880
    ds_read_b64_tr_b16 a[212:213], v17 offset:160
    v_max_f32_e32 v65, 0, v65
    v_mfma_f32_16x16x32_bf16 v[236:239], a[196:199], a[12:15], v[236:239]
    s_waitcnt lgkmcnt(5)
    ds_read_b64_tr_b16 a[214:215], v17 offset:9376
    v_max_f32_e32 v66, 0, v66
    v_mfma_f32_16x16x32_bf16 v[96:99], a[200:203], a[8:11], v[96:99]
    s_add_u32 s39, s38, 221184
    ds_read_b64_tr_b16 a[192:193], v9 offset:37056
    v_max_f32_e32 v67, 0, v67
    v_mfma_f32_16x16x32_bf16 v[100:103], a[200:203], a[12:15], v[100:103]
    s_waitcnt lgkmcnt(5)
    ds_read_b64_tr_b16 a[194:195], v9 offset:46272
    v_mul_f32_e32 v64, v64, v208
    v_mfma_f32_16x16x32_bf16 v[240:243], a[204:207], a[8:11], v[240:243]
    ds_read_b64_tr_b16 a[196:197], v10 offset:192
    buffer_load_dwordx4 v0, s[16:19], s39 offen lds
    v_mfma_f32_16x16x32_bf16 v[244:247], a[204:207], a[12:15], v[244:247]
    s_waitcnt lgkmcnt(5)
    ds_read_b64_tr_b16 a[198:199], v10 offset:9408
    v_mul_f32_e32 v65, v65, v209
    v_mfma_f32_16x16x32_bf16 v[104:107], a[208:211], a[8:11], v[104:107]
    s_add_u32 m0, s40, 126976
    ds_read_b64_tr_b16 a[200:201], v16 offset:37088
    v_mul_f32_e32 v66, v66, v210
    v_mul_f32_e32 v67, v67, v211
    v_mfma_f32_16x16x32_bf16 v[108:111], a[208:211], a[12:15], v[108:111]
    s_waitcnt lgkmcnt(5)
    ds_read_b64_tr_b16 a[202:203], v16 offset:46304
    v_cvt_pk_bf16_f32 v64, v64, v65
    v_cvt_pk_bf16_f32 v65, v66, v67
    v_mfma_f32_16x16x32_bf16 v[248:251], a[212:215], a[8:11], v[248:251]
    s_add_u32 s39, s38, 221312
    ds_read_b64_tr_b16 a[204:205], v17 offset:224
    v_max_f32_e32 v72, 0, v72
    v_max_f32_e32 v73, 0, v73
    v_mfma_f32_16x16x32_bf16 v[252:255], a[212:215], a[12:15], v[252:255]
    s_waitcnt lgkmcnt(5)
    ds_read_b64_tr_b16 a[206:207], v17 offset:9440
    v_max_f32_e32 v74, 0, v74
    v_max_f32_e32 v75, 0, v75
    v_mfma_f32_16x16x32_bf16 v[112:115], a[192:195], a[8:11], v[112:115]
    ds_read_b64_tr_b16 a[208:209], v9 offset:37120
    buffer_load_dwordx4 v0, s[16:19], s39 offen lds
    v_mul_f32_e32 v72, v72, v216
    v_mfma_f32_16x16x32_bf16 v[116:119], a[192:195], a[12:15], v[116:119]
    s_waitcnt lgkmcnt(5)
    ds_read_b64_tr_b16 a[210:211], v9 offset:46336
    v_mul_f32_e32 v73, v73, v217
    v_mul_f32_e32 v74, v74, v218
    v_mfma_f32_16x16x32_bf16 v[32:35], a[196:199], a[8:11], v[32:35]
    s_add_u32 m0, s40, 131072
    ds_read_b64_tr_b16 a[212:213], v10 offset:256
    v_mul_f32_e32 v75, v75, v219
    v_cvt_pk_bf16_f32 v66, v72, v73
    v_mfma_f32_16x16x32_bf16 v[36:39], a[196:199], a[12:15], v[36:39]
    s_waitcnt lgkmcnt(5)
    ds_read_b64_tr_b16 a[214:215], v10 offset:9472
    v_cvt_pk_bf16_f32 v67, v74, v75
    buffer_store_dwordx4 v[64:67], v29, s[20:23], s43 offen offset:0 sc1
    v_mfma_f32_16x16x32_bf16 v[120:123], a[200:203], a[8:11], v[120:123]
    s_add_u32 s39, s38, 258048
    ds_read_b64_tr_b16 a[192:193], v16 offset:37152
    v_max_f32_e32 v68, 0, v68
    v_max_f32_e32 v69, 0, v69
    v_mfma_f32_16x16x32_bf16 v[124:127], a[200:203], a[12:15], v[124:127]
    s_waitcnt lgkmcnt(5)
    ds_read_b64_tr_b16 a[194:195], v16 offset:46368
    v_max_f32_e32 v70, 0, v70
    v_max_f32_e32 v71, 0, v71
    v_mfma_f32_16x16x32_bf16 v[40:43], a[204:207], a[8:11], v[40:43]
    ds_read_b64_tr_b16 a[196:197], v17 offset:288
    buffer_load_dwordx4 v0, s[16:19], s39 offen lds
    v_mul_f32_e32 v68, v68, v212
    v_mfma_f32_16x16x32_bf16 v[44:47], a[204:207], a[12:15], v[44:47]
    s_waitcnt lgkmcnt(5)
    ds_read_b64_tr_b16 a[198:199], v17 offset:9504
    v_mul_f32_e32 v69, v69, v213
    v_mul_f32_e32 v70, v70, v214
    v_mfma_f32_16x16x32_bf16 v[128:131], a[208:211], a[8:11], v[128:131]
    s_add_u32 m0, s40, 135168
    ds_read_b64_tr_b16 a[200:201], v9 offset:37184
    v_mul_f32_e32 v71, v71, v215
    v_cvt_pk_bf16_f32 v68, v68, v69
    v_mfma_f32_16x16x32_bf16 v[132:135], a[208:211], a[12:15], v[132:135]
    s_waitcnt lgkmcnt(5)
    ds_read_b64_tr_b16 a[202:203], v9 offset:46400
    v_cvt_pk_bf16_f32 v69, v70, v71
    v_max_f32_e32 v76, 0, v76
    v_mfma_f32_16x16x32_bf16 v[48:51], a[212:215], a[8:11], v[48:51]
    s_add_u32 s39, s38, 258176
    ds_read_b64_tr_b16 a[204:205], v10 offset:320
    v_max_f32_e32 v77, 0, v77
    v_max_f32_e32 v78, 0, v78
    v_mfma_f32_16x16x32_bf16 v[52:55], a[212:215], a[12:15], v[52:55]
    s_waitcnt lgkmcnt(5)
    ds_read_b64_tr_b16 a[206:207], v10 offset:9536
    v_max_f32_e32 v79, 0, v79
    v_mul_f32_e32 v76, v76, v220
    v_mfma_f32_16x16x32_bf16 v[136:139], a[192:195], a[8:11], v[136:139]
    ds_read_b64_tr_b16 a[208:209], v16 offset:37216
    buffer_load_dwordx4 v0, s[16:19], s39 offen lds
    v_mul_f32_e32 v77, v77, v221
    v_mfma_f32_16x16x32_bf16 v[140:143], a[192:195], a[12:15], v[140:143]
    s_waitcnt lgkmcnt(5)
    ds_read_b64_tr_b16 a[210:211], v16 offset:46432
    v_mul_f32_e32 v78, v78, v222
    v_mul_f32_e32 v79, v79, v223
    v_mfma_f32_16x16x32_bf16 v[56:59], a[196:199], a[8:11], v[56:59]
    s_add_u32 m0, s40, 139264
    ds_read_b64_tr_b16 a[212:213], v17 offset:352
    v_cvt_pk_bf16_f32 v70, v76, v77
    v_cvt_pk_bf16_f32 v71, v78, v79
    v_mfma_f32_16x16x32_bf16 v[60:63], a[196:199], a[12:15], v[60:63]
    s_waitcnt lgkmcnt(5)
    ds_read_b64_tr_b16 a[214:215], v17 offset:9568
    buffer_store_dwordx4 v[68:71], v29, s[20:23], s43 offen offset:1024 sc1
    v_mfma_f32_16x16x32_bf16 v[144:147], a[200:203], a[8:11], v[144:147]
    s_add_u32 s39, s38, 294912
    ds_read_b64_tr_b16 a[192:193], v9 offset:37248
    v_mfma_f32_16x16x32_bf16 v[148:151], a[200:203], a[12:15], v[148:151]
    s_waitcnt lgkmcnt(5)
    ds_read_b64_tr_b16 a[194:195], v9 offset:46464
    v_mfma_f32_16x16x32_bf16 a[96:99], a[204:207], a[8:11], a[96:99]
    s_add_u32 s43, s43, 2048
    ds_read_b64_tr_b16 a[196:197], v10 offset:384
    buffer_load_dwordx4 v0, s[16:19], s39 offen lds
    v_max_f32_e32 v80, 0, v80
    v_mfma_f32_16x16x32_bf16 a[100:103], a[204:207], a[12:15], a[100:103]
    s_waitcnt lgkmcnt(5)
    ds_read_b64_tr_b16 a[198:199], v10 offset:9600
    v_max_f32_e32 v81, 0, v81
    v_max_f32_e32 v82, 0, v82
    v_mfma_f32_16x16x32_bf16 v[152:155], a[208:211], a[8:11], v[152:155]
    s_add_u32 m0, s40, 143360
    ds_read_b64_tr_b16 a[200:201], v16 offset:37280
    v_max_f32_e32 v83, 0, v83
    v_mul_f32_e32 v80, v80, v224
    v_mfma_f32_16x16x32_bf16 v[156:159], a[208:211], a[12:15], v[156:159]
    s_waitcnt lgkmcnt(5)
    ds_read_b64_tr_b16 a[202:203], v16 offset:46496
    v_mul_f32_e32 v81, v81, v225
    v_mul_f32_e32 v82, v82, v226
    v_mfma_f32_16x16x32_bf16 a[104:107], a[212:215], a[8:11], a[104:107]
    s_add_u32 s39, s38, 295040
    ds_read_b64_tr_b16 a[204:205], v17 offset:416
    v_mul_f32_e32 v83, v83, v227
    v_cvt_pk_bf16_f32 v80, v80, v81
    v_mfma_f32_16x16x32_bf16 a[108:111], a[212:215], a[12:15], a[108:111]
    s_waitcnt lgkmcnt(5)
    ds_read_b64_tr_b16 a[206:207], v17 offset:9632
    v_cvt_pk_bf16_f32 v81, v82, v83
    v_max_f32_e32 v88, 0, v88
    v_mfma_f32_16x16x32_bf16 v[160:163], a[192:195], a[8:11], v[160:163]
    ds_read_b64_tr_b16 a[208:209], v9 offset:37312
    buffer_load_dwordx4 v0, s[16:19], s39 offen lds
    v_max_f32_e32 v89, 0, v89
    v_mfma_f32_16x16x32_bf16 v[164:167], a[192:195], a[12:15], v[164:167]
    s_waitcnt lgkmcnt(5)
    ds_read_b64_tr_b16 a[210:211], v9 offset:46528
    v_max_f32_e32 v90, 0, v90
    v_max_f32_e32 v91, 0, v91
    v_mfma_f32_16x16x32_bf16 a[112:115], a[196:199], a[8:11], a[112:115]
    ds_read_b64_tr_b16 a[212:213], v10 offset:448
    v_mul_f32_e32 v88, v88, v232
    v_mul_f32_e32 v89, v89, v233
    v_mfma_f32_16x16x32_bf16 a[116:119], a[196:199], a[12:15], a[116:119]
    s_waitcnt lgkmcnt(5)
    ds_read_b64_tr_b16 a[214:215], v10 offset:9664
    v_mul_f32_e32 v90, v90, v234
    v_mul_f32_e32 v91, v91, v235
    v_mfma_f32_16x16x32_bf16 v[168:171], a[200:203], a[8:11], v[168:171]
    ds_read_b64_tr_b16 a[192:193], v16 offset:37344
    v_cvt_pk_bf16_f32 v82, v88, v89
    v_cvt_pk_bf16_f32 v83, v90, v91
    v_mfma_f32_16x16x32_bf16 v[172:175], a[200:203], a[12:15], v[172:175]
    s_waitcnt lgkmcnt(5)
    ds_read_b64_tr_b16 a[194:195], v16 offset:46560
    buffer_store_dwordx4 v[80:83], v29, s[20:23], s43 offen offset:0 sc1
    v_max_f32_e32 v84, 0, v84
    v_mfma_f32_16x16x32_bf16 a[120:123], a[204:207], a[8:11], a[120:123]
    ds_read_b64_tr_b16 a[196:197], v17 offset:480
    v_max_f32_e32 v85, 0, v85
    v_max_f32_e32 v86, 0, v86
    v_mfma_f32_16x16x32_bf16 a[124:127], a[204:207], a[12:15], a[124:127]
    s_waitcnt lgkmcnt(5)
    ds_read_b64_tr_b16 a[198:199], v17 offset:9696
    v_max_f32_e32 v87, 0, v87
    v_mul_f32_e32 v84, v84, v228
    v_mfma_f32_16x16x32_bf16 v[176:179], a[208:211], a[8:11], v[176:179]
    ds_read_b64_tr_b16 a[200:201], v9 offset:37376
    v_mul_f32_e32 v85, v85, v229
    v_mul_f32_e32 v86, v86, v230
    v_mfma_f32_16x16x32_bf16 v[180:183], a[208:211], a[12:15], v[180:183]
    s_waitcnt lgkmcnt(5)
    ds_read_b64_tr_b16 a[202:203], v9 offset:46592
    v_mul_f32_e32 v87, v87, v231
    v_cvt_pk_bf16_f32 v84, v84, v85
    v_mfma_f32_16x16x32_bf16 a[128:131], a[212:215], a[8:11], a[128:131]
    ds_read_b64_tr_b16 a[204:205], v10 offset:512
    v_cvt_pk_bf16_f32 v85, v86, v87
    v_max_f32_e32 v92, 0, v92
    v_mfma_f32_16x16x32_bf16 a[132:135], a[212:215], a[12:15], a[132:135]
    s_waitcnt lgkmcnt(5)
    ds_read_b64_tr_b16 a[206:207], v10 offset:9728
    v_max_f32_e32 v93, 0, v93
    v_max_f32_e32 v94, 0, v94
    v_mfma_f32_16x16x32_bf16 v[184:187], a[192:195], a[8:11], v[184:187]
    ds_read_b64_tr_b16 a[208:209], v16 offset:37408
    v_max_f32_e32 v95, 0, v95
    v_mul_f32_e32 v92, v92, v236
    v_mfma_f32_16x16x32_bf16 v[188:191], a[192:195], a[12:15], v[188:191]
    s_waitcnt lgkmcnt(5)
    ds_read_b64_tr_b16 a[210:211], v16 offset:46624
    v_mul_f32_e32 v93, v93, v237
    v_mul_f32_e32 v94, v94, v238
    v_mfma_f32_16x16x32_bf16 a[136:139], a[196:199], a[8:11], a[136:139]
    ds_read_b64_tr_b16 a[212:213], v17 offset:544
    v_mul_f32_e32 v95, v95, v239
    v_cvt_pk_bf16_f32 v86, v92, v93
    v_mfma_f32_16x16x32_bf16 a[140:143], a[196:199], a[12:15], a[140:143]
    s_waitcnt lgkmcnt(5)
    ds_read_b64_tr_b16 a[214:215], v17 offset:9760
    v_cvt_pk_bf16_f32 v87, v94, v95
    buffer_store_dwordx4 v[84:87], v29, s[20:23], s43 offen offset:1024 sc1
    v_mfma_f32_16x16x32_bf16 v[192:195], a[200:203], a[8:11], v[192:195]
    s_waitcnt vmcnt(13)
    s_barrier
    ds_read_b64_tr_b16 a[192:193], v1 offset:0
    v_mfma_f32_16x16x32_bf16 v[196:199], a[200:203], a[12:15], v[196:199]
    s_waitcnt lgkmcnt(5)
    ds_read_b64_tr_b16 a[194:195], v1 offset:2048
    v_mfma_f32_16x16x32_bf16 a[144:147], a[204:207], a[8:11], a[144:147]
    s_add_u32 s43, s43, 2048
    ds_read_b64_tr_b16 a[196:197], v2 offset:0
    v_max_f32_e32 v96, 0, v96
    v_max_f32_e32 v97, 0, v97
    v_mfma_f32_16x16x32_bf16 a[148:151], a[204:207], a[12:15], a[148:151]
    s_waitcnt lgkmcnt(5)
    ds_read_b64_tr_b16 a[198:199], v2 offset:2048
    v_max_f32_e32 v98, 0, v98
    v_max_f32_e32 v99, 0, v99
    v_mfma_f32_16x16x32_bf16 v[200:203], a[208:211], a[8:11], v[200:203]
    ds_read_b64_tr_b16 a[200:201], v3 offset:0
    v_mul_f32_e32 v96, v96, v240
    v_mul_f32_e32 v97, v97, v241
    v_mfma_f32_16x16x32_bf16 v[204:207], a[208:211], a[12:15], v[204:207]
    s_waitcnt lgkmcnt(5)
    ds_read_b64_tr_b16 a[202:203], v3 offset:2048
    v_mul_f32_e32 v98, v98, v242
    v_mul_f32_e32 v99, v99, v243
    v_mfma_f32_16x16x32_bf16 a[152:155], a[212:215], a[8:11], a[152:155]
    ds_read_b64_tr_b16 a[204:205], v4 offset:0
    v_cvt_pk_bf16_f32 v96, v96, v97
    v_cvt_pk_bf16_f32 v97, v98, v99
    v_mfma_f32_16x16x32_bf16 a[156:159], a[212:215], a[12:15], a[156:159]
    s_waitcnt lgkmcnt(5)
    ds_read_b64_tr_b16 a[206:207], v4 offset:2048
    v_max_f32_e32 v104, 0, v104
    v_max_f32_e32 v105, 0, v105
    v_mfma_f32_16x16x32_bf16 a[0:3], a[192:195], v[64:67], 0
    s_add_u32 m0, s40, 0
    ds_read_b64_tr_b16 a[208:209], v1 offset:4096
    v_max_f32_e32 v106, 0, v106
    v_max_f32_e32 v107, 0, v107
    v_mfma_f32_16x16x32_bf16 a[4:7], a[192:195], v[68:71], 0
    s_waitcnt lgkmcnt(5)
    ds_read_b64_tr_b16 a[210:211], v1 offset:6144
    v_mul_f32_e32 v104, v104, v248
    v_mul_f32_e32 v105, v105, v249
    v_mfma_f32_16x16x32_bf16 a[8:11], a[196:199], v[64:67], 0
    s_add_u32 s39, s38, 256
    ds_read_b64_tr_b16 a[212:213], v2 offset:4096
    v_mul_f32_e32 v106, v106, v250
    v_mul_f32_e32 v107, v107, v251
    v_mfma_f32_16x16x32_bf16 a[12:15], a[196:199], v[68:71], 0
    s_waitcnt lgkmcnt(5)
    ds_read_b64_tr_b16 a[214:215], v2 offset:6144
    buffer_load_dwordx4 v0, s[16:19], s39 offen lds
    v_cvt_pk_bf16_f32 v98, v104, v105
    v_mfma_f32_16x16x32_bf16 a[16:19], a[200:203], v[64:67], 0
    s_add_u32 m0, s40, 4096
    ds_read_b64_tr_b16 a[192:193], v3 offset:4096
    v_cvt_pk_bf16_f32 v99, v106, v107
    buffer_store_dwordx4 v[96:99], v29, s[20:23], s43 offen offset:0 sc1
    v_mfma_f32_16x16x32_bf16 a[20:23], a[200:203], v[68:71], 0
    s_waitcnt lgkmcnt(5)
    ds_read_b64_tr_b16 a[194:195], v3 offset:6144
    v_max_f32_e32 v100, 0, v100
    v_max_f32_e32 v101, 0, v101
    v_mfma_f32_16x16x32_bf16 a[24:27], a[204:207], v[64:67], 0
    s_add_u32 s39, s38, 37120
    ds_read_b64_tr_b16 a[196:197], v4 offset:4096
    buffer_load_dwordx4 v0, s[16:19], s39 offen lds
    v_max_f32_e32 v102, 0, v102
    v_mfma_f32_16x16x32_bf16 a[28:31], a[204:207], v[68:71], 0
    s_waitcnt lgkmcnt(5)
    ds_read_b64_tr_b16 a[198:199], v4 offset:6144
    v_max_f32_e32 v103, 0, v103
    v_mul_f32_e32 v100, v100, v244
    v_mfma_f32_16x16x32_bf16 a[32:35], a[208:211], v[64:67], 0
    s_add_u32 m0, s40, 8192
    ds_read_b64_tr_b16 a[200:201], v1 offset:8192
    v_mul_f32_e32 v101, v101, v245
    v_mul_f32_e32 v102, v102, v246
    v_mfma_f32_16x16x32_bf16 a[36:39], a[208:211], v[68:71], 0
    s_waitcnt lgkmcnt(5)
    ds_read_b64_tr_b16 a[202:203], v1 offset:10240
    v_mul_f32_e32 v103, v103, v247
    v_cvt_pk_bf16_f32 v100, v100, v101
    v_mfma_f32_16x16x32_bf16 a[40:43], a[212:215], v[64:67], 0
    s_add_u32 s39, s38, 73984
    ds_read_b64_tr_b16 a[204:205], v2 offset:8192
    v_cvt_pk_bf16_f32 v101, v102, v103
    v_max_f32_e32 v108, 0, v108
    v_mfma_f32_16x16x32_bf16 a[44:47], a[212:215], v[68:71], 0
    s_waitcnt lgkmcnt(5)
    ds_read_b64_tr_b16 a[206:207], v2 offset:10240
    v_max_f32_e32 v109, 0, v109
    v_max_f32_e32 v110, 0, v110
    v_mfma_f32_16x16x32_bf16 a[48:51], a[192:195], v[64:67], 0
    ds_read_b64_tr_b16 a[208:209], v3 offset:8192
    buffer_load_dwordx4 v0, s[16:19], s39 offen lds
    v_max_f32_e32 v111, 0, v111
    v_mfma_f32_16x16x32_bf16 a[52:55], a[192:195], v[68:71], 0
    s_waitcnt lgkmcnt(5)
    ds_read_b64_tr_b16 a[210:211], v3 offset:10240
    v_mul_f32_e32 v108, v108, v252
    v_mul_f32_e32 v109, v109, v253
    v_mfma_f32_16x16x32_bf16 a[56:59], a[196:199], v[64:67], 0
    s_add_u32 m0, s40, 12288
    ds_read_b64_tr_b16 a[212:213], v4 offset:8192
    v_mul_f32_e32 v110, v110, v254
    v_mul_f32_e32 v111, v111, v255
    v_mfma_f32_16x16x32_bf16 a[60:63], a[196:199], v[68:71], 0
    s_waitcnt lgkmcnt(5)
    ds_read_b64_tr_b16 a[214:215], v4 offset:10240
    v_cvt_pk_bf16_f32 v102, v108, v109
    v_cvt_pk_bf16_f32 v103, v110, v111
    v_mfma_f32_16x16x32_bf16 a[0:3], a[200:203], v[80:83], a[0:3]
    s_add_u32 s39, s38, 110848
    ds_read_b64_tr_b16 a[192:193], v1 offset:12288
    buffer_store_dwordx4 v[100:103], v29, s[20:23], s43 offen offset:1024 sc1
    v_mfma_f32_16x16x32_bf16 a[4:7], a[200:203], v[84:87], a[4:7]
    s_waitcnt lgkmcnt(5)
    ds_read_b64_tr_b16 a[194:195], v1 offset:14336
    v_mfma_f32_16x16x32_bf16 a[8:11], a[204:207], v[80:83], a[8:11]
    s_add_u32 s43, s43, 2048
    ds_read_b64_tr_b16 a[196:197], v2 offset:12288
    buffer_load_dwordx4 v0, s[16:19], s39 offen lds
    v_max_f32_e32 v112, 0, v112
    v_mfma_f32_16x16x32_bf16 a[12:15], a[204:207], v[84:87], a[12:15]
    s_waitcnt lgkmcnt(5)
    ds_read_b64_tr_b16 a[198:199], v2 offset:14336
    v_max_f32_e32 v113, 0, v113
    v_max_f32_e32 v114, 0, v114
    v_mfma_f32_16x16x32_bf16 a[16:19], a[208:211], v[80:83], a[16:19]
    s_add_u32 m0, s40, 16384
    ds_read_b64_tr_b16 a[200:201], v3 offset:12288
    v_max_f32_e32 v115, 0, v115
    v_mul_f32_e32 v112, v112, v32
    v_mfma_f32_16x16x32_bf16 a[20:23], a[208:211], v[84:87], a[20:23]
    s_waitcnt lgkmcnt(5)
    ds_read_b64_tr_b16 a[202:203], v3 offset:14336
    v_mul_f32_e32 v113, v113, v33
    v_mul_f32_e32 v114, v114, v34
    v_mfma_f32_16x16x32_bf16 a[24:27], a[212:215], v[80:83], a[24:27]
    s_add_u32 s39, s38, 147712
    ds_read_b64_tr_b16 a[204:205], v4 offset:12288
    v_mul_f32_e32 v115, v115, v35
    v_cvt_pk_bf16_f32 v112, v112, v113
    v_mfma_f32_16x16x32_bf16 a[28:31], a[212:215], v[84:87], a[28:31]
    s_waitcnt lgkmcnt(5)
    ds_read_b64_tr_b16 a[206:207], v4 offset:14336
    v_cvt_pk_bf16_f32 v113, v114, v115
    v_max_f32_e32 v120, 0, v120
    v_mfma_f32_16x16x32_bf16 a[32:35], a[192:195], v[80:83], a[32:35]
    ds_read_b64_tr_b16 a[208:209], v1 offset:16384
    buffer_load_dwordx4 v0, s[16:19], s39 offen lds
    v_max_f32_e32 v121, 0, v121
    v_mfma_f32_16x16x32_bf16 a[36:39], a[192:195], v[84:87], a[36:39]
    s_waitcnt lgkmcnt(5)
    ds_read_b64_tr_b16 a[210:211], v1 offset:18432
    v_max_f32_e32 v122, 0, v122
    v_max_f32_e32 v123, 0, v123
    v_mfma_f32_16x16x32_bf16 a[40:43], a[196:199], v[80:83], a[40:43]
    s_add_u32 m0, s40, 20480
    ds_read_b64_tr_b16 a[212:213], v2 offset:16384
    v_mul_f32_e32 v120, v120, v40
    v_mul_f32_e32 v121, v121, v41
    v_mfma_f32_16x16x32_bf16 a[44:47], a[196:199], v[84:87], a[44:47]
    s_waitcnt lgkmcnt(5)
    ds_read_b64_tr_b16 a[214:215], v2 offset:18432
    v_mul_f32_e32 v122, v122, v42
    v_mul_f32_e32 v123, v123, v43
    v_mfma_f32_16x16x32_bf16 a[48:51], a[200:203], v[80:83], a[48:51]
    s_add_u32 s39, s38, 184576
    ds_read_b64_tr_b16 a[192:193], v3 offset:16384
    v_cvt_pk_bf16_f32 v114, v120, v121
    v_cvt_pk_bf16_f32 v115, v122, v123
    v_mfma_f32_16x16x32_bf16 a[52:55], a[200:203], v[84:87], a[52:55]
    s_waitcnt lgkmcnt(5)
    ds_read_b64_tr_b16 a[194:195], v3 offset:18432
    buffer_store_dwordx4 v[112:115], v29, s[20:23], s43 offen offset:0 sc1
    v_max_f32_e32 v116, 0, v116
    v_mfma_f32_16x16x32_bf16 a[56:59], a[204:207], v[80:83], a[56:59]
    ds_read_b64_tr_b16 a[196:197], v4 offset:16384
    buffer_load_dwordx4 v0, s[16:19], s39 offen lds
    v_max_f32_e32 v117, 0, v117
    v_mfma_f32_16x16x32_bf16 a[60:63], a[204:207], v[84:87], a[60:63]
    s_waitcnt lgkmcnt(5)
    ds_read_b64_tr_b16 a[198:199], v4 offset:18432
    v_max_f32_e32 v118, 0, v118
    v_max_f32_e32 v119, 0, v119
    v_mfma_f32_16x16x32_bf16 a[0:3], a[208:211], v[96:99], a[0:3]
    s_add_u32 m0, s40, 24576
    ds_read_b64_tr_b16 a[200:201], v1 offset:20480
    v_mul_f32_e32 v116, v116, v36
    v_mul_f32_e32 v117, v117, v37
    v_mfma_f32_16x16x32_bf16 a[4:7], a[208:211], v[100:103], a[4:7]
    s_waitcnt lgkmcnt(5)
    ds_read_b64_tr_b16 a[202:203], v1 offset:22528
    v_mul_f32_e32 v118, v118, v38
    v_mul_f32_e32 v119, v119, v39
    v_mfma_f32_16x16x32_bf16 a[8:11], a[212:215], v[96:99], a[8:11]
    s_add_u32 s39, s38, 221440
    ds_read_b64_tr_b16 a[204:205], v2 offset:20480
    v_cvt_pk_bf16_f32 v116, v116, v117
    v_cvt_pk_bf16_f32 v117, v118, v119
    v_mfma_f32_16x16x32_bf16 a[12:15], a[212:215], v[100:103], a[12:15]
    s_waitcnt lgkmcnt(5)
    ds_read_b64_tr_b16 a[206:207], v2 offset:22528
    v_max_f32_e32 v124, 0, v124
    v_max_f32_e32 v125, 0, v125
    v_mfma_f32_16x16x32_bf16 a[16:19], a[192:195], v[96:99], a[16:19]
    ds_read_b64_tr_b16 a[208:209], v3 offset:20480
    buffer_load_dwordx4 v0, s[16:19], s39 offen lds
    v_max_f32_e32 v126, 0, v126
    v_mfma_f32_16x16x32_bf16 a[20:23], a[192:195], v[100:103], a[20:23]
    s_waitcnt lgkmcnt(5)
    ds_read_b64_tr_b16 a[210:211], v3 offset:22528
    v_max_f32_e32 v127, 0, v127
    v_mul_f32_e32 v124, v124, v44
    v_mfma_f32_16x16x32_bf16 a[24:27], a[196:199], v[96:99], a[24:27]
    s_add_u32 m0, s40, 28672
    ds_read_b64_tr_b16 a[212:213], v4 offset:20480
    v_mul_f32_e32 v125, v125, v45
    v_mul_f32_e32 v126, v126, v46
    v_mfma_f32_16x16x32_bf16 a[28:31], a[196:199], v[100:103], a[28:31]
    s_waitcnt lgkmcnt(5)
    ds_read_b64_tr_b16 a[214:215], v4 offset:22528
    v_mul_f32_e32 v127, v127, v47
    v_cvt_pk_bf16_f32 v118, v124, v125
    v_mfma_f32_16x16x32_bf16 a[32:35], a[200:203], v[96:99], a[32:35]
    s_add_u32 s39, s38, 258304
    ds_read_b64_tr_b16 a[192:193], v1 offset:24576
    v_cvt_pk_bf16_f32 v119, v126, v127
    buffer_store_dwordx4 v[116:119], v29, s[20:23], s43 offen offset:1024 sc1
    v_mfma_f32_16x16x32_bf16 a[36:39], a[200:203], v[100:103], a[36:39]
    s_waitcnt lgkmcnt(5)
    ds_read_b64_tr_b16 a[194:195], v1 offset:26624
    v_mfma_f32_16x16x32_bf16 a[40:43], a[204:207], v[96:99], a[40:43]
    s_add_u32 s43, s43, 2048
    ds_read_b64_tr_b16 a[196:197], v2 offset:24576
    buffer_load_dwordx4 v0, s[16:19], s39 offen lds
    v_max_f32_e32 v128, 0, v128
    v_mfma_f32_16x16x32_bf16 a[44:47], a[204:207], v[100:103], a[44:47]
    s_waitcnt lgkmcnt(5)
    ds_read_b64_tr_b16 a[198:199], v2 offset:26624
    v_max_f32_e32 v129, 0, v129
    v_max_f32_e32 v130, 0, v130
    v_mfma_f32_16x16x32_bf16 a[48:51], a[208:211], v[96:99], a[48:51]
    s_add_u32 m0, s40, 32768
    ds_read_b64_tr_b16 a[200:201], v3 offset:24576
    v_max_f32_e32 v131, 0, v131
    v_mul_f32_e32 v128, v128, v48
    v_mfma_f32_16x16x32_bf16 a[52:55], a[208:211], v[100:103], a[52:55]
    s_waitcnt lgkmcnt(5)
    ds_read_b64_tr_b16 a[202:203], v3 offset:26624
    v_mul_f32_e32 v129, v129, v49
    v_mul_f32_e32 v130, v130, v50
    v_mfma_f32_16x16x32_bf16 a[56:59], a[212:215], v[96:99], a[56:59]
    s_add_u32 s39, s38, 295168
    ds_read_b64_tr_b16 a[204:205], v4 offset:24576
    v_mul_f32_e32 v131, v131, v51
    v_cvt_pk_bf16_f32 v128, v128, v129
    v_mfma_f32_16x16x32_bf16 a[60:63], a[212:215], v[100:103], a[60:63]
    s_waitcnt lgkmcnt(5)
    ds_read_b64_tr_b16 a[206:207], v4 offset:26624
    v_cvt_pk_bf16_f32 v129, v130, v131
    v_max_f32_e32 v136, 0, v136
    v_mfma_f32_16x16x32_bf16 a[0:3], a[192:195], v[112:115], a[0:3]
    ds_read_b64_tr_b16 a[208:209], v1 offset:28672
    buffer_load_dwordx4 v0, s[16:19], s39 offen lds
    v_max_f32_e32 v137, 0, v137
    v_mfma_f32_16x16x32_bf16 a[4:7], a[192:195], v[116:119], a[4:7]
    s_waitcnt lgkmcnt(5)
    ds_read_b64_tr_b16 a[210:211], v1 offset:30720
    v_max_f32_e32 v138, 0, v138
    v_max_f32_e32 v139, 0, v139
    v_mfma_f32_16x16x32_bf16 a[8:11], a[196:199], v[112:115], a[8:11]
    ds_read_b64_tr_b16 a[212:213], v2 offset:28672
    v_mul_f32_e32 v136, v136, v56
    v_mul_f32_e32 v137, v137, v57
    v_mfma_f32_16x16x32_bf16 a[12:15], a[196:199], v[116:119], a[12:15]
    s_waitcnt lgkmcnt(5)
    ds_read_b64_tr_b16 a[214:215], v2 offset:30720
    v_mul_f32_e32 v138, v138, v58
    v_mul_f32_e32 v139, v139, v59
    v_mfma_f32_16x16x32_bf16 a[16:19], a[200:203], v[112:115], a[16:19]
    ds_read_b64_tr_b16 a[192:193], v3 offset:28672
    v_cvt_pk_bf16_f32 v130, v136, v137
    v_cvt_pk_bf16_f32 v131, v138, v139
    v_mfma_f32_16x16x32_bf16 a[20:23], a[200:203], v[116:119], a[20:23]
    s_waitcnt lgkmcnt(5)
    ds_read_b64_tr_b16 a[194:195], v3 offset:30720
    buffer_store_dwordx4 v[128:131], v29, s[20:23], s43 offen offset:0 sc1
    v_max_f32_e32 v132, 0, v132
    v_mfma_f32_16x16x32_bf16 a[24:27], a[204:207], v[112:115], a[24:27]
    ds_read_b64_tr_b16 a[196:197], v4 offset:28672
    v_max_f32_e32 v133, 0, v133
    v_max_f32_e32 v134, 0, v134
    v_mfma_f32_16x16x32_bf16 a[28:31], a[204:207], v[116:119], a[28:31]
    s_waitcnt lgkmcnt(5)
    ds_read_b64_tr_b16 a[198:199], v4 offset:30720
    v_max_f32_e32 v135, 0, v135
    v_mul_f32_e32 v132, v132, v52
    v_mfma_f32_16x16x32_bf16 a[32:35], a[208:211], v[112:115], a[32:35]
    ds_read_b64_tr_b16 a[200:201], v1 offset:32768
    v_mul_f32_e32 v133, v133, v53
    v_mul_f32_e32 v134, v134, v54
    v_mfma_f32_16x16x32_bf16 a[36:39], a[208:211], v[116:119], a[36:39]
    s_waitcnt lgkmcnt(5)
    ds_read_b64_tr_b16 a[202:203], v1 offset:34816
    v_mul_f32_e32 v135, v135, v55
    v_cvt_pk_bf16_f32 v132, v132, v133
    v_mfma_f32_16x16x32_bf16 a[40:43], a[212:215], v[112:115], a[40:43]
    ds_read_b64_tr_b16 a[204:205], v2 offset:32768
    v_cvt_pk_bf16_f32 v133, v134, v135
    v_max_f32_e32 v140, 0, v140
    v_mfma_f32_16x16x32_bf16 a[44:47], a[212:215], v[116:119], a[44:47]
    s_waitcnt lgkmcnt(5)
    ds_read_b64_tr_b16 a[206:207], v2 offset:34816
    v_max_f32_e32 v141, 0, v141
    v_max_f32_e32 v142, 0, v142
    v_mfma_f32_16x16x32_bf16 a[48:51], a[192:195], v[112:115], a[48:51]
    ds_read_b64_tr_b16 a[208:209], v3 offset:32768
    v_max_f32_e32 v143, 0, v143
    v_mul_f32_e32 v140, v140, v60
    v_mfma_f32_16x16x32_bf16 a[52:55], a[192:195], v[116:119], a[52:55]
    s_waitcnt lgkmcnt(5)
    ds_read_b64_tr_b16 a[210:211], v3 offset:34816
    v_mul_f32_e32 v141, v141, v61
    v_mul_f32_e32 v142, v142, v62
    v_mfma_f32_16x16x32_bf16 a[56:59], a[196:199], v[112:115], a[56:59]
    ds_read_b64_tr_b16 a[212:213], v4 offset:32768
    v_mul_f32_e32 v143, v143, v63
    v_cvt_pk_bf16_f32 v134, v140, v141
    v_mfma_f32_16x16x32_bf16 a[60:63], a[196:199], v[116:119], a[60:63]
    s_waitcnt lgkmcnt(5)
    ds_read_b64_tr_b16 a[214:215], v4 offset:34816
    v_cvt_pk_bf16_f32 v135, v142, v143
    buffer_store_dwordx4 v[132:135], v29, s[20:23], s43 offen offset:1024 sc1
    v_add_u32 v1, 36864, v1
    v_add_u32 v2, 36864, v2
    v_add_u32 v3, 36864, v3
    v_add_u32 v4, 36864, v4
    s_add_u32 s43, s43, 2048
    v_mfma_f32_16x16x32_bf16 a[0:3], a[200:203], v[128:131], a[0:3]
    s_waitcnt vmcnt(17)
    s_barrier
    ds_read_b64_tr_b16 a[192:193], v1 offset:0
    v_accvgpr_read_b32 v21, a96
    v_max_f32_e32 v144, 0, v144
    v_mfma_f32_16x16x32_bf16 a[4:7], a[200:203], v[132:135], a[4:7]
    s_waitcnt lgkmcnt(5)
    ds_read_b64_tr_b16 a[194:195], v1 offset:2048
    v_accvgpr_read_b32 v22, a97
    v_max_f32_e32 v145, 0, v145
    v_mfma_f32_16x16x32_bf16 a[8:11], a[204:207], v[128:131], a[8:11]
    ds_read_b64_tr_b16 a[196:197], v2 offset:0
    v_accvgpr_read_b32 v23, a98
    v_max_f32_e32 v146, 0, v146
    v_mfma_f32_16x16x32_bf16 a[12:15], a[204:207], v[132:135], a[12:15]
    s_waitcnt lgkmcnt(5)
    ds_read_b64_tr_b16 a[198:199], v2 offset:2048
    v_accvgpr_read_b32 v24, a99
    v_max_f32_e32 v147, 0, v147
    v_mfma_f32_16x16x32_bf16 a[16:19], a[208:211], v[128:131], a[16:19]
    ds_read_b64_tr_b16 a[200:201], v3 offset:0
    v_mul_f32_e32 v144, v144, v21
    v_mul_f32_e32 v145, v145, v22
    v_mfma_f32_16x16x32_bf16 a[20:23], a[208:211], v[132:135], a[20:23]
    s_waitcnt lgkmcnt(5)
    ds_read_b64_tr_b16 a[202:203], v3 offset:2048
    v_mul_f32_e32 v146, v146, v23
    v_mul_f32_e32 v147, v147, v24
    v_mfma_f32_16x16x32_bf16 a[24:27], a[212:215], v[128:131], a[24:27]
    ds_read_b64_tr_b16 a[204:205], v4 offset:0
    v_cvt_pk_bf16_f32 v144, v144, v145
    v_cvt_pk_bf16_f32 v145, v146, v147
    v_mfma_f32_16x16x32_bf16 a[28:31], a[212:215], v[132:135], a[28:31]
    s_waitcnt lgkmcnt(5)
    ds_read_b64_tr_b16 a[206:207], v4 offset:2048
    v_accvgpr_read_b32 v21, a104
    v_max_f32_e32 v152, 0, v152
    v_mfma_f32_16x16x32_bf16 a[32:35], a[192:195], v[128:131], a[32:35]
    s_add_u32 m0, s40, 36864
    ds_read_b64_tr_b16 a[208:209], v1 offset:4096
    v_accvgpr_read_b32 v22, a105
    v_max_f32_e32 v153, 0, v153
    v_mfma_f32_16x16x32_bf16 a[36:39], a[192:195], v[132:135], a[36:39]
    s_waitcnt lgkmcnt(5)
    ds_read_b64_tr_b16 a[210:211], v1 offset:6144
    v_accvgpr_read_b32 v23, a106
    v_max_f32_e32 v154, 0, v154
    v_mfma_f32_16x16x32_bf16 a[40:43], a[196:199], v[128:131], a[40:43]
    s_add_u32 s39, s38, 384
    ds_read_b64_tr_b16 a[212:213], v2 offset:4096
    v_accvgpr_read_b32 v24, a107
    v_max_f32_e32 v155, 0, v155
    v_mfma_f32_16x16x32_bf16 a[44:47], a[196:199], v[132:135], a[44:47]
    s_waitcnt lgkmcnt(5)
    ds_read_b64_tr_b16 a[214:215], v2 offset:6144
    buffer_load_dwordx4 v0, s[16:19], s39 offen lds
    v_mul_f32_e32 v152, v152, v21
    v_mfma_f32_16x16x32_bf16 a[48:51], a[200:203], v[128:131], a[48:51]
    s_add_u32 m0, s40, 40960
    ds_read_b64_tr_b16 a[192:193], v3 offset:4096
    v_mul_f32_e32 v153, v153, v22
    v_mul_f32_e32 v154, v154, v23
    v_mfma_f32_16x16x32_bf16 a[52:55], a[200:203], v[132:135], a[52:55]
    s_waitcnt lgkmcnt(5)
    ds_read_b64_tr_b16 a[194:195], v3 offset:6144
    v_mul_f32_e32 v155, v155, v24
    v_cvt_pk_bf16_f32 v146, v152, v153
    v_mfma_f32_16x16x32_bf16 a[56:59], a[204:207], v[128:131], a[56:59]
    s_add_u32 s39, s38, 37248
    ds_read_b64_tr_b16 a[196:197], v4 offset:4096
    buffer_load_dwordx4 v0, s[16:19], s39 offen lds
    v_cvt_pk_bf16_f32 v147, v154, v155
    v_mfma_f32_16x16x32_bf16 a[60:63], a[204:207], v[132:135], a[60:63]
    s_waitcnt lgkmcnt(5)
    ds_read_b64_tr_b16 a[198:199], v4 offset:6144
    buffer_store_dwordx4 v[144:147], v29, s[20:23], s43 offen offset:0 sc1
    v_accvgpr_read_b32 v21, a100
    v_max_f32_e32 v148, 0, v148
    v_accvgpr_read_b32 v22, a101
    v_max_f32_e32 v149, 0, v149
    v_accvgpr_read_b32 v23, a102
    v_max_f32_e32 v150, 0, v150
    v_accvgpr_read_b32 v24, a103
    v_max_f32_e32 v151, 0, v151
    v_mul_f32_e32 v148, v148, v21
    v_mul_f32_e32 v149, v149, v22
    v_mul_f32_e32 v150, v150, v23
    v_mul_f32_e32 v151, v151, v24
    v_cvt_pk_bf16_f32 v148, v148, v149
    v_cvt_pk_bf16_f32 v149, v150, v151
    v_accvgpr_read_b32 v21, a108
    v_max_f32_e32 v156, 0, v156
    v_accvgpr_read_b32 v22, a109
    v_max_f32_e32 v157, 0, v157
    v_accvgpr_read_b32 v23, a110
    v_max_f32_e32 v158, 0, v158
    v_accvgpr_read_b32 v24, a111
    v_max_f32_e32 v159, 0, v159
    v_mul_f32_e32 v156, v156, v21
    v_mul_f32_e32 v157, v157, v22
    v_mul_f32_e32 v158, v158, v23
    v_mul_f32_e32 v159, v159, v24
    v_cvt_pk_bf16_f32 v150, v156, v157
    v_cvt_pk_bf16_f32 v151, v158, v159
    buffer_store_dwordx4 v[148:151], v29, s[20:23], s43 offen offset:1024 sc1
    s_add_u32 s43, s43, 2048
    v_mfma_f32_16x16x32_bf16 a[0:3], a[208:211], v[144:147], a[0:3]
    s_add_u32 m0, s40, 45056
    ds_read_b64_tr_b16 a[200:201], v1 offset:8192
    v_accvgpr_read_b32 v21, a112
    v_max_f32_e32 v160, 0, v160
    v_mfma_f32_16x16x32_bf16 a[4:7], a[208:211], v[148:151], a[4:7]
    s_waitcnt lgkmcnt(5)
    ds_read_b64_tr_b16 a[202:203], v1 offset:10240
    v_accvgpr_read_b32 v22, a113
    v_max_f32_e32 v161, 0, v161
    v_mfma_f32_16x16x32_bf16 a[8:11], a[212:215], v[144:147], a[8:11]
    s_add_u32 s39, s38, 74112
    ds_read_b64_tr_b16 a[204:205], v2 offset:8192
    v_accvgpr_read_b32 v23, a114
    v_max_f32_e32 v162, 0, v162
    v_mfma_f32_16x16x32_bf16 a[12:15], a[212:215], v[148:151], a[12:15]
    s_waitcnt lgkmcnt(5)
    ds_read_b64_tr_b16 a[206:207], v2 offset:10240
    v_accvgpr_read_b32 v24, a115
    v_max_f32_e32 v163, 0, v163
    v_mfma_f32_16x16x32_bf16 a[16:19], a[192:195], v[144:147], a[16:19]
    ds_read_b64_tr_b16 a[208:209], v3 offset:8192
    buffer_load_dwordx4 v0, s[16:19], s39 offen lds
    v_mul_f32_e32 v160, v160, v21
    v_mfma_f32_16x16x32_bf16 a[20:23], a[192:195], v[148:151], a[20:23]
    s_waitcnt lgkmcnt(5)
    ds_read_b64_tr_b16 a[210:211], v3 offset:10240
    v_mul_f32_e32 v161, v161, v22
    v_mul_f32_e32 v162, v162, v23
    v_mfma_f32_16x16x32_bf16 a[24:27], a[196:199], v[144:147], a[24:27]
    s_add_u32 m0, s40, 49152
    ds_read_b64_tr_b16 a[212:213], v4 offset:8192
    v_mul_f32_e32 v163, v163, v24
    v_cvt_pk_bf16_f32 v160, v160, v161
    v_mfma_f32_16x16x32_bf16 a[28:31], a[196:199], v[148:151], a[28:31]
    s_waitcnt lgkmcnt(5)
    ds_read_b64_tr_b16 a[214:215], v4 offset:10240
    v_cvt_pk_bf16_f32 v161, v162, v163
    v_accvgpr_read_b32 v21, a120
    v_mfma_f32_16x16x32_bf16 a[32:35], a[200:203], v[144:147], a[32:35]
    s_add_u32 s39, s38, 110976
    ds_read_b64_tr_b16 a[192:193], v1 offset:12288
    v_max_f32_e32 v168, 0, v168
    v_accvgpr_read_b32 v22, a121
    v_mfma_f32_16x16x32_bf16 a[36:39], a[200:203], v[148:151], a[36:39]
    s_waitcnt lgkmcnt(5)
    ds_read_b64_tr_b16 a[194:195], v1 offset:14336
    v_max_f32_e32 v169, 0, v169
    v_accvgpr_read_b32 v23, a122
    v_mfma_f32_16x16x32_bf16 a[40:43], a[204:207], v[144:147], a[40:43]
    ds_read_b64_tr_b16 a[196:197], v2 offset:12288
    buffer_load_dwordx4 v0, s[16:19], s39 offen lds
    v_max_f32_e32 v170, 0, v170
    v_mfma_f32_16x16x32_bf16 a[44:47], a[204:207], v[148:151], a[44:47]
    s_waitcnt lgkmcnt(5)
    ds_read_b64_tr_b16 a[198:199], v2 offset:14336
    v_accvgpr_read_b32 v24, a123
    v_max_f32_e32 v171, 0, v171
    v_mfma_f32_16x16x32_bf16 a[48:51], a[208:211], v[144:147], a[48:51]
    s_add_u32 m0, s40, 53248
    ds_read_b64_tr_b16 a[200:201], v3 offset:12288
    v_mul_f32_e32 v168, v168, v21
    v_mul_f32_e32 v169, v169, v22
    v_mfma_f32_16x16x32_bf16 a[52:55], a[208:211], v[148:151], a[52:55]
    s_waitcnt lgkmcnt(5)
    ds_read_b64_tr_b16 a[202:203], v3 offset:14336
    v_mul_f32_e32 v170, v170, v23
    v_mul_f32_e32 v171, v171, v24
    v_mfma_f32_16x16x32_bf16 a[56:59], a[212:215], v[144:147], a[56:59]
    s_add_u32 s39, s38, 147840
    ds_read_b64_tr_b16 a[204:205], v4 offset:12288
    v_cvt_pk_bf16_f32 v162, v168, v169
    v_cvt_pk_bf16_f32 v163, v170, v171
    v_mfma_f32_16x16x32_bf16 a[60:63], a[212:215], v[148:151], a[60:63]
    s_waitcnt lgkmcnt(5)
    ds_read_b64_tr_b16 a[206:207], v4 offset:14336
    buffer_store_dwordx4 v[160:163], v29, s[20:23], s43 offen offset:0 sc1
    v_accvgpr_read_b32 v21, a116
    v_max_f32_e32 v164, 0, v164
    v_accvgpr_read_b32 v22, a117
    v_max_f32_e32 v165, 0, v165
    v_accvgpr_read_b32 v23, a118
    v_max_f32_e32 v166, 0, v166
    v_accvgpr_read_b32 v24, a119
    v_max_f32_e32 v167, 0, v167
    v_mul_f32_e32 v164, v164, v21
    v_mul_f32_e32 v165, v165, v22
    v_mul_f32_e32 v166, v166, v23
    v_mul_f32_e32 v167, v167, v24
    v_cvt_pk_bf16_f32 v164, v164, v165
    v_cvt_pk_bf16_f32 v165, v166, v167
    v_accvgpr_read_b32 v21, a124
    v_max_f32_e32 v172, 0, v172
    v_accvgpr_read_b32 v22, a125
    v_max_f32_e32 v173, 0, v173
    v_accvgpr_read_b32 v23, a126
    v_max_f32_e32 v174, 0, v174
    v_accvgpr_read_b32 v24, a127
    v_max_f32_e32 v175, 0, v175
    v_mul_f32_e32 v172, v172, v21
    v_mul_f32_e32 v173, v173, v22
    v_mul_f32_e32 v174, v174, v23
    v_mul_f32_e32 v175, v175, v24
    v_cvt_pk_bf16_f32 v166, v172, v173
    v_cvt_pk_bf16_f32 v167, v174, v175
    buffer_store_dwordx4 v[164:167], v29, s[20:23], s43 offen offset:1024 sc1
    s_add_u32 s43, s43, 2048
    v_mfma_f32_16x16x32_bf16 a[0:3], a[192:195], v[160:163], a[0:3]
    ds_read_b64_tr_b16 a[208:209], v1 offset:16384
    buffer_load_dwordx4 v0, s[16:19], s39 offen lds
    v_accvgpr_read_b32 v21, a128
    v_mfma_f32_16x16x32_bf16 a[4:7], a[192:195], v[164:167], a[4:7]
    s_waitcnt lgkmcnt(5)
    ds_read_b64_tr_b16 a[210:211], v1 offset:18432
    v_max_f32_e32 v176, 0, v176
    v_accvgpr_read_b32 v22, a129
    v_mfma_f32_16x16x32_bf16 a[8:11], a[196:199], v[160:163], a[8:11]
    s_add_u32 m0, s40, 57344
    ds_read_b64_tr_b16 a[212:213], v2 offset:16384
    v_max_f32_e32 v177, 0, v177
    v_accvgpr_read_b32 v23, a130
    v_mfma_f32_16x16x32_bf16 a[12:15], a[196:199], v[164:167], a[12:15]
    s_waitcnt lgkmcnt(5)
    ds_read_b64_tr_b16 a[214:215], v2 offset:18432
    v_max_f32_e32 v178, 0, v178
    v_accvgpr_read_b32 v24, a131
    v_mfma_f32_16x16x32_bf16 a[16:19], a[200:203], v[160:163], a[16:19]
    s_add_u32 s39, s38, 184704
    ds_read_b64_tr_b16 a[192:193], v3 offset:16384
    v_max_f32_e32 v179, 0, v179
    v_mul_f32_e32 v176, v176, v21
    v_mfma_f32_16x16x32_bf16 a[20:23], a[200:203], v[164:167], a[20:23]
    s_waitcnt lgkmcnt(5)
    ds_read_b64_tr_b16 a[194:195], v3 offset:18432
    v_mul_f32_e32 v177, v177, v22
    v_mul_f32_e32 v178, v178, v23
    v_mfma_f32_16x16x32_bf16 a[24:27], a[204:207], v[160:163], a[24:27]
    ds_read_b64_tr_b16 a[196:197], v4 offset:16384
    buffer_load_dwordx4 v0, s[16:19], s39 offen lds
    v_mul_f32_e32 v179, v179, v24
    v_mfma_f32_16x16x32_bf16 a[28:31], a[204:207], v[164:167], a[28:31]
    s_waitcnt lgkmcnt(5)
    ds_read_b64_tr_b16 a[198:199], v4 offset:18432
    v_cvt_pk_bf16_f32 v176, v176, v177
    v_cvt_pk_bf16_f32 v177, v178, v179
    v_mfma_f32_16x16x32_bf16 a[32:35], a[208:211], v[160:163], a[32:35]
    s_add_u32 m0, s40, 61440
    ds_read_b64_tr_b16 a[200:201], v1 offset:20480
    v_accvgpr_read_b32 v21, a136
    v_max_f32_e32 v184, 0, v184
    v_mfma_f32_16x16x32_bf16 a[36:39], a[208:211], v[164:167], a[36:39]
    s_waitcnt lgkmcnt(5)
    ds_read_b64_tr_b16 a[202:203], v1 offset:22528
    v_accvgpr_read_b32 v22, a137
    v_max_f32_e32 v185, 0, v185
    v_mfma_f32_16x16x32_bf16 a[40:43], a[212:215], v[160:163], a[40:43]
    s_add_u32 s39, s38, 221568
    ds_read_b64_tr_b16 a[204:205], v2 offset:20480
    v_accvgpr_read_b32 v23, a138
    v_max_f32_e32 v186, 0, v186
    v_mfma_f32_16x16x32_bf16 a[44:47], a[212:215], v[164:167], a[44:47]
    s_waitcnt lgkmcnt(5)
    ds_read_b64_tr_b16 a[206:207], v2 offset:22528
    v_accvgpr_read_b32 v24, a139
    v_max_f32_e32 v187, 0, v187
    v_mfma_f32_16x16x32_bf16 a[48:51], a[192:195], v[160:163], a[48:51]
    ds_read_b64_tr_b16 a[208:209], v3 offset:20480
    buffer_load_dwordx4 v0, s[16:19], s39 offen lds
    v_mul_f32_e32 v184, v184, v21
    v_mfma_f32_16x16x32_bf16 a[52:55], a[192:195], v[164:167], a[52:55]
    s_waitcnt lgkmcnt(5)
    ds_read_b64_tr_b16 a[210:211], v3 offset:22528
    v_mul_f32_e32 v185, v185, v22
    v_mul_f32_e32 v186, v186, v23
    v_mfma_f32_16x16x32_bf16 a[56:59], a[196:199], v[160:163], a[56:59]
    s_add_u32 m0, s40, 65536
    ds_read_b64_tr_b16 a[212:213], v4 offset:20480
    v_mul_f32_e32 v187, v187, v24
    v_cvt_pk_bf16_f32 v178, v184, v185
    v_mfma_f32_16x16x32_bf16 a[60:63], a[196:199], v[164:167], a[60:63]
    s_waitcnt lgkmcnt(5)
    ds_read_b64_tr_b16 a[214:215], v4 offset:22528
    v_cvt_pk_bf16_f32 v179, v186, v187
    buffer_store_dwordx4 v[176:179], v29, s[20:23], s43 offen offset:0 sc1
    v_accvgpr_read_b32 v21, a132
    v_max_f32_e32 v180, 0, v180
    v_accvgpr_read_b32 v22, a133
    v_max_f32_e32 v181, 0, v181
    v_accvgpr_read_b32 v23, a134
    v_max_f32_e32 v182, 0, v182
    v_accvgpr_read_b32 v24, a135
    v_max_f32_e32 v183, 0, v183
    v_mul_f32_e32 v180, v180, v21
    v_mul_f32_e32 v181, v181, v22
    v_mul_f32_e32 v182, v182, v23
    v_mul_f32_e32 v183, v183, v24
    v_cvt_pk_bf16_f32 v180, v180, v181
    v_cvt_pk_bf16_f32 v181, v182, v183
    v_accvgpr_read_b32 v21, a140
    v_max_f32_e32 v188, 0, v188
    v_accvgpr_read_b32 v22, a141
    v_max_f32_e32 v189, 0, v189
    v_accvgpr_read_b32 v23, a142
    v_max_f32_e32 v190, 0, v190
    v_accvgpr_read_b32 v24, a143
    v_max_f32_e32 v191, 0, v191
    v_mul_f32_e32 v188, v188, v21
    v_mul_f32_e32 v189, v189, v22
    v_mul_f32_e32 v190, v190, v23
    v_mul_f32_e32 v191, v191, v24
    v_cvt_pk_bf16_f32 v182, v188, v189
    v_cvt_pk_bf16_f32 v183, v190, v191
    buffer_store_dwordx4 v[180:183], v29, s[20:23], s43 offen offset:1024 sc1
    s_add_u32 s43, s43, 2048
    v_mfma_f32_16x16x32_bf16 a[0:3], a[200:203], v[176:179], a[0:3]
    s_add_u32 s39, s38, 258432
    ds_read_b64_tr_b16 a[192:193], v1 offset:24576
    v_accvgpr_read_b32 v21, a144
    v_max_f32_e32 v192, 0, v192
    v_mfma_f32_16x16x32_bf16 a[4:7], a[200:203], v[180:183], a[4:7]
    s_waitcnt lgkmcnt(5)
    ds_read_b64_tr_b16 a[194:195], v1 offset:26624
    v_accvgpr_read_b32 v22, a145
    v_max_f32_e32 v193, 0, v193
    v_mfma_f32_16x16x32_bf16 a[8:11], a[204:207], v[176:179], a[8:11]
    ds_read_b64_tr_b16 a[196:197], v2 offset:24576
    buffer_load_dwordx4 v0, s[16:19], s39 offen lds
    v_accvgpr_read_b32 v23, a146
    v_mfma_f32_16x16x32_bf16 a[12:15], a[204:207], v[180:183], a[12:15]
    s_waitcnt lgkmcnt(5)
    ds_read_b64_tr_b16 a[198:199], v2 offset:26624
    v_max_f32_e32 v194, 0, v194
    v_accvgpr_read_b32 v24, a147
    v_mfma_f32_16x16x32_bf16 a[16:19], a[208:211], v[176:179], a[16:19]
    s_add_u32 m0, s40, 69632
    ds_read_b64_tr_b16 a[200:201], v3 offset:24576
    v_max_f32_e32 v195, 0, v195
    v_mul_f32_e32 v192, v192, v21
    v_mfma_f32_16x16x32_bf16 a[20:23], a[208:211], v[180:183], a[20:23]
    s_waitcnt lgkmcnt(5)
    ds_read_b64_tr_b16 a[202:203], v3 offset:26624
    v_mul_f32_e32 v193, v193, v22
    v_mul_f32_e32 v194, v194, v23
    v_mfma_f32_16x16x32_bf16 a[24:27], a[212:215], v[176:179], a[24:27]
    s_add_u32 s39, s38, 295296
    ds_read_b64_tr_b16 a[204:205], v4 offset:24576
    v_mul_f32_e32 v195, v195, v24
    v_cvt_pk_bf16_f32 v192, v192, v193
    v_mfma_f32_16x16x32_bf16 a[28:31], a[212:215], v[180:183], a[28:31]
    s_waitcnt lgkmcnt(5)
    ds_read_b64_tr_b16 a[206:207], v4 offset:26624
    v_cvt_pk_bf16_f32 v193, v194, v195
    v_accvgpr_read_b32 v21, a152
    v_mfma_f32_16x16x32_bf16 a[32:35], a[192:195], v[176:179], a[32:35]
    ds_read_b64_tr_b16 a[208:209], v1 offset:28672
    buffer_load_dwordx4 v0, s[16:19], s39 offen lds
    v_max_f32_e32 v200, 0, v200
    v_mfma_f32_16x16x32_bf16 a[36:39], a[192:195], v[180:183], a[36:39]
    s_waitcnt lgkmcnt(5)
    ds_read_b64_tr_b16 a[210:211], v1 offset:30720
    v_accvgpr_read_b32 v22, a153
    v_max_f32_e32 v201, 0, v201
    v_mfma_f32_16x16x32_bf16 a[40:43], a[196:199], v[176:179], a[40:43]
    ds_read_b64_tr_b16 a[212:213], v2 offset:28672
    v_accvgpr_read_b32 v23, a154
    v_max_f32_e32 v202, 0, v202
    v_mfma_f32_16x16x32_bf16 a[44:47], a[196:199], v[180:183], a[44:47]
    s_waitcnt lgkmcnt(5)
    ds_read_b64_tr_b16 a[214:215], v2 offset:30720
    v_accvgpr_read_b32 v24, a155
    v_max_f32_e32 v203, 0, v203
    v_mfma_f32_16x16x32_bf16 a[48:51], a[200:203], v[176:179], a[48:51]
    ds_read_b64_tr_b16 a[192:193], v3 offset:28672
    v_mul_f32_e32 v200, v200, v21
    v_mul_f32_e32 v201, v201, v22
    v_mfma_f32_16x16x32_bf16 a[52:55], a[200:203], v[180:183], a[52:55]
    s_waitcnt lgkmcnt(5)
    ds_read_b64_tr_b16 a[194:195], v3 offset:30720
    v_mul_f32_e32 v202, v202, v23
    v_mul_f32_e32 v203, v203, v24
    v_mfma_f32_16x16x32_bf16 a[56:59], a[204:207], v[176:179], a[56:59]
    ds_read_b64_tr_b16 a[196:197], v4 offset:28672
    v_cvt_pk_bf16_f32 v194, v200, v201
    v_cvt_pk_bf16_f32 v195, v202, v203
    v_mfma_f32_16x16x32_bf16 a[60:63], a[204:207], v[180:183], a[60:63]
    s_waitcnt lgkmcnt(5)
    ds_read_b64_tr_b16 a[198:199], v4 offset:30720
    buffer_store_dwordx4 v[192:195], v29, s[20:23], s43 offen offset:0 sc1
    v_accvgpr_read_b32 v21, a148
    v_max_f32_e32 v196, 0, v196
    v_accvgpr_read_b32 v22, a149
    v_max_f32_e32 v197, 0, v197
    v_accvgpr_read_b32 v23, a150
    v_max_f32_e32 v198, 0, v198
    v_accvgpr_read_b32 v24, a151
    v_max_f32_e32 v199, 0, v199
    v_mul_f32_e32 v196, v196, v21
    v_mul_f32_e32 v197, v197, v22
    v_mul_f32_e32 v198, v198, v23
    v_mul_f32_e32 v199, v199, v24
    v_cvt_pk_bf16_f32 v196, v196, v197
    v_cvt_pk_bf16_f32 v197, v198, v199
    v_accvgpr_read_b32 v21, a156
    v_max_f32_e32 v204, 0, v204
    v_accvgpr_read_b32 v22, a157
    v_max_f32_e32 v205, 0, v205
    v_accvgpr_read_b32 v23, a158
    v_max_f32_e32 v206, 0, v206
    v_accvgpr_read_b32 v24, a159
    v_max_f32_e32 v207, 0, v207
    v_mul_f32_e32 v204, v204, v21
    v_mul_f32_e32 v205, v205, v22
    v_mul_f32_e32 v206, v206, v23
    v_mul_f32_e32 v207, v207, v24
    v_cvt_pk_bf16_f32 v198, v204, v205
    v_cvt_pk_bf16_f32 v199, v206, v207
    buffer_store_dwordx4 v[196:199], v29, s[20:23], s43 offen offset:1024 sc1
    s_add_u32 s43, s43, 2048
    v_mfma_f32_16x16x32_bf16 a[0:3], a[208:211], v[192:195], a[0:3]
    ds_read_b64_tr_b16 a[200:201], v1 offset:32768
    v_accvgpr_read_b32 v15, a244
    v_mfma_f32_16x16x32_bf16 a[4:7], a[208:211], v[196:199], a[4:7]
    s_waitcnt lgkmcnt(5)
    ds_read_b64_tr_b16 a[202:203], v1 offset:34816
    v_accvgpr_read_b32 v5, a241
    v_mfma_f32_16x16x32_bf16 a[8:11], a[212:215], v[192:195], a[8:11]
    ds_read_b64_tr_b16 a[204:205], v2 offset:32768
    v_accvgpr_read_b32 v7, a242
    v_mfma_f32_16x16x32_bf16 a[12:15], a[212:215], v[196:199], a[12:15]
    s_waitcnt lgkmcnt(5)
    ds_read_b64_tr_b16 a[206:207], v2 offset:34816
    v_accvgpr_read_b32 v31, a243
    v_mfma_f32_16x16x32_bf16 a[16:19], a[192:195], v[192:195], a[16:19]
    ds_read_b64_tr_b16 a[208:209], v3 offset:32768
    v_lshrrev_b32 v14, 4, v30
    v_mfma_f32_16x16x32_bf16 a[20:23], a[192:195], v[196:199], a[20:23]
    s_waitcnt lgkmcnt(5)
    ds_read_b64_tr_b16 a[210:211], v3 offset:34816
    v_mul_u32_u24 v14, 9216, v14
    v_mfma_f32_16x16x32_bf16 a[24:27], a[196:199], v[192:195], a[24:27]
    ds_read_b64_tr_b16 a[212:213], v4 offset:32768
    v_add_u32 v14, v14, v31
    v_mfma_f32_16x16x32_bf16 a[28:31], a[196:199], v[196:199], a[28:31]
    s_waitcnt lgkmcnt(5)
    ds_read_b64_tr_b16 a[214:215], v4 offset:34816
    v_add_u32 v1, -110592, v1
    v_add_u32 v2, -110592, v2
    v_add_u32 v3, -110592, v3
    v_add_u32 v4, -110592, v4
    v_mfma_f32_16x16x32_bf16 a[32:35], a[200:203], v[192:195], a[32:35]
    s_waitcnt vmcnt(19)
    s_barrier
    s_cmp_lg_u32 s30, 0
    s_cbranch_scc1 Ksg_23
    s_add_u32 s95, s50, 0
    s_mov_b32 s98, 1
    s_atomic_add s98, s[20:21], s95
Ksg_23:
    ds_read_b64_tr_b16 a[192:193], v1 offset:0
    v_mfma_f32_16x16x32_bf16 a[36:39], a[200:203], v[196:199], a[36:39]
    s_waitcnt lgkmcnt(5)
    ds_read_b64_tr_b16 a[194:195], v1 offset:2048
    v_mfma_f32_16x16x32_bf16 a[40:43], a[204:207], v[192:195], a[40:43]
    s_lshl_b32 s44, s32, 4
    ds_read_b64_tr_b16 a[196:197], v2 offset:0
    v_mfma_f32_16x16x32_bf16 a[44:47], a[204:207], v[196:199], a[44:47]
    s_waitcnt lgkmcnt(5)
    ds_read_b64_tr_b16 a[198:199], v2 offset:2048
    v_mfma_f32_16x16x32_bf16 a[48:51], a[208:211], v[192:195], a[48:51]
    s_lshl_b32 s45, s30, 2
    ds_read_b64_tr_b16 a[200:201], v3 offset:0
    v_mfma_f32_16x16x32_bf16 a[52:55], a[208:211], v[196:199], a[52:55]
    s_waitcnt lgkmcnt(5)
    ds_read_b64_tr_b16 a[202:203], v3 offset:2048
    v_mfma_f32_16x16x32_bf16 a[56:59], a[212:215], v[192:195], a[56:59]
    s_add_u32 s44, s44, s45
    ds_read_b64_tr_b16 a[204:205], v4 offset:0
    v_mfma_f32_16x16x32_bf16 a[60:63], a[212:215], v[196:199], a[60:63]
    s_waitcnt lgkmcnt(5)
    ds_read_b64_tr_b16 a[206:207], v4 offset:2048
    v_mfma_f32_16x16x32_bf16 v[72:75], a[192:195], v[64:67], 0
    s_add_u32 m0, s40, 73728
    ds_read_b64_tr_b16 a[208:209], v1 offset:4096
    v_mfma_f32_16x16x32_bf16 v[76:79], a[192:195], v[68:71], 0
    s_waitcnt lgkmcnt(5)
    ds_read_b64_tr_b16 a[210:211], v1 offset:6144
    v_mfma_f32_16x16x32_bf16 v[88:91], a[196:199], v[64:67], 0
    s_add_u32 s39, s101, 0
    ds_read_b64_tr_b16 a[212:213], v2 offset:4096
    v_mfma_f32_16x16x32_bf16 v[92:95], a[196:199], v[68:71], 0
    s_waitcnt lgkmcnt(5)
    ds_read_b64_tr_b16 a[214:215], v2 offset:6144
    buffer_load_dwordx4 v0, s[16:19], s39 offen lds
    v_mfma_f32_16x16x32_bf16 v[104:107], a[200:203], v[64:67], 0
    s_add_u32 m0, s40, 77824
    ds_read_b64_tr_b16 a[192:193], v3 offset:4096
    v_mfma_f32_16x16x32_bf16 v[108:111], a[200:203], v[68:71], 0
    s_waitcnt lgkmcnt(5)
    ds_read_b64_tr_b16 a[194:195], v3 offset:6144
    v_mfma_f32_16x16x32_bf16 v[120:123], a[204:207], v[64:67], 0
    s_add_u32 s39, s101, 36864
    ds_read_b64_tr_b16 a[196:197], v4 offset:4096
    buffer_load_dwordx4 v0, s[16:19], s39 offen lds
    v_mfma_f32_16x16x32_bf16 v[124:127], a[204:207], v[68:71], 0
    s_waitcnt lgkmcnt(5)
    ds_read_b64_tr_b16 a[198:199], v4 offset:6144
    v_mfma_f32_16x16x32_bf16 v[72:75], a[208:211], v[80:83], v[72:75]
    s_add_u32 m0, s40, 81920
    ds_read_b64_tr_b16 a[200:201], v1 offset:8192
    v_mfma_f32_16x16x32_bf16 v[76:79], a[208:211], v[84:87], v[76:79]
    s_waitcnt lgkmcnt(5)
    ds_read_b64_tr_b16 a[202:203], v1 offset:10240
    v_mfma_f32_16x16x32_bf16 v[88:91], a[212:215], v[80:83], v[88:91]
    s_add_u32 s39, s101, 73728
    ds_read_b64_tr_b16 a[204:205], v2 offset:8192
    v_mfma_f32_16x16x32_bf16 v[92:95], a[212:215], v[84:87], v[92:95]
    s_waitcnt lgkmcnt(5)
    ds_read_b64_tr_b16 a[206:207], v2 offset:10240
    v_mfma_f32_16x16x32_bf16 v[104:107], a[192:195], v[80:83], v[104:107]
    s_lshl_b32 s44, s44, 4
    ds_read_b64_tr_b16 a[208:209], v3 offset:8192
    buffer_load_dwordx4 v0, s[16:19], s39 offen lds
    v_mfma_f32_16x16x32_bf16 v[108:111], a[192:195], v[84:87], v[108:111]
    s_waitcnt lgkmcnt(5)
    ds_read_b64_tr_b16 a[210:211], v3 offset:10240
    v_mfma_f32_16x16x32_bf16 v[120:123], a[196:199], v[80:83], v[120:123]
    s_add_u32 m0, s40, 86016
    ds_read_b64_tr_b16 a[212:213], v4 offset:8192
    v_mfma_f32_16x16x32_bf16 v[124:127], a[196:199], v[84:87], v[124:127]
    s_waitcnt lgkmcnt(5)
    ds_read_b64_tr_b16 a[214:215], v4 offset:10240
    v_mfma_f32_16x16x32_bf16 v[72:75], a[200:203], v[96:99], v[72:75]
    s_add_u32 s39, s101, 110592
    ds_read_b64_tr_b16 a[192:193], v1 offset:12288
    v_mfma_f32_16x16x32_bf16 v[76:79], a[200:203], v[100:103], v[76:79]
    s_waitcnt lgkmcnt(5)
    ds_read_b64_tr_b16 a[194:195], v1 offset:14336
    v_mfma_f32_16x16x32_bf16 v[88:91], a[204:207], v[96:99], v[88:91]
    s_add_u32 s44, s44, s31
    ds_read_b64_tr_b16 a[196:197], v2 offset:12288
    buffer_load_dwordx4 v0, s[16:19], s39 offen lds
    v_mfma_f32_16x16x32_bf16 v[92:95], a[204:207], v[100:103], v[92:95]
    s_waitcnt lgkmcnt(5)
    ds_read_b64_tr_b16 a[198:199], v2 offset:14336
    v_mfma_f32_16x16x32_bf16 v[104:107], a[208:211], v[96:99], v[104:107]
    s_add_u32 m0, s40, 90112
    ds_read_b64_tr_b16 a[200:201], v3 offset:12288
    v_mfma_f32_16x16x32_bf16 v[108:111], a[208:211], v[100:103], v[108:111]
    s_waitcnt lgkmcnt(5)
    ds_read_b64_tr_b16 a[202:203], v3 offset:14336
    v_mfma_f32_16x16x32_bf16 v[120:123], a[212:215], v[96:99], v[120:123]
    s_add_u32 s39, s101, 147456
    ds_read_b64_tr_b16 a[204:205], v4 offset:12288
    v_mfma_f32_16x16x32_bf16 v[124:127], a[212:215], v[100:103], v[124:127]
    s_waitcnt lgkmcnt(5)
    ds_read_b64_tr_b16 a[206:207], v4 offset:14336
    v_mfma_f32_16x16x32_bf16 v[72:75], a[192:195], v[112:115], v[72:75]
    s_mul_i32 s44, s44, 9216
    ds_read_b64_tr_b16 a[208:209], v1 offset:16384
    buffer_load_dwordx4 v0, s[16:19], s39 offen lds
    v_mfma_f32_16x16x32_bf16 v[76:79], a[192:195], v[116:119], v[76:79]
    s_waitcnt lgkmcnt(5)
    ds_read_b64_tr_b16 a[210:211], v1 offset:18432
    v_mfma_f32_16x16x32_bf16 v[88:91], a[196:199], v[112:115], v[88:91]
    s_add_u32 m0, s40, 94208
    ds_read_b64_tr_b16 a[212:213], v2 offset:16384
    v_mfma_f32_16x16x32_bf16 v[92:95], a[196:199], v[116:119], v[92:95]
    s_waitcnt lgkmcnt(5)
    ds_read_b64_tr_b16 a[214:215], v2 offset:18432
    v_mfma_f32_16x16x32_bf16 v[104:107], a[200:203], v[112:115], v[104:107]
    s_add_u32 s39, s101, 184320
    ds_read_b64_tr_b16 a[192:193], v3 offset:16384
    v_mfma_f32_16x16x32_bf16 v[108:111], a[200:203], v[116:119], v[108:111]
    s_waitcnt lgkmcnt(5)
    ds_read_b64_tr_b16 a[194:195], v3 offset:18432
    v_mfma_f32_16x16x32_bf16 v[120:123], a[204:207], v[112:115], v[120:123]
    s_add_u32 s44, s44, 2621440
    ds_read_b64_tr_b16 a[196:197], v4 offset:16384
    buffer_load_dwordx4 v0, s[16:19], s39 offen lds
    v_mfma_f32_16x16x32_bf16 v[124:127], a[204:207], v[116:119], v[124:127]
    s_waitcnt lgkmcnt(5)
    ds_read_b64_tr_b16 a[198:199], v4 offset:18432
    v_mfma_f32_16x16x32_bf16 v[72:75], a[208:211], v[128:131], v[72:75]
    s_add_u32 s46, s44, 4096
    ds_read_b64_tr_b16 a[200:201], v1 offset:20480
    v_mfma_f32_16x16x32_bf16 v[76:79], a[208:211], v[132:135], v[76:79]
    s_waitcnt lgkmcnt(5)
    ds_read_b64_tr_b16 a[202:203], v1 offset:22528
    s_cmp_lg_u32 s30, 0
    s_cbranch_scc1 Kpi_24
    s_add_u32 s96, s50, 0
    s_mov_b32 s97, 0
    s_atomic_add s97, s[20:21], s96 glc
Kpi_24:
    v_mfma_f32_16x16x32_bf16 v[88:91], a[212:215], v[128:131], v[88:91]
    s_add_u32 m0, s40, 98304
    ds_read_b64_tr_b16 a[204:205], v2 offset:20480
    v_mfma_f32_16x16x32_bf16 v[92:95], a[212:215], v[132:135], v[92:95]
    s_waitcnt lgkmcnt(5)
    ds_read_b64_tr_b16 a[206:207], v2 offset:22528
    v_mfma_f32_16x16x32_bf16 v[104:107], a[192:195], v[128:131], v[104:107]
    s_add_u32 s39, s101, 221184
    ds_read_b64_tr_b16 a[208:209], v3 offset:20480
    buffer_load_dwordx4 v0, s[16:19], s39 offen lds
    v_mfma_f32_16x16x32_bf16 v[108:111], a[192:195], v[132:135], v[108:111]
    s_waitcnt lgkmcnt(5)
    ds_read_b64_tr_b16 a[210:211], v3 offset:22528
    v_mfma_f32_16x16x32_bf16 v[120:123], a[196:199], v[128:131], v[120:123]
    s_add_u32 m0, s40, 102400
    ds_read_b64_tr_b16 a[212:213], v4 offset:20480
    v_mfma_f32_16x16x32_bf16 v[124:127], a[196:199], v[132:135], v[124:127]
    s_waitcnt lgkmcnt(5)
    ds_read_b64_tr_b16 a[214:215], v4 offset:22528
    v_mfma_f32_16x16x32_bf16 v[72:75], a[200:203], v[144:147], v[72:75]
    s_add_u32 s39, s101, 258048
    ds_read_b64_tr_b16 a[192:193], v1 offset:24576
    v_mfma_f32_16x16x32_bf16 v[76:79], a[200:203], v[148:151], v[76:79]
    s_waitcnt lgkmcnt(5)
    ds_read_b64_tr_b16 a[194:195], v1 offset:26624
    v_mfma_f32_16x16x32_bf16 v[88:91], a[204:207], v[144:147], v[88:91]
    s_add_u32 s47, s46, 294912
    ds_read_b64_tr_b16 a[196:197], v2 offset:24576
    buffer_load_dwordx4 v0, s[16:19], s39 offen lds
    v_mfma_f32_16x16x32_bf16 v[92:95], a[204:207], v[148:151], v[92:95]
    s_waitcnt lgkmcnt(5)
    ds_read_b64_tr_b16 a[198:199], v2 offset:26624
    v_mfma_f32_16x16x32_bf16 v[104:107], a[208:211], v[144:147], v[104:107]
    s_add_u32 m0, s40, 106496
    ds_read_b64_tr_b16 a[200:201], v3 offset:24576
    v_mfma_f32_16x16x32_bf16 v[108:111], a[208:211], v[148:151], v[108:111]
    s_waitcnt lgkmcnt(5)
    ds_read_b64_tr_b16 a[202:203], v3 offset:26624
    v_mfma_f32_16x16x32_bf16 v[120:123], a[212:215], v[144:147], v[120:123]
    s_add_u32 s39, s101, 294912
    ds_read_b64_tr_b16 a[204:205], v4 offset:24576
    v_mfma_f32_16x16x32_bf16 v[124:127], a[212:215], v[148:151], v[124:127]
    s_waitcnt lgkmcnt(5)
    ds_read_b64_tr_b16 a[206:207], v4 offset:26624
    v_mfma_f32_16x16x32_bf16 v[72:75], a[192:195], v[160:163], v[72:75]
    s_and_b32 s45, s31, 1
    ds_read_b64_tr_b16 a[208:209], v1 offset:28672
    buffer_load_dwordx4 v0, s[16:19], s39 offen lds
    v_mfma_f32_16x16x32_bf16 v[76:79], a[192:195], v[164:167], v[76:79]
    s_waitcnt lgkmcnt(5)
    ds_read_b64_tr_b16 a[210:211], v1 offset:30720
    v_mfma_f32_16x16x32_bf16 v[88:91], a[196:199], v[160:163], v[88:91]
    s_mul_i32 s45, s45, 5120
    ds_read_b64_tr_b16 a[212:213], v2 offset:28672
    v_mfma_f32_16x16x32_bf16 v[92:95], a[196:199], v[164:167], v[92:95]
    s_waitcnt lgkmcnt(5)
    ds_read_b64_tr_b16 a[214:215], v2 offset:30720
    v_mfma_f32_16x16x32_bf16 v[104:107], a[200:203], v[160:163], v[104:107]
    s_add_u32 s44, s44, s45
    ds_read_b64_tr_b16 a[192:193], v3 offset:28672
    v_mfma_f32_16x16x32_bf16 v[108:111], a[200:203], v[164:167], v[108:111]
    s_waitcnt lgkmcnt(5)
    ds_read_b64_tr_b16 a[194:195], v3 offset:30720
    v_mfma_f32_16x16x32_bf16 v[120:123], a[204:207], v[160:163], v[120:123]
    s_add_u32 s45, s44, 294912
    ds_read_b64_tr_b16 a[196:197], v4 offset:28672
    v_mfma_f32_16x16x32_bf16 v[124:127], a[204:207], v[164:167], v[124:127]
    s_waitcnt lgkmcnt(5)
    ds_read_b64_tr_b16 a[198:199], v4 offset:30720
    v_mfma_f32_16x16x32_bf16 v[72:75], a[208:211], v[176:179], v[72:75]
    s_lshl_b32 s29, s32, 4
    ds_read_b64_tr_b16 a[200:201], v1 offset:32768
    v_mfma_f32_16x16x32_bf16 v[76:79], a[208:211], v[180:183], v[76:79]
    s_waitcnt lgkmcnt(5)
    ds_read_b64_tr_b16 a[202:203], v1 offset:34816
    v_mfma_f32_16x16x32_bf16 v[88:91], a[212:215], v[176:179], v[88:91]
    s_add_u32 s29, s29, s31
    ds_read_b64_tr_b16 a[204:205], v2 offset:32768
    v_mfma_f32_16x16x32_bf16 v[92:95], a[212:215], v[180:183], v[92:95]
    s_waitcnt lgkmcnt(5)
    ds_read_b64_tr_b16 a[206:207], v2 offset:34816
    v_mfma_f32_16x16x32_bf16 v[104:107], a[192:195], v[176:179], v[104:107]
    s_mul_i32 s88, s29, 147456
    ds_read_b64_tr_b16 a[208:209], v3 offset:32768
    v_mfma_f32_16x16x32_bf16 v[108:111], a[192:195], v[180:183], v[108:111]
    s_waitcnt lgkmcnt(5)
    ds_read_b64_tr_b16 a[210:211], v3 offset:34816
    v_mfma_f32_16x16x32_bf16 v[120:123], a[196:199], v[176:179], v[120:123]
    s_lshl_b32 s89, s30, 8
    ds_read_b64_tr_b16 a[212:213], v4 offset:32768
    v_mfma_f32_16x16x32_bf16 v[124:127], a[196:199], v[180:183], v[124:127]
    s_waitcnt lgkmcnt(5)
    ds_read_b64_tr_b16 a[214:215], v4 offset:34816
    v_add_u32 v1, 36864, v1
    v_add_u32 v2, 36864, v2
    v_add_u32 v3, 36864, v3
    v_add_u32 v4, 36864, v4
    v_mfma_f32_16x16x32_bf16 v[72:75], a[200:203], v[192:195], v[72:75]
    s_waitcnt vmcnt(9)
    s_cmp_eq_u32 s30, 0
    s_cbranch_scc1 Kspin_26
Kok_25:
    s_barrier
    s_cmp_lg_u32 s30, 0
    s_cbranch_scc1 Ksg_27
    s_add_u32 s95, s50, 256
    s_mov_b32 s98, 1
    s_atomic_add s98, s[20:21], s95
Ksg_27:
    ds_read_b64_tr_b16 a[192:193], v1 offset:0
    v_mfma_f32_16x16x32_bf16 v[76:79], a[200:203], v[196:199], v[76:79]
    s_waitcnt lgkmcnt(5)
    ds_read_b64_tr_b16 a[194:195], v1 offset:2048
    v_mfma_f32_16x16x32_bf16 v[88:91], a[204:207], v[192:195], v[88:91]
    s_add_u32 s88, s88, s89
    ds_read_b64_tr_b16 a[196:197], v2 offset:0
    v_mfma_f32_16x16x32_bf16 v[92:95], a[204:207], v[196:199], v[92:95]
    s_waitcnt lgkmcnt(5)
    ds_read_b64_tr_b16 a[198:199], v2 offset:2048
    v_mfma_f32_16x16x32_bf16 v[104:107], a[208:211], v[192:195], v[104:107]
    s_add_u32 s88, s88, 2621440
    ds_read_b64_tr_b16 a[200:201], v3 offset:0
    v_mfma_f32_16x16x32_bf16 v[108:111], a[208:211], v[196:199], v[108:111]
    s_waitcnt lgkmcnt(5)
    ds_read_b64_tr_b16 a[202:203], v3 offset:2048
    v_mfma_f32_16x16x32_bf16 v[120:123], a[212:215], v[192:195], v[120:123]
    s_add_u32 s89, s88, 73728
    ds_read_b64_tr_b16 a[204:205], v4 offset:0
    v_mfma_f32_16x16x32_bf16 v[124:127], a[212:215], v[196:199], v[124:127]
    s_waitcnt lgkmcnt(5)
    ds_read_b64_tr_b16 a[206:207], v4 offset:2048
    v_mfma_f32_16x16x32_bf16 v[136:139], a[192:195], v[64:67], 0
    s_add_u32 m0, s40, 110592
    ds_read_b64_tr_b16 a[208:209], v1 offset:4096
    v_mfma_f32_16x16x32_bf16 v[140:143], a[192:195], v[68:71], 0
    s_waitcnt lgkmcnt(5)
    ds_read_b64_tr_b16 a[210:211], v1 offset:6144
    v_mfma_f32_16x16x32_bf16 v[152:155], a[196:199], v[64:67], 0
    s_add_u32 s39, s100, 0
    ds_read_b64_tr_b16 a[212:213], v2 offset:4096
    v_mfma_f32_16x16x32_bf16 v[156:159], a[196:199], v[68:71], 0
    s_waitcnt lgkmcnt(5)
    ds_read_b64_tr_b16 a[214:215], v2 offset:6144
    buffer_load_dwordx4 v0, s[16:19], s39 offen lds
    v_mfma_f32_16x16x32_bf16 v[168:171], a[200:203], v[64:67], 0
    s_add_u32 m0, s40, 114688
    ds_read_b64_tr_b16 a[192:193], v3 offset:4096
    v_mfma_f32_16x16x32_bf16 v[172:175], a[200:203], v[68:71], 0
    s_waitcnt lgkmcnt(5)
    ds_read_b64_tr_b16 a[194:195], v3 offset:6144
    v_mfma_f32_16x16x32_bf16 v[184:187], a[204:207], v[64:67], 0
    s_add_u32 s39, s100, 128
    ds_read_b64_tr_b16 a[196:197], v4 offset:4096
    buffer_load_dwordx4 v0, s[16:19], s39 offen lds
    v_mfma_f32_16x16x32_bf16 v[188:191], a[204:207], v[68:71], 0
    s_waitcnt lgkmcnt(5)
    ds_read_b64_tr_b16 a[198:199], v4 offset:6144
    v_mfma_f32_16x16x32_bf16 v[136:139], a[208:211], v[80:83], v[136:139]
    s_add_u32 m0, s40, 118784
    ds_read_b64_tr_b16 a[200:201], v1 offset:8192
    v_mfma_f32_16x16x32_bf16 v[140:143], a[208:211], v[84:87], v[140:143]
    s_waitcnt lgkmcnt(5)
    ds_read_b64_tr_b16 a[202:203], v1 offset:10240
    v_mfma_f32_16x16x32_bf16 v[152:155], a[212:215], v[80:83], v[152:155]
    s_add_u32 s39, s100, 36864
    ds_read_b64_tr_b16 a[204:205], v2 offset:8192
    v_mfma_f32_16x16x32_bf16 v[156:159], a[212:215], v[84:87], v[156:159]
    s_waitcnt lgkmcnt(5)
    ds_read_b64_tr_b16 a[206:207], v2 offset:10240
    v_mfma_f32_16x16x32_bf16 v[168:171], a[192:195], v[80:83], v[168:171]
    s_add_u32 s90, s88, 14336
    ds_read_b64_tr_b16 a[208:209], v3 offset:8192
    buffer_load_dwordx4 v0, s[16:19], s39 offen lds
    v_mfma_f32_16x16x32_bf16 v[172:175], a[192:195], v[84:87], v[172:175]
    s_waitcnt lgkmcnt(5)
    ds_read_b64_tr_b16 a[210:211], v3 offset:10240
    v_mfma_f32_16x16x32_bf16 v[184:187], a[196:199], v[80:83], v[184:187]
    s_add_u32 m0, s40, 122880
    ds_read_b64_tr_b16 a[212:213], v4 offset:8192
    v_mfma_f32_16x16x32_bf16 v[188:191], a[196:199], v[84:87], v[188:191]
    s_waitcnt lgkmcnt(5)
    ds_read_b64_tr_b16 a[214:215], v4 offset:10240
    v_mfma_f32_16x16x32_bf16 v[136:139], a[200:203], v[96:99], v[136:139]
    s_add_u32 s39, s100, 36992
    ds_read_b64_tr_b16 a[192:193], v1 offset:12288
    v_mfma_f32_16x16x32_bf16 v[140:143], a[200:203], v[100:103], v[140:143]
    s_waitcnt lgkmcnt(5)
    ds_read_b64_tr_b16 a[194:195], v1 offset:14336
    v_mfma_f32_16x16x32_bf16 v[152:155], a[204:207], v[96:99], v[152:155]
    s_add_u32 s91, s89, 14336
    ds_read_b64_tr_b16 a[196:197], v2 offset:12288
    buffer_load_dwordx4 v0, s[16:19], s39 offen lds
    v_mfma_f32_16x16x32_bf16 v[156:159], a[204:207], v[100:103], v[156:159]
    s_waitcnt lgkmcnt(5)
    ds_read_b64_tr_b16 a[198:199], v2 offset:14336
    v_mfma_f32_16x16x32_bf16 v[168:171], a[208:211], v[96:99], v[168:171]
    s_add_u32 m0, s40, 126976
    ds_read_b64_tr_b16 a[200:201], v3 offset:12288
    v_mfma_f32_16x16x32_bf16 v[172:175], a[208:211], v[100:103], v[172:175]
    s_waitcnt lgkmcnt(5)
    ds_read_b64_tr_b16 a[202:203], v3 offset:14336
    v_mfma_f32_16x16x32_bf16 v[184:187], a[212:215], v[96:99], v[184:187]
    s_add_u32 s39, s100, 73728
    ds_read_b64_tr_b16 a[204:205], v4 offset:12288
    v_mfma_f32_16x16x32_bf16 v[188:191], a[212:215], v[100:103], v[188:191]
    s_waitcnt lgkmcnt(5)
    ds_read_b64_tr_b16 a[206:207], v4 offset:14336
    v_mfma_f32_16x16x32_bf16 v[136:139], a[192:195], v[112:115], v[136:139]
    s_lshr_b32 s92, s29, 2
    ds_read_b64_tr_b16 a[208:209], v1 offset:16384
    buffer_load_dwordx4 v0, s[16:19], s39 offen lds
    v_mfma_f32_16x16x32_bf16 v[140:143], a[192:195], v[116:119], v[140:143]
    s_waitcnt lgkmcnt(5)
    ds_read_b64_tr_b16 a[210:211], v1 offset:18432
    v_mfma_f32_16x16x32_bf16 v[152:155], a[196:199], v[112:115], v[152:155]
    s_add_u32 m0, s40, 131072
    ds_read_b64_tr_b16 a[212:213], v2 offset:16384
    v_mfma_f32_16x16x32_bf16 v[156:159], a[196:199], v[116:119], v[156:159]
    s_waitcnt lgkmcnt(5)
    ds_read_b64_tr_b16 a[214:215], v2 offset:18432
    v_mfma_f32_16x16x32_bf16 v[168:171], a[200:203], v[112:115], v[168:171]
    s_add_u32 s39, s100, 73856
    ds_read_b64_tr_b16 a[192:193], v3 offset:16384
    v_mfma_f32_16x16x32_bf16 v[172:175], a[200:203], v[116:119], v[172:175]
    s_waitcnt lgkmcnt(5)
    ds_read_b64_tr_b16 a[194:195], v3 offset:18432
    v_mfma_f32_16x16x32_bf16 v[184:187], a[204:207], v[112:115], v[184:187]
    s_mul_i32 s92, s92, 36864
    ds_read_b64_tr_b16 a[196:197], v4 offset:16384
    buffer_load_dwordx4 v0, s[16:19], s39 offen lds
    v_mfma_f32_16x16x32_bf16 v[188:191], a[204:207], v[116:119], v[188:191]
    s_waitcnt lgkmcnt(5)
    ds_read_b64_tr_b16 a[198:199], v4 offset:18432
    v_mfma_f32_16x16x32_bf16 v[136:139], a[208:211], v[128:131], v[136:139]
    s_bfe_u32 s93, s29, 0x10001
    ds_read_b64_tr_b16 a[200:201], v1 offset:20480
    v_mfma_f32_16x16x32_bf16 v[140:143], a[208:211], v[132:135], v[140:143]
    s_waitcnt lgkmcnt(5)
    ds_read_b64_tr_b16 a[202:203], v1 offset:22528
    s_cmp_lg_u32 s30, 0
    s_cbranch_scc1 Kpi_28
    s_add_u32 s96, s50, 256
    s_mov_b32 s97, 0
    s_atomic_add s97, s[20:21], s96 glc
Kpi_28:
    v_mfma_f32_16x16x32_bf16 v[152:155], a[212:215], v[128:131], v[152:155]
    s_add_u32 m0, s40, 135168
    ds_read_b64_tr_b16 a[204:205], v2 offset:20480
    v_mfma_f32_16x16x32_bf16 v[156:159], a[212:215], v[132:135], v[156:159]
    s_waitcnt lgkmcnt(5)
    ds_read_b64_tr_b16 a[206:207], v2 offset:22528
    v_mfma_f32_16x16x32_bf16 v[168:171], a[192:195], v[128:131], v[168:171]
    s_add_u32 s39, s100, 110592
    ds_read_b64_tr_b16 a[208:209], v3 offset:20480
    buffer_load_dwordx4 v0, s[16:19], s39 offen lds
    v_mfma_f32_16x16x32_bf16 v[172:175], a[192:195], v[132:135], v[172:175]
    s_waitcnt lgkmcnt(5)
    ds_read_b64_tr_b16 a[210:211], v3 offset:22528
    v_mfma_f32_16x16x32_bf16 v[184:187], a[196:199], v[128:131], v[184:187]
    s_add_u32 m0, s40, 139264
    ds_read_b64_tr_b16 a[212:213], v4 offset:20480
    v_mfma_f32_16x16x32_bf16 v[188:191], a[196:199], v[132:135], v[188:191]
    s_waitcnt lgkmcnt(5)
    ds_read_b64_tr_b16 a[214:215], v4 offset:22528
    v_mfma_f32_16x16x32_bf16 v[136:139], a[200:203], v[144:147], v[136:139]
    s_add_u32 s39, s100, 110720
    ds_read_b64_tr_b16 a[192:193], v1 offset:24576
    v_mfma_f32_16x16x32_bf16 v[140:143], a[200:203], v[148:151], v[140:143]
    s_waitcnt lgkmcnt(5)
    ds_read_b64_tr_b16 a[194:195], v1 offset:26624
    v_mfma_f32_16x16x32_bf16 v[152:155], a[204:207], v[144:147], v[152:155]
    s_lshl_b32 s93, s93, 10
    ds_read_b64_tr_b16 a[196:197], v2 offset:24576
    buffer_load_dwordx4 v0, s[16:19], s39 offen lds
    v_mfma_f32_16x16x32_bf16 v[156:159], a[204:207], v[148:151], v[156:159]
    s_waitcnt lgkmcnt(5)
    ds_read_b64_tr_b16 a[198:199], v2 offset:26624
    v_mfma_f32_16x16x32_bf16 v[168:171], a[208:211], v[144:147], v[168:171]
    s_add_u32 m0, s40, 143360
    ds_read_b64_tr_b16 a[200:201], v3 offset:24576
    v_mfma_f32_16x16x32_bf16 v[172:175], a[208:211], v[148:151], v[172:175]
    s_waitcnt lgkmcnt(5)
    ds_read_b64_tr_b16 a[202:203], v3 offset:26624
    v_mfma_f32_16x16x32_bf16 v[184:187], a[212:215], v[144:147], v[184:187]
    s_add_u32 s39, s100, 147456
    ds_read_b64_tr_b16 a[204:205], v4 offset:24576
    v_mfma_f32_16x16x32_bf16 v[188:191], a[212:215], v[148:151], v[188:191]
    s_waitcnt lgkmcnt(5)
    ds_read_b64_tr_b16 a[206:207], v4 offset:26624
    v_mfma_f32_16x16x32_bf16 v[136:139], a[192:195], v[160:163], v[136:139]
    s_add_u32 s92, s92, s93
    ds_read_b64_tr_b16 a[208:209], v1 offset:28672
    buffer_load_dwordx4 v0, s[16:19], s39 offen lds
    v_mfma_f32_16x16x32_bf16 v[140:143], a[192:195], v[164:167], v[140:143]
    s_waitcnt lgkmcnt(5)
    ds_read_b64_tr_b16 a[210:211], v1 offset:30720
    v_mfma_f32_16x16x32_bf16 v[152:155], a[196:199], v[160:163], v[152:155]
    s_and_b32 s93, s29, 1
    ds_read_b64_tr_b16 a[212:213], v2 offset:28672
    v_mfma_f32_16x16x32_bf16 v[156:159], a[196:199], v[164:167], v[156:159]
    s_waitcnt lgkmcnt(5)
    ds_read_b64_tr_b16 a[214:215], v2 offset:30720
    buffer_load_dwordx4 a[96:99], v29, s[20:23], s52 offen offset:0 sc1
    v_mfma_f32_16x16x32_bf16 v[168:171], a[200:203], v[160:163], v[168:171]
    s_lshl_b32 s93, s93, 7
    ds_read_b64_tr_b16 a[192:193], v3 offset:28672
    v_mfma_f32_16x16x32_bf16 v[172:175], a[200:203], v[164:167], v[172:175]
    s_waitcnt lgkmcnt(5)
    ds_read_b64_tr_b16 a[194:195], v3 offset:30720
    v_mfma_f32_16x16x32_bf16 v[184:187], a[204:207], v[160:163], v[184:187]
    s_add_u32 s92, s92, s93
    ds_read_b64_tr_b16 a[196:197], v4 offset:28672
    buffer_load_dwordx4 a[100:103], v29, s[20:23], s52 offen offset:1024 sc1
    v_mfma_f32_16x16x32_bf16 v[188:191], a[204:207], v[164:167], v[188:191]
    s_waitcnt lgkmcnt(5)
    ds_read_b64_tr_b16 a[198:199], v4 offset:30720
    v_mfma_f32_16x16x32_bf16 v[136:139], a[208:211], v[176:179], v[136:139]
    s_add_u32 s52, s52, 2048
    ds_read_b64_tr_b16 a[200:201], v1 offset:32768
    v_mfma_f32_16x16x32_bf16 v[140:143], a[208:211], v[180:183], v[140:143]
    s_waitcnt lgkmcnt(5)
    ds_read_b64_tr_b16 a[202:203], v1 offset:34816
    buffer_load_dwordx4 a[104:107], v29, s[20:23], s52 offen offset:0 sc1
    v_mfma_f32_16x16x32_bf16 v[152:155], a[212:215], v[176:179], v[152:155]
    s_lshl_b32 s93, s34, 11
    ds_read_b64_tr_b16 a[204:205], v2 offset:32768
    v_mfma_f32_16x16x32_bf16 v[156:159], a[212:215], v[180:183], v[156:159]
    s_waitcnt lgkmcnt(5)
    ds_read_b64_tr_b16 a[206:207], v2 offset:34816
    v_mfma_f32_16x16x32_bf16 v[168:171], a[192:195], v[176:179], v[168:171]
    s_add_u32 s92, s92, s93
    ds_read_b64_tr_b16 a[208:209], v3 offset:32768
    buffer_load_dwordx4 a[108:111], v29, s[20:23], s52 offen offset:1024 sc1
    v_mfma_f32_16x16x32_bf16 v[172:175], a[192:195], v[180:183], v[172:175]
    s_waitcnt lgkmcnt(5)
    ds_read_b64_tr_b16 a[210:211], v3 offset:34816
    v_mfma_f32_16x16x32_bf16 v[184:187], a[196:199], v[176:179], v[184:187]
    s_add_u32 s52, s52, 2048
    ds_read_b64_tr_b16 a[212:213], v4 offset:32768
    v_mfma_f32_16x16x32_bf16 v[188:191], a[196:199], v[180:183], v[188:191]
    s_waitcnt lgkmcnt(5)
    ds_read_b64_tr_b16 a[214:215], v4 offset:34816
    buffer_load_dwordx4 a[112:115], v29, s[20:23], s52 offen offset:0 sc1
    v_add_u32 v1, 36864, v1
    v_add_u32 v2, 36864, v2
    v_add_u32 v3, 36864, v3
    v_add_u32 v4, 36864, v4
    v_mfma_f32_16x16x32_bf16 v[136:139], a[200:203], v[192:195], v[136:139]
    s_waitcnt vmcnt(14)
    s_cmp_eq_u32 s30, 0
    s_cbranch_scc1 Kspin_30
Kok_29:
    s_barrier
    ds_read_b64_tr_b16 a[192:193], v1 offset:0
    v_mfma_f32_16x16x32_bf16 v[140:143], a[200:203], v[196:199], v[140:143]
    s_waitcnt lgkmcnt(5)
    ds_read_b64_tr_b16 a[194:195], v1 offset:2048
    v_mfma_f32_16x16x32_bf16 v[152:155], a[204:207], v[192:195], v[152:155]
    s_lshl_b32 s93, s33, 9
    ds_read_b64_tr_b16 a[196:197], v2 offset:0
    buffer_load_dwordx4 a[116:119], v29, s[20:23], s52 offen offset:1024 sc1
    v_mfma_f32_16x16x32_bf16 v[156:159], a[204:207], v[196:199], v[156:159]
    s_waitcnt lgkmcnt(5)
    ds_read_b64_tr_b16 a[198:199], v2 offset:2048
    v_mfma_f32_16x16x32_bf16 v[168:171], a[208:211], v[192:195], v[168:171]
    s_add_u32 s52, s52, 2048
    ds_read_b64_tr_b16 a[200:201], v3 offset:0
    v_mfma_f32_16x16x32_bf16 v[172:175], a[208:211], v[196:199], v[172:175]
    s_waitcnt lgkmcnt(5)
    ds_read_b64_tr_b16 a[202:203], v3 offset:2048
    buffer_load_dwordx4 a[120:123], v29, s[20:23], s52 offen offset:0 sc1
    v_mfma_f32_16x16x32_bf16 v[184:187], a[212:215], v[192:195], v[184:187]
    s_add_u32 s92, s92, s93
    ds_read_b64_tr_b16 a[204:205], v4 offset:0
    v_mfma_f32_16x16x32_bf16 v[188:191], a[212:215], v[196:199], v[188:191]
    s_waitcnt lgkmcnt(5)
    ds_read_b64_tr_b16 a[206:207], v4 offset:2048
    s_lshl_b32 s53, s32, 13
    s_add_u32 s53, s53, 46146048
    s_lshr_b32 s93, s29, 1
    s_mul_i32 s93, s93, 768
    s_and_b32 s94, s29, 1
    s_lshl_b32 s94, s94, 5
    s_add_u32 s93, s93, s94
    s_add_u32 s51, s93, 2359296
    v_and_b32 v12, 7, v30
    v_lshlrev_b32 v12, 2, v12
    v_mfma_f32_16x16x32_bf16 v[208:211], a[192:195], v[64:67], 0
    s_add_u32 m0, s40, 0
    ds_read_b64_tr_b16 a[208:209], v1 offset:4096
    v_mfma_f32_16x16x32_bf16 v[212:215], a[192:195], v[68:71], 0
    s_waitcnt lgkmcnt(5)
    ds_read_b64_tr_b16 a[210:211], v1 offset:6144
    v_mfma_f32_16x16x32_bf16 v[216:219], a[196:199], v[64:67], 0
    s_add_u32 s39, s100, 147584
    ds_read_b64_tr_b16 a[212:213], v2 offset:4096
    v_mfma_f32_16x16x32_bf16 v[220:223], a[196:199], v[68:71], 0
    s_waitcnt lgkmcnt(5)
    ds_read_b64_tr_b16 a[214:215], v2 offset:6144
    buffer_load_dwordx4 v0, s[16:19], s39 offen lds
    v_mfma_f32_16x16x32_bf16 v[224:227], a[200:203], v[64:67], 0
    s_add_u32 m0, s40, 4096
    ds_read_b64_tr_b16 a[192:193], v3 offset:4096
    v_mfma_f32_16x16x32_bf16 v[228:231], a[200:203], v[68:71], 0
    s_waitcnt lgkmcnt(5)
    ds_read_b64_tr_b16 a[194:195], v3 offset:6144
    v_mfma_f32_16x16x32_bf16 v[232:235], a[204:207], v[64:67], 0
    s_add_u32 s39, s100, 184320
    ds_read_b64_tr_b16 a[196:197], v4 offset:4096
    buffer_load_dwordx4 v0, s[16:19], s39 offen lds
    v_mfma_f32_16x16x32_bf16 v[236:239], a[204:207], v[68:71], 0
    s_waitcnt lgkmcnt(5)
    ds_read_b64_tr_b16 a[198:199], v4 offset:6144
    v_mfma_f32_16x16x32_bf16 v[208:211], a[208:211], v[80:83], v[208:211]
    s_add_u32 m0, s40, 8192
    ds_read_b64_tr_b16 a[200:201], v1 offset:8192
    v_mfma_f32_16x16x32_bf16 v[212:215], a[208:211], v[84:87], v[212:215]
    s_waitcnt lgkmcnt(5)
    ds_read_b64_tr_b16 a[202:203], v1 offset:10240
    v_mfma_f32_16x16x32_bf16 v[216:219], a[212:215], v[80:83], v[216:219]
    s_add_u32 s39, s100, 184448
    ds_read_b64_tr_b16 a[204:205], v2 offset:8192
    v_mfma_f32_16x16x32_bf16 v[220:223], a[212:215], v[84:87], v[220:223]
    s_waitcnt lgkmcnt(5)
    ds_read_b64_tr_b16 a[206:207], v2 offset:10240
    v_mfma_f32_16x16x32_bf16 v[224:227], a[192:195], v[80:83], v[224:227]
    ds_read_b64_tr_b16 a[208:209], v3 offset:8192
    buffer_load_dwordx4 v0, s[16:19], s39 offen lds
    v_mfma_f32_16x16x32_bf16 v[228:231], a[192:195], v[84:87], v[228:231]
    s_waitcnt lgkmcnt(5)
    ds_read_b64_tr_b16 a[210:211], v3 offset:10240
    v_mfma_f32_16x16x32_bf16 v[232:235], a[196:199], v[80:83], v[232:235]
    s_add_u32 m0, s40, 12288
    ds_read_b64_tr_b16 a[212:213], v4 offset:8192
    v_mfma_f32_16x16x32_bf16 v[236:239], a[196:199], v[84:87], v[236:239]
    s_waitcnt lgkmcnt(5)
    ds_read_b64_tr_b16 a[214:215], v4 offset:10240
    v_mfma_f32_16x16x32_bf16 v[208:211], a[200:203], v[96:99], v[208:211]
    s_add_u32 s39, s100, 221184
    ds_read_b64_tr_b16 a[192:193], v1 offset:12288
    v_mfma_f32_16x16x32_bf16 v[212:215], a[200:203], v[100:103], v[212:215]
    s_waitcnt lgkmcnt(5)
    ds_read_b64_tr_b16 a[194:195], v1 offset:14336
    v_mfma_f32_16x16x32_bf16 v[216:219], a[204:207], v[96:99], v[216:219]
    ds_read_b64_tr_b16 a[196:197], v2 offset:12288
    buffer_load_dwordx4 v0, s[16:19], s39 offen lds
    v_mfma_f32_16x16x32_bf16 v[220:223], a[204:207], v[100:103], v[220:223]
    s_waitcnt lgkmcnt(5)
    ds_read_b64_tr_b16 a[198:199], v2 offset:14336
    v_mfma_f32_16x16x32_bf16 v[224:227], a[208:211], v[96:99], v[224:227]
    s_add_u32 m0, s40, 16384
    ds_read_b64_tr_b16 a[200:201], v3 offset:12288
    v_mfma_f32_16x16x32_bf16 v[228:231], a[208:211], v[100:103], v[228:231]
    s_waitcnt lgkmcnt(5)
    ds_read_b64_tr_b16 a[202:203], v3 offset:14336
    v_mfma_f32_16x16x32_bf16 v[232:235], a[212:215], v[96:99], v[232:235]
    s_add_u32 s39, s100, 221312
    ds_read_b64_tr_b16 a[204:205], v4 offset:12288
    v_mfma_f32_16x16x32_bf16 v[236:239], a[212:215], v[100:103], v[236:239]
    s_waitcnt lgkmcnt(5)
    ds_read_b64_tr_b16 a[206:207], v4 offset:14336
    v_mfma_f32_16x16x32_bf16 v[208:211], a[192:195], v[112:115], v[208:211]
    ds_read_b64_tr_b16 a[208:209], v1 offset:16384
    buffer_load_dwordx4 v0, s[16:19], s39 offen lds
    v_mfma_f32_16x16x32_bf16 v[212:215], a[192:195], v[116:119], v[212:215]
    s_waitcnt lgkmcnt(5)
    ds_read_b64_tr_b16 a[210:211], v1 offset:18432
    v_mfma_f32_16x16x32_bf16 v[216:219], a[196:199], v[112:115], v[216:219]
    s_add_u32 m0, s40, 20480
    ds_read_b64_tr_b16 a[212:213], v2 offset:16384
    v_mfma_f32_16x16x32_bf16 v[220:223], a[196:199], v[116:119], v[220:223]
    s_waitcnt lgkmcnt(5)
    ds_read_b64_tr_b16 a[214:215], v2 offset:18432
    v_mfma_f32_16x16x32_bf16 v[224:227], a[200:203], v[112:115], v[224:227]
    s_add_u32 s39, s100, 258048
    ds_read_b64_tr_b16 a[192:193], v3 offset:16384
    v_mfma_f32_16x16x32_bf16 v[228:231], a[200:203], v[116:119], v[228:231]
    s_waitcnt lgkmcnt(5)
    ds_read_b64_tr_b16 a[194:195], v3 offset:18432
    v_mfma_f32_16x16x32_bf16 v[232:235], a[204:207], v[112:115], v[232:235]
    ds_read_b64_tr_b16 a[196:197], v4 offset:16384
    buffer_load_dwordx4 v0, s[16:19], s39 offen lds
    v_mfma_f32_16x16x32_bf16 v[236:239], a[204:207], v[116:119], v[236:239]
    s_waitcnt lgkmcnt(5)
    ds_read_b64_tr_b16 a[198:199], v4 offset:18432
    v_mfma_f32_16x16x32_bf16 v[208:211], a[208:211], v[128:131], v[208:211]
    s_add_u32 m0, s40, 24576
    ds_read_b64_tr_b16 a[200:201], v1 offset:20480
    v_mfma_f32_16x16x32_bf16 v[212:215], a[208:211], v[132:135], v[212:215]
    s_waitcnt lgkmcnt(5)
    ds_read_b64_tr_b16 a[202:203], v1 offset:22528
    v_mfma_f32_16x16x32_bf16 v[216:219], a[212:215], v[128:131], v[216:219]
    s_add_u32 s39, s100, 258176
    ds_read_b64_tr_b16 a[204:205], v2 offset:20480
    v_mfma_f32_16x16x32_bf16 v[220:223], a[212:215], v[132:135], v[220:223]
    s_waitcnt lgkmcnt(5)
    ds_read_b64_tr_b16 a[206:207], v2 offset:22528
    v_mfma_f32_16x16x32_bf16 v[224:227], a[192:195], v[128:131], v[224:227]
    ds_read_b64_tr_b16 a[208:209], v3 offset:20480
    buffer_load_dwordx4 v0, s[16:19], s39 offen lds
    v_mfma_f32_16x16x32_bf16 v[228:231], a[192:195], v[132:135], v[228:231]
    s_waitcnt lgkmcnt(5)
    ds_read_b64_tr_b16 a[210:211], v3 offset:22528
    v_mfma_f32_16x16x32_bf16 v[232:235], a[196:199], v[128:131], v[232:235]
    s_add_u32 m0, s40, 28672
    ds_read_b64_tr_b16 a[212:213], v4 offset:20480
    v_mfma_f32_16x16x32_bf16 v[236:239], a[196:199], v[132:135], v[236:239]
    s_waitcnt lgkmcnt(5)
    ds_read_b64_tr_b16 a[214:215], v4 offset:22528
    v_mfma_f32_16x16x32_bf16 v[208:211], a[200:203], v[144:147], v[208:211]
    s_add_u32 s39, s100, 294912
    ds_read_b64_tr_b16 a[192:193], v1 offset:24576
    v_mfma_f32_16x16x32_bf16 v[212:215], a[200:203], v[148:151], v[212:215]
    s_waitcnt lgkmcnt(5)
    ds_read_b64_tr_b16 a[194:195], v1 offset:26624
    v_mfma_f32_16x16x32_bf16 v[216:219], a[204:207], v[144:147], v[216:219]
    ds_read_b64_tr_b16 a[196:197], v2 offset:24576
    buffer_load_dwordx4 v0, s[16:19], s39 offen lds
    v_mfma_f32_16x16x32_bf16 v[220:223], a[204:207], v[148:151], v[220:223]
    s_waitcnt lgkmcnt(5)
    ds_read_b64_tr_b16 a[198:199], v2 offset:26624
    v_mfma_f32_16x16x32_bf16 v[224:227], a[208:211], v[144:147], v[224:227]
    s_add_u32 m0, s40, 32768
    ds_read_b64_tr_b16 a[200:201], v3 offset:24576
    v_mfma_f32_16x16x32_bf16 v[228:231], a[208:211], v[148:151], v[228:231]
    s_waitcnt lgkmcnt(5)
    ds_read_b64_tr_b16 a[202:203], v3 offset:26624
    v_mfma_f32_16x16x32_bf16 v[232:235], a[212:215], v[144:147], v[232:235]
    s_add_u32 s39, s100, 295040
    ds_read_b64_tr_b16 a[204:205], v4 offset:24576
    v_mfma_f32_16x16x32_bf16 v[236:239], a[212:215], v[148:151], v[236:239]
    s_waitcnt lgkmcnt(5)
    ds_read_b64_tr_b16 a[206:207], v4 offset:26624
    v_mfma_f32_16x16x32_bf16 v[208:211], a[192:195], v[160:163], v[208:211]
    ds_read_b64_tr_b16 a[208:209], v1 offset:28672
    buffer_load_dwordx4 v0, s[16:19], s39 offen lds
    v_mfma_f32_16x16x32_bf16 v[212:215], a[192:195], v[164:167], v[212:215]
    s_waitcnt lgkmcnt(5)
    ds_read_b64_tr_b16 a[210:211], v1 offset:30720
    v_mfma_f32_16x16x32_bf16 v[216:219], a[196:199], v[160:163], v[216:219]
    ds_read_b64_tr_b16 a[212:213], v2 offset:28672
    v_mfma_f32_16x16x32_bf16 v[220:223], a[196:199], v[164:167], v[220:223]
    s_waitcnt lgkmcnt(5)
    ds_read_b64_tr_b16 a[214:215], v2 offset:30720
    buffer_load_dwordx4 a[124:127], v29, s[20:23], s52 offen offset:1024 sc1
    v_mfma_f32_16x16x32_bf16 v[224:227], a[200:203], v[160:163], v[224:227]
    s_add_u32 s52, s52, 2048
    ds_read_b64_tr_b16 a[192:193], v3 offset:28672
    v_mfma_f32_16x16x32_bf16 v[228:231], a[200:203], v[164:167], v[228:231]
    s_waitcnt lgkmcnt(5)
    ds_read_b64_tr_b16 a[194:195], v3 offset:30720
    v_mfma_f32_16x16x32_bf16 v[232:235], a[204:207], v[160:163], v[232:235]
    ds_read_b64_tr_b16 a[196:197], v4 offset:28672
    buffer_load_dwordx4 a[128:131], v29, s[20:23], s52 offen offset:0 sc1
    v_mfma_f32_16x16x32_bf16 v[236:239], a[204:207], v[164:167], v[236:239]
    s_waitcnt lgkmcnt(5)
    ds_read_b64_tr_b16 a[198:199], v4 offset:30720
    v_mfma_f32_16x16x32_bf16 v[208:211], a[208:211], v[176:179], v[208:211]
    ds_read_b64_tr_b16 a[200:201], v1 offset:32768
    v_mfma_f32_16x16x32_bf16 v[212:215], a[208:211], v[180:183], v[212:215]
    s_waitcnt lgkmcnt(5)
    ds_read_b64_tr_b16 a[202:203], v1 offset:34816
    buffer_load_dwordx4 a[132:135], v29, s[20:23], s52 offen offset:1024 sc1
    v_mfma_f32_16x16x32_bf16 v[216:219], a[212:215], v[176:179], v[216:219]
    s_add_u32 s52, s52, 2048
    ds_read_b64_tr_b16 a[204:205], v2 offset:32768
    v_mfma_f32_16x16x32_bf16 v[220:223], a[212:215], v[180:183], v[220:223]
    s_waitcnt lgkmcnt(5)
    ds_read_b64_tr_b16 a[206:207], v2 offset:34816
    v_mfma_f32_16x16x32_bf16 v[224:227], a[192:195], v[176:179], v[224:227]
    ds_read_b64_tr_b16 a[208:209], v3 offset:32768
    buffer_load_dwordx4 a[136:139], v29, s[20:23], s52 offen offset:0 sc1
    v_mfma_f32_16x16x32_bf16 v[228:231], a[192:195], v[180:183], v[228:231]
    s_waitcnt lgkmcnt(5)
    ds_read_b64_tr_b16 a[210:211], v3 offset:34816
    v_mfma_f32_16x16x32_bf16 v[232:235], a[196:199], v[176:179], v[232:235]
    ds_read_b64_tr_b16 a[212:213], v4 offset:32768
    v_mfma_f32_16x16x32_bf16 v[236:239], a[196:199], v[180:183], v[236:239]
    s_waitcnt lgkmcnt(5)
    ds_read_b64_tr_b16 a[214:215], v4 offset:34816
    buffer_load_dwordx4 a[140:143], v29, s[20:23], s52 offen offset:1024 sc1
    s_add_u32 s52, s52, 2048
    v_add_u32 v1, 36864, v1
    v_add_u32 v2, 36864, v2
    v_add_u32 v3, 36864, v3
    v_add_u32 v4, 36864, v4
    v_mfma_f32_16x16x32_bf16 v[208:211], a[200:203], v[192:195], v[208:211]
    s_waitcnt vmcnt(21)
    s_barrier
    ds_read_b64_tr_b16 a[192:193], v1 offset:0
    v_mfma_f32_16x16x32_bf16 v[212:215], a[200:203], v[196:199], v[212:215]
    s_waitcnt lgkmcnt(5)
    ds_read_b64_tr_b16 a[194:195], v1 offset:2048
    v_mfma_f32_16x16x32_bf16 v[216:219], a[204:207], v[192:195], v[216:219]
    ds_read_b64_tr_b16 a[196:197], v2 offset:0
    buffer_load_dwordx4 a[144:147], v29, s[20:23], s52 offen offset:0 sc1
    v_mfma_f32_16x16x32_bf16 v[220:223], a[204:207], v[196:199], v[220:223]
    s_waitcnt lgkmcnt(5)
    ds_read_b64_tr_b16 a[198:199], v2 offset:2048
    v_mfma_f32_16x16x32_bf16 v[224:227], a[208:211], v[192:195], v[224:227]
    ds_read_b64_tr_b16 a[200:201], v3 offset:0
    v_mfma_f32_16x16x32_bf16 v[228:231], a[208:211], v[196:199], v[228:231]
    s_waitcnt lgkmcnt(5)
    ds_read_b64_tr_b16 a[202:203], v3 offset:2048
    buffer_load_dwordx4 a[148:151], v29, s[20:23], s52 offen offset:1024 sc1
    v_mfma_f32_16x16x32_bf16 v[232:235], a[212:215], v[192:195], v[232:235]
    s_add_u32 s52, s52, 2048
    ds_read_b64_tr_b16 a[204:205], v4 offset:0
    v_mfma_f32_16x16x32_bf16 v[236:239], a[212:215], v[196:199], v[236:239]
    s_waitcnt lgkmcnt(5)
    ds_read_b64_tr_b16 a[206:207], v4 offset:2048
    s_waitcnt vmcnt(21)
    v_mfma_f32_16x16x32_bf16 a[0:3], a[192:195], a[96:99], a[0:3]
    s_add_u32 m0, s40, 36864
    ds_read_b64_tr_b16 a[208:209], v1 offset:4096
    v_mfma_f32_16x16x32_bf16 a[4:7], a[192:195], a[100:103], a[4:7]
    s_waitcnt lgkmcnt(5)
    ds_read_b64_tr_b16 a[210:211], v1 offset:6144
    v_mfma_f32_16x16x32_bf16 a[8:11], a[196:199], a[96:99], a[8:11]
    s_add_u32 s39, s100, 256
    ds_read_b64_tr_b16 a[212:213], v2 offset:4096
    v_mfma_f32_16x16x32_bf16 a[12:15], a[196:199], a[100:103], a[12:15]
    s_waitcnt lgkmcnt(5)
    ds_read_b64_tr_b16 a[214:215], v2 offset:6144
    buffer_load_dwordx4 v0, s[16:19], s39 offen lds
    v_mfma_f32_16x16x32_bf16 a[16:19], a[200:203], a[96:99], a[16:19]
    s_add_u32 m0, s40, 40960
    ds_read_b64_tr_b16 a[192:193], v3 offset:4096
    v_mfma_f32_16x16x32_bf16 a[20:23], a[200:203], a[100:103], a[20:23]
    s_waitcnt lgkmcnt(5)
    ds_read_b64_tr_b16 a[194:195], v3 offset:6144
    v_mfma_f32_16x16x32_bf16 a[24:27], a[204:207], a[96:99], a[24:27]
    s_add_u32 s39, s100, 37120
    ds_read_b64_tr_b16 a[196:197], v4 offset:4096
    buffer_load_dwordx4 v0, s[16:19], s39 offen lds
    v_mfma_f32_16x16x32_bf16 a[28:31], a[204:207], a[100:103], a[28:31]
    s_waitcnt lgkmcnt(5)
    ds_read_b64_tr_b16 a[198:199], v4 offset:6144
    v_mfma_f32_16x16x32_bf16 a[32:35], a[208:211], a[96:99], a[32:35]
    s_add_u32 m0, s40, 45056
    ds_read_b64_tr_b16 a[200:201], v1 offset:8192
    v_mfma_f32_16x16x32_bf16 a[36:39], a[208:211], a[100:103], a[36:39]
    s_waitcnt lgkmcnt(5)
    ds_read_b64_tr_b16 a[202:203], v1 offset:10240
    v_mfma_f32_16x16x32_bf16 a[40:43], a[212:215], a[96:99], a[40:43]
    s_add_u32 s39, s100, 73984
    ds_read_b64_tr_b16 a[204:205], v2 offset:8192
    v_mfma_f32_16x16x32_bf16 a[44:47], a[212:215], a[100:103], a[44:47]
    s_waitcnt lgkmcnt(5)
    ds_read_b64_tr_b16 a[206:207], v2 offset:10240
    v_mfma_f32_16x16x32_bf16 a[48:51], a[192:195], a[96:99], a[48:51]
    ds_read_b64_tr_b16 a[208:209], v3 offset:8192
    buffer_load_dwordx4 v0, s[16:19], s39 offen lds
    v_mfma_f32_16x16x32_bf16 a[52:55], a[192:195], a[100:103], a[52:55]
    s_waitcnt lgkmcnt(5)
    ds_read_b64_tr_b16 a[210:211], v3 offset:10240
    v_mfma_f32_16x16x32_bf16 a[56:59], a[196:199], a[96:99], a[56:59]
    s_add_u32 m0, s40, 49152
    ds_read_b64_tr_b16 a[212:213], v4 offset:8192
    v_mfma_f32_16x16x32_bf16 a[60:63], a[196:199], a[100:103], a[60:63]
    s_waitcnt lgkmcnt(5)
    ds_read_b64_tr_b16 a[214:215], v4 offset:10240
    s_waitcnt vmcnt(22)
    v_mfma_f32_16x16x32_bf16 a[0:3], a[200:203], a[104:107], a[0:3]
    s_add_u32 s39, s100, 110848
    ds_read_b64_tr_b16 a[192:193], v1 offset:12288
    v_mfma_f32_16x16x32_bf16 a[4:7], a[200:203], a[108:111], a[4:7]
    s_waitcnt lgkmcnt(5)
    ds_read_b64_tr_b16 a[194:195], v1 offset:14336
    v_mfma_f32_16x16x32_bf16 a[8:11], a[204:207], a[104:107], a[8:11]
    ds_read_b64_tr_b16 a[196:197], v2 offset:12288
    buffer_load_dwordx4 v0, s[16:19], s39 offen lds
    v_mfma_f32_16x16x32_bf16 a[12:15], a[204:207], a[108:111], a[12:15]
    s_waitcnt lgkmcnt(5)
    ds_read_b64_tr_b16 a[198:199], v2 offset:14336
    v_mfma_f32_16x16x32_bf16 a[16:19], a[208:211], a[104:107], a[16:19]
    s_add_u32 m0, s40, 53248
    ds_read_b64_tr_b16 a[200:201], v3 offset:12288
    v_mfma_f32_16x16x32_bf16 a[20:23], a[208:211], a[108:111], a[20:23]
    s_waitcnt lgkmcnt(5)
    ds_read_b64_tr_b16 a[202:203], v3 offset:14336
    v_mfma_f32_16x16x32_bf16 a[24:27], a[212:215], a[104:107], a[24:27]
    s_add_u32 s39, s100, 147712
    ds_read_b64_tr_b16 a[204:205], v4 offset:12288
    v_mfma_f32_16x16x32_bf16 a[28:31], a[212:215], a[108:111], a[28:31]
    s_waitcnt lgkmcnt(5)
    ds_read_b64_tr_b16 a[206:207], v4 offset:14336
    v_mfma_f32_16x16x32_bf16 a[32:35], a[192:195], a[104:107], a[32:35]
    ds_read_b64_tr_b16 a[208:209], v1 offset:16384
    buffer_load_dwordx4 v0, s[16:19], s39 offen lds
    v_mfma_f32_16x16x32_bf16 a[36:39], a[192:195], a[108:111], a[36:39]
    s_waitcnt lgkmcnt(5)
    ds_read_b64_tr_b16 a[210:211], v1 offset:18432
    v_mfma_f32_16x16x32_bf16 a[40:43], a[196:199], a[104:107], a[40:43]
    s_add_u32 m0, s40, 57344
    ds_read_b64_tr_b16 a[212:213], v2 offset:16384
    v_mfma_f32_16x16x32_bf16 a[44:47], a[196:199], a[108:111], a[44:47]
    s_waitcnt lgkmcnt(5)
    ds_read_b64_tr_b16 a[214:215], v2 offset:18432
    v_mfma_f32_16x16x32_bf16 a[48:51], a[200:203], a[104:107], a[48:51]
    s_add_u32 s39, s100, 184576
    ds_read_b64_tr_b16 a[192:193], v3 offset:16384
    v_cvt_pk_bf16_f32 v32, v208, v209
    v_mfma_f32_16x16x32_bf16 a[52:55], a[200:203], a[108:111], a[52:55]
    s_waitcnt lgkmcnt(5)
    ds_read_b64_tr_b16 a[194:195], v3 offset:18432
    v_cvt_pk_bf16_f32 v33, v210, v211
    v_mfma_f32_16x16x32_bf16 a[56:59], a[204:207], a[104:107], a[56:59]
    ds_read_b64_tr_b16 a[196:197], v4 offset:16384
    buffer_load_dwordx4 v0, s[16:19], s39 offen lds
    v_mfma_f32_16x16x32_bf16 a[60:63], a[204:207], a[108:111], a[60:63]
    s_waitcnt lgkmcnt(5)
    ds_read_b64_tr_b16 a[198:199], v4 offset:18432
    v_cvt_pk_bf16_f32 v34, v216, v217
    s_waitcnt vmcnt(23)
    v_mfma_f32_16x16x32_bf16 a[0:3], a[208:211], a[112:115], a[0:3]
    s_add_u32 m0, s40, 61440
    ds_read_b64_tr_b16 a[200:201], v1 offset:20480
    v_cvt_pk_bf16_f32 v35, v218, v219
    v_mfma_f32_16x16x32_bf16 a[4:7], a[208:211], a[116:119], a[4:7]
    s_waitcnt lgkmcnt(5)
    ds_read_b64_tr_b16 a[202:203], v1 offset:22528
    buffer_store_dwordx4 v[32:35], v15, s[20:23], s46 offen offset:0 sc1
    v_mfma_f32_16x16x32_bf16 a[8:11], a[212:215], a[112:115], a[8:11]
    s_add_u32 s39, s100, 221440
    ds_read_b64_tr_b16 a[204:205], v2 offset:20480
    v_cvt_pk_bf16_f32 v36, v212, v213
    v_mfma_f32_16x16x32_bf16 a[12:15], a[212:215], a[116:119], a[12:15]
    s_waitcnt lgkmcnt(5)
    ds_read_b64_tr_b16 a[206:207], v2 offset:22528
    v_cvt_pk_bf16_f32 v37, v214, v215
    v_mfma_f32_16x16x32_bf16 a[16:19], a[192:195], a[112:115], a[16:19]
    ds_read_b64_tr_b16 a[208:209], v3 offset:20480
    buffer_load_dwordx4 v0, s[16:19], s39 offen lds
    v_mfma_f32_16x16x32_bf16 a[20:23], a[192:195], a[116:119], a[20:23]
    s_waitcnt lgkmcnt(5)
    ds_read_b64_tr_b16 a[210:211], v3 offset:22528
    v_cvt_pk_bf16_f32 v38, v220, v221
    v_mfma_f32_16x16x32_bf16 a[24:27], a[196:199], a[112:115], a[24:27]
    s_add_u32 m0, s40, 65536
    ds_read_b64_tr_b16 a[212:213], v4 offset:20480
    v_cvt_pk_bf16_f32 v39, v222, v223
    v_mfma_f32_16x16x32_bf16 a[28:31], a[196:199], a[116:119], a[28:31]
    s_waitcnt lgkmcnt(5)
    ds_read_b64_tr_b16 a[214:215], v4 offset:22528
    buffer_store_dwordx4 v[36:39], v15, s[20:23], s47 offen offset:0 sc1
    v_mfma_f32_16x16x32_bf16 a[32:35], a[200:203], a[112:115], a[32:35]
    s_add_u32 s39, s100, 258304
    ds_read_b64_tr_b16 a[192:193], v1 offset:24576
    v_cvt_pk_bf16_f32 v40, v224, v225
    v_mfma_f32_16x16x32_bf16 a[36:39], a[200:203], a[116:119], a[36:39]
    s_waitcnt lgkmcnt(5)
    ds_read_b64_tr_b16 a[194:195], v1 offset:26624
    v_cvt_pk_bf16_f32 v41, v226, v227
    v_mfma_f32_16x16x32_bf16 a[40:43], a[204:207], a[112:115], a[40:43]
    ds_read_b64_tr_b16 a[196:197], v2 offset:24576
    buffer_load_dwordx4 v0, s[16:19], s39 offen lds
    v_mfma_f32_16x16x32_bf16 a[44:47], a[204:207], a[116:119], a[44:47]
    s_waitcnt lgkmcnt(5)
    ds_read_b64_tr_b16 a[198:199], v2 offset:26624
    v_cvt_pk_bf16_f32 v42, v232, v233
    v_mfma_f32_16x16x32_bf16 a[48:51], a[208:211], a[112:115], a[48:51]
    s_add_u32 m0, s40, 69632
    ds_read_b64_tr_b16 a[200:201], v3 offset:24576
    v_cvt_pk_bf16_f32 v43, v234, v235
    v_mfma_f32_16x16x32_bf16 a[52:55], a[208:211], a[116:119], a[52:55]
    s_waitcnt lgkmcnt(5)
    ds_read_b64_tr_b16 a[202:203], v3 offset:26624
    buffer_store_dwordx4 v[40:43], v15, s[20:23], s46 offen offset:512 sc1
    v_mfma_f32_16x16x32_bf16 a[56:59], a[212:215], a[112:115], a[56:59]
    s_add_u32 s39, s100, 295168
    ds_read_b64_tr_b16 a[204:205], v4 offset:24576
    v_cvt_pk_bf16_f32 v44, v228, v229
    v_mfma_f32_16x16x32_bf16 a[60:63], a[212:215], a[116:119], a[60:63]
    s_waitcnt lgkmcnt(5)
    ds_read_b64_tr_b16 a[206:207], v4 offset:26624
    v_cvt_pk_bf16_f32 v45, v230, v231
    s_waitcnt vmcnt(17)
    v_mfma_f32_16x16x32_bf16 a[0:3], a[192:195], a[120:123], a[0:3]
    ds_read_b64_tr_b16 a[208:209], v1 offset:28672
    buffer_load_dwordx4 v0, s[16:19], s39 offen lds
    v_mfma_f32_16x16x32_bf16 a[4:7], a[192:195], a[124:127], a[4:7]
    s_waitcnt lgkmcnt(5)
    ds_read_b64_tr_b16 a[210:211], v1 offset:30720
    v_cvt_pk_bf16_f32 v46, v236, v237
    v_mfma_f32_16x16x32_bf16 a[8:11], a[196:199], a[120:123], a[8:11]
    ds_read_b64_tr_b16 a[212:213], v2 offset:28672
    v_cvt_pk_bf16_f32 v47, v238, v239
    v_mfma_f32_16x16x32_bf16 a[12:15], a[196:199], a[124:127], a[12:15]
    s_waitcnt lgkmcnt(5)
    ds_read_b64_tr_b16 a[214:215], v2 offset:30720
    buffer_load_dwordx4 a[152:155], v29, s[20:23], s52 offen offset:0 sc1
    v_mfma_f32_16x16x32_bf16 a[16:19], a[200:203], a[120:123], a[16:19]
    ds_read_b64_tr_b16 a[192:193], v3 offset:28672
    buffer_store_dwordx4 v[44:47], v15, s[20:23], s47 offen offset:512 sc1
    v_mfma_f32_16x16x32_bf16 a[20:23], a[200:203], a[124:127], a[20:23]
    s_waitcnt lgkmcnt(5)
    ds_read_b64_tr_b16 a[194:195], v3 offset:30720
    v_mfma_f32_16x16x32_bf16 a[24:27], a[204:207], a[120:123], a[24:27]
    ds_read_b64_tr_b16 a[196:197], v4 offset:28672
    buffer_load_dwordx4 a[156:159], v29, s[20:23], s52 offen offset:1024 sc1
    v_mfma_f32_16x16x32_bf16 a[28:31], a[204:207], a[124:127], a[28:31]
    s_waitcnt lgkmcnt(5)
    ds_read_b64_tr_b16 a[198:199], v4 offset:30720
    v_mfma_f32_16x16x32_bf16 a[32:35], a[208:211], a[120:123], a[32:35]
    s_add_u32 s52, s52, 2048
    ds_read_b64_tr_b16 a[200:201], v1 offset:32768
    v_mfma_f32_16x16x32_bf16 a[36:39], a[208:211], a[124:127], a[36:39]
    s_waitcnt lgkmcnt(5)
    ds_read_b64_tr_b16 a[202:203], v1 offset:34816
    buffer_load_dwordx4 a[160:163], v29, s[20:23], s52 offen offset:0 sc1
    v_mfma_f32_16x16x32_bf16 a[40:43], a[212:215], a[120:123], a[40:43]
    ds_read_b64_tr_b16 a[204:205], v2 offset:32768
    v_mfma_f32_16x16x32_bf16 a[44:47], a[212:215], a[124:127], a[44:47]
    s_waitcnt lgkmcnt(5)
    ds_read_b64_tr_b16 a[206:207], v2 offset:34816
    v_mfma_f32_16x16x32_bf16 a[48:51], a[192:195], a[120:123], a[48:51]
    ds_read_b64_tr_b16 a[208:209], v3 offset:32768
    buffer_load_dwordx4 a[164:167], v29, s[20:23], s52 offen offset:1024 sc1
    v_mfma_f32_16x16x32_bf16 a[52:55], a[192:195], a[124:127], a[52:55]
    s_waitcnt lgkmcnt(5)
    ds_read_b64_tr_b16 a[210:211], v3 offset:34816
    v_mfma_f32_16x16x32_bf16 a[56:59], a[196:199], a[120:123], a[56:59]
    s_add_u32 s52, s52, 2048
    ds_read_b64_tr_b16 a[212:213], v4 offset:32768
    v_mfma_f32_16x16x32_bf16 a[60:63], a[196:199], a[124:127], a[60:63]
    s_waitcnt lgkmcnt(5)
    ds_read_b64_tr_b16 a[214:215], v4 offset:34816
    buffer_load_dwordx4 a[64:67], v7, s[20:23], s92 offen sc1
    s_add_u32 s92, s92, 4096
    s_waitcnt vmcnt(22)
    v_add_u32 v1, -110592, v1
    v_add_u32 v2, -110592, v2
    v_add_u32 v3, -110592, v3
    v_add_u32 v4, -110592, v4
    v_mfma_f32_16x16x32_bf16 a[0:3], a[200:203], a[128:131], a[0:3]
    s_barrier
    ds_read_b64_tr_b16 a[192:193], v1 offset:0
    v_mfma_f32_16x16x32_bf16 a[4:7], a[200:203], a[132:135], a[4:7]
    s_waitcnt lgkmcnt(5)
    ds_read_b64_tr_b16 a[194:195], v1 offset:2048
    v_mfma_f32_16x16x32_bf16 a[8:11], a[204:207], a[128:131], a[8:11]
    ds_read_b64_tr_b16 a[196:197], v2 offset:0
    buffer_load_dwordx4 a[68:71], v7, s[20:23], s92 offen sc1
    v_mfma_f32_16x16x32_bf16 a[12:15], a[204:207], a[132:135], a[12:15]
    s_waitcnt lgkmcnt(5)
    ds_read_b64_tr_b16 a[198:199], v2 offset:2048
    v_mfma_f32_16x16x32_bf16 a[16:19], a[208:211], a[128:131], a[16:19]
    s_add_u32 s92, s92, 4096
    ds_read_b64_tr_b16 a[200:201], v3 offset:0
    v_mfma_f32_16x16x32_bf16 a[20:23], a[208:211], a[132:135], a[20:23]
    s_waitcnt lgkmcnt(5)
    ds_read_b64_tr_b16 a[202:203], v3 offset:2048
    buffer_load_dwordx4 a[72:75], v7, s[20:23], s92 offen sc1
    v_mfma_f32_16x16x32_bf16 a[24:27], a[212:215], a[128:131], a[24:27]
    s_add_u32 s92, s92, 4096
    ds_read_b64_tr_b16 a[204:205], v4 offset:0
    v_mfma_f32_16x16x32_bf16 a[28:31], a[212:215], a[132:135], a[28:31]
    s_waitcnt lgkmcnt(5)
    ds_read_b64_tr_b16 a[206:207], v4 offset:2048
    v_mfma_f32_16x16x32_bf16 a[32:35], a[192:195], a[128:131], a[32:35]
    s_add_u32 m0, s40, 73728
    ds_read_b64_tr_b16 a[208:209], v1 offset:4096
    v_mfma_f32_16x16x32_bf16 a[36:39], a[192:195], a[132:135], a[36:39]
    s_waitcnt lgkmcnt(5)
    ds_read_b64_tr_b16 a[210:211], v1 offset:6144
    v_mfma_f32_16x16x32_bf16 a[40:43], a[196:199], a[128:131], a[40:43]
    s_add_u32 s39, s100, 384
    ds_read_b64_tr_b16 a[212:213], v2 offset:4096
    v_mfma_f32_16x16x32_bf16 a[44:47], a[196:199], a[132:135], a[44:47]
    s_waitcnt lgkmcnt(5)
    ds_read_b64_tr_b16 a[214:215], v2 offset:6144
    buffer_load_dwordx4 v0, s[16:19], s39 offen lds
    v_mfma_f32_16x16x32_bf16 a[48:51], a[200:203], a[128:131], a[48:51]
    s_add_u32 m0, s40, 77824
    ds_read_b64_tr_b16 a[192:193], v3 offset:4096
    v_mfma_f32_16x16x32_bf16 a[52:55], a[200:203], a[132:135], a[52:55]
    s_waitcnt lgkmcnt(5)
    ds_read_b64_tr_b16 a[194:195], v3 offset:6144
    v_mfma_f32_16x16x32_bf16 a[56:59], a[204:207], a[128:131], a[56:59]
    s_add_u32 s39, s100, 37248
    ds_read_b64_tr_b16 a[196:197], v4 offset:4096
    buffer_load_dwordx4 v0, s[16:19], s39 offen lds
    v_mfma_f32_16x16x32_bf16 a[60:63], a[204:207], a[132:135], a[60:63]
    s_waitcnt lgkmcnt(5)
    ds_read_b64_tr_b16 a[198:199], v4 offset:6144
    s_waitcnt vmcnt(24)
    v_mfma_f32_16x16x32_bf16 a[0:3], a[208:211], a[136:139], a[0:3]
    s_add_u32 m0, s40, 81920
    ds_read_b64_tr_b16 a[200:201], v1 offset:8192
    v_mfma_f32_16x16x32_bf16 a[4:7], a[208:211], a[140:143], a[4:7]
    s_waitcnt lgkmcnt(5)
    ds_read_b64_tr_b16 a[202:203], v1 offset:10240
    v_mfma_f32_16x16x32_bf16 a[8:11], a[212:215], a[136:139], a[8:11]
    s_add_u32 s39, s100, 74112
    ds_read_b64_tr_b16 a[204:205], v2 offset:8192
    v_mfma_f32_16x16x32_bf16 a[12:15], a[212:215], a[140:143], a[12:15]
    s_waitcnt lgkmcnt(5)
    ds_read_b64_tr_b16 a[206:207], v2 offset:10240
    v_mfma_f32_16x16x32_bf16 a[16:19], a[192:195], a[136:139], a[16:19]
    ds_read_b64_tr_b16 a[208:209], v3 offset:8192
    buffer_load_dwordx4 v0, s[16:19], s39 offen lds
    v_mfma_f32_16x16x32_bf16 a[20:23], a[192:195], a[140:143], a[20:23]
    s_waitcnt lgkmcnt(5)
    ds_read_b64_tr_b16 a[210:211], v3 offset:10240
    v_mfma_f32_16x16x32_bf16 a[24:27], a[196:199], a[136:139], a[24:27]
    s_add_u32 m0, s40, 86016
    ds_read_b64_tr_b16 a[212:213], v4 offset:8192
    v_mfma_f32_16x16x32_bf16 a[28:31], a[196:199], a[140:143], a[28:31]
    s_waitcnt lgkmcnt(5)
    ds_read_b64_tr_b16 a[214:215], v4 offset:10240
    v_mfma_f32_16x16x32_bf16 a[32:35], a[200:203], a[136:139], a[32:35]
    s_add_u32 s39, s100, 110976
    ds_read_b64_tr_b16 a[192:193], v1 offset:12288
    v_mfma_f32_16x16x32_bf16 a[36:39], a[200:203], a[140:143], a[36:39]
    s_waitcnt lgkmcnt(5)
    ds_read_b64_tr_b16 a[194:195], v1 offset:14336
    v_mfma_f32_16x16x32_bf16 a[40:43], a[204:207], a[136:139], a[40:43]
    ds_read_b64_tr_b16 a[196:197], v2 offset:12288
    buffer_load_dwordx4 v0, s[16:19], s39 offen lds
    v_mfma_f32_16x16x32_bf16 a[44:47], a[204:207], a[140:143], a[44:47]
    s_waitcnt lgkmcnt(5)
    ds_read_b64_tr_b16 a[198:199], v2 offset:14336
    v_mfma_f32_16x16x32_bf16 a[48:51], a[208:211], a[136:139], a[48:51]
    s_add_u32 m0, s40, 90112
    ds_read_b64_tr_b16 a[200:201], v3 offset:12288
    v_mfma_f32_16x16x32_bf16 a[52:55], a[208:211], a[140:143], a[52:55]
    s_waitcnt lgkmcnt(5)
    ds_read_b64_tr_b16 a[202:203], v3 offset:14336
    v_mfma_f32_16x16x32_bf16 a[56:59], a[212:215], a[136:139], a[56:59]
    s_add_u32 s39, s100, 147840
    ds_read_b64_tr_b16 a[204:205], v4 offset:12288
    v_mfma_f32_16x16x32_bf16 a[60:63], a[212:215], a[140:143], a[60:63]
    s_waitcnt lgkmcnt(5)
    ds_read_b64_tr_b16 a[206:207], v4 offset:14336
    s_waitcnt vmcnt(24)
    v_mfma_f32_16x16x32_bf16 a[0:3], a[192:195], a[144:147], a[0:3]
    ds_read_b64_tr_b16 a[208:209], v1 offset:16384
    buffer_load_dwordx4 v0, s[16:19], s39 offen lds
    v_mfma_f32_16x16x32_bf16 a[4:7], a[192:195], a[148:151], a[4:7]
    s_waitcnt lgkmcnt(5)
    ds_read_b64_tr_b16 a[210:211], v1 offset:18432
    v_mfma_f32_16x16x32_bf16 a[8:11], a[196:199], a[144:147], a[8:11]
    s_add_u32 m0, s40, 94208
    ds_read_b64_tr_b16 a[212:213], v2 offset:16384
    v_mfma_f32_16x16x32_bf16 a[12:15], a[196:199], a[148:151], a[12:15]
    s_waitcnt lgkmcnt(5)
    ds_read_b64_tr_b16 a[214:215], v2 offset:18432
    v_mfma_f32_16x16x32_bf16 a[16:19], a[200:203], a[144:147], a[16:19]
    s_add_u32 s39, s100, 184704
    ds_read_b64_tr_b16 a[192:193], v3 offset:16384
    v_mfma_f32_16x16x32_bf16 a[20:23], a[200:203], a[148:151], a[20:23]
    s_waitcnt lgkmcnt(5)
    ds_read_b64_tr_b16 a[194:195], v3 offset:18432
    v_mfma_f32_16x16x32_bf16 a[24:27], a[204:207], a[144:147], a[24:27]
    ds_read_b64_tr_b16 a[196:197], v4 offset:16384
    buffer_load_dwordx4 v0, s[16:19], s39 offen lds
    v_mfma_f32_16x16x32_bf16 a[28:31], a[204:207], a[148:151], a[28:31]
    s_waitcnt lgkmcnt(5)
    ds_read_b64_tr_b16 a[198:199], v4 offset:18432
    v_mfma_f32_16x16x32_bf16 a[32:35], a[208:211], a[144:147], a[32:35]
    s_add_u32 m0, s40, 98304
    ds_read_b64_tr_b16 a[200:201], v1 offset:20480
    v_mfma_f32_16x16x32_bf16 a[36:39], a[208:211], a[148:151], a[36:39]
    s_waitcnt lgkmcnt(5)
    ds_read_b64_tr_b16 a[202:203], v1 offset:22528
    v_mfma_f32_16x16x32_bf16 a[40:43], a[212:215], a[144:147], a[40:43]
    s_add_u32 s39, s100, 221568
    ds_read_b64_tr_b16 a[204:205], v2 offset:20480
    v_mfma_f32_16x16x32_bf16 a[44:47], a[212:215], a[148:151], a[44:47]
    s_waitcnt lgkmcnt(5)
    ds_read_b64_tr_b16 a[206:207], v2 offset:22528
    v_mfma_f32_16x16x32_bf16 a[48:51], a[192:195], a[144:147], a[48:51]
    ds_read_b64_tr_b16 a[208:209], v3 offset:20480
    buffer_load_dwordx4 v0, s[16:19], s39 offen lds
    v_mfma_f32_16x16x32_bf16 a[52:55], a[192:195], a[148:151], a[52:55]
    s_waitcnt lgkmcnt(5)
    ds_read_b64_tr_b16 a[210:211], v3 offset:22528
    v_mfma_f32_16x16x32_bf16 a[56:59], a[196:199], a[144:147], a[56:59]
    s_add_u32 m0, s40, 102400
    ds_read_b64_tr_b16 a[212:213], v4 offset:20480
    v_mfma_f32_16x16x32_bf16 a[60:63], a[196:199], a[148:151], a[60:63]
    s_waitcnt lgkmcnt(5)
    ds_read_b64_tr_b16 a[214:215], v4 offset:22528
    s_waitcnt vmcnt(12)
    v_mfma_f32_16x16x32_bf16 a[0:3], a[200:203], a[152:155], a[0:3]
    s_add_u32 s39, s100, 258432
    ds_read_b64_tr_b16 a[192:193], v1 offset:24576
    v_mfma_f32_16x16x32_bf16 a[4:7], a[200:203], a[156:159], a[4:7]
    s_waitcnt lgkmcnt(5)
    ds_read_b64_tr_b16 a[194:195], v1 offset:26624
    v_mfma_f32_16x16x32_bf16 a[8:11], a[204:207], a[152:155], a[8:11]
    ds_read_b64_tr_b16 a[196:197], v2 offset:24576
    buffer_load_dwordx4 v0, s[16:19], s39 offen lds
    v_mfma_f32_16x16x32_bf16 a[12:15], a[204:207], a[156:159], a[12:15]
    s_waitcnt lgkmcnt(5)
    ds_read_b64_tr_b16 a[198:199], v2 offset:26624
    v_mfma_f32_16x16x32_bf16 a[16:19], a[208:211], a[152:155], a[16:19]
    s_add_u32 m0, s40, 106496
    ds_read_b64_tr_b16 a[200:201], v3 offset:24576
    v_mfma_f32_16x16x32_bf16 a[20:23], a[208:211], a[156:159], a[20:23]
    s_waitcnt lgkmcnt(5)
    ds_read_b64_tr_b16 a[202:203], v3 offset:26624
    v_mfma_f32_16x16x32_bf16 a[24:27], a[212:215], a[152:155], a[24:27]
    s_add_u32 s39, s100, 295296
    ds_read_b64_tr_b16 a[204:205], v4 offset:24576
    v_mfma_f32_16x16x32_bf16 a[28:31], a[212:215], a[156:159], a[28:31]
    s_waitcnt lgkmcnt(5)
    ds_read_b64_tr_b16 a[206:207], v4 offset:26624
    v_mfma_f32_16x16x32_bf16 a[32:35], a[192:195], a[152:155], a[32:35]
    ds_read_b64_tr_b16 a[208:209], v1 offset:28672
    buffer_load_dwordx4 v0, s[16:19], s39 offen lds
    v_mfma_f32_16x16x32_bf16 a[36:39], a[192:195], a[156:159], a[36:39]
    s_waitcnt lgkmcnt(5)
    ds_read_b64_tr_b16 a[210:211], v1 offset:30720
    v_mfma_f32_16x16x32_bf16 a[40:43], a[196:199], a[152:155], a[40:43]
    ds_read_b64_tr_b16 a[212:213], v2 offset:28672
    v_mfma_f32_16x16x32_bf16 a[44:47], a[196:199], a[156:159], a[44:47]
    s_waitcnt lgkmcnt(5)
    ds_read_b64_tr_b16 a[214:215], v2 offset:30720
    buffer_load_dwordx4 a[76:79], v7, s[20:23], s92 offen sc1
    v_mfma_f32_16x16x32_bf16 a[48:51], a[200:203], a[152:155], a[48:51]
    s_add_u32 s92, s92, 4096
    ds_read_b64_tr_b16 a[192:193], v3 offset:28672
    v_mfma_f32_16x16x32_bf16 a[52:55], a[200:203], a[156:159], a[52:55]
    s_waitcnt lgkmcnt(5)
    ds_read_b64_tr_b16 a[194:195], v3 offset:30720
    v_mfma_f32_16x16x32_bf16 a[56:59], a[204:207], a[152:155], a[56:59]
    ds_read_b64_tr_b16 a[196:197], v4 offset:28672
    buffer_load_dwordx4 a[80:83], v7, s[20:23], s92 offen sc1
    v_mfma_f32_16x16x32_bf16 a[60:63], a[204:207], a[156:159], a[60:63]
    s_waitcnt lgkmcnt(5)
    ds_read_b64_tr_b16 a[198:199], v4 offset:30720
    s_waitcnt vmcnt(14)
    v_mfma_f32_16x16x32_bf16 a[0:3], a[208:211], a[160:163], a[0:3]
    s_add_u32 s92, s92, 4096
    ds_read_b64_tr_b16 a[200:201], v1 offset:32768
    v_mfma_f32_16x16x32_bf16 a[4:7], a[208:211], a[164:167], a[4:7]
    s_waitcnt lgkmcnt(5)
    ds_read_b64_tr_b16 a[202:203], v1 offset:34816
    buffer_load_dwordx4 a[84:87], v7, s[20:23], s92 offen sc1
    v_mfma_f32_16x16x32_bf16 a[8:11], a[212:215], a[160:163], a[8:11]
    s_add_u32 s92, s92, 4096
    ds_read_b64_tr_b16 a[204:205], v2 offset:32768
    v_mfma_f32_16x16x32_bf16 a[12:15], a[212:215], a[164:167], a[12:15]
    s_waitcnt lgkmcnt(5)
    ds_read_b64_tr_b16 a[206:207], v2 offset:34816
    v_mfma_f32_16x16x32_bf16 a[16:19], a[192:195], a[160:163], a[16:19]
    ds_read_b64_tr_b16 a[208:209], v3 offset:32768
    buffer_load_dwordx4 a[88:91], v7, s[20:23], s92 offen sc1
    v_mfma_f32_16x16x32_bf16 a[20:23], a[192:195], a[164:167], a[20:23]
    s_waitcnt lgkmcnt(5)
    ds_read_b64_tr_b16 a[210:211], v3 offset:34816
    v_mfma_f32_16x16x32_bf16 a[24:27], a[196:199], a[160:163], a[24:27]
    s_add_u32 s92, s92, 4096
    ds_read_b64_tr_b16 a[212:213], v4 offset:32768
    v_mfma_f32_16x16x32_bf16 a[28:31], a[196:199], a[164:167], a[28:31]
    s_waitcnt lgkmcnt(5)
    ds_read_b64_tr_b16 a[214:215], v4 offset:34816
    buffer_load_dwordx4 a[92:95], v7, s[20:23], s92 offen sc1
    s_add_u32 s92, s92, 4096
    v_add_u32 v1, 36864, v1
    v_add_u32 v2, 36864, v2
    v_add_u32 v3, 36864, v3
    v_add_u32 v4, 36864, v4
    v_mfma_f32_16x16x32_bf16 a[32:35], a[200:203], a[160:163], a[32:35]
    s_barrier
    s_cmp_lg_u32 s30, 0
    s_cbranch_scc1 Ksg_31
    s_add_u32 s95, s53, 0
    s_mov_b32 s98, 1
    s_atomic_add s98, s[20:21], s95
Ksg_31:
    ds_read_b64_tr_b16 a[192:193], v1 offset:0
    v_mfma_f32_16x16x32_bf16 a[36:39], a[200:203], a[164:167], a[36:39]
    s_waitcnt lgkmcnt(5)
    ds_read_b64_tr_b16 a[194:195], v1 offset:2048
    v_mfma_f32_16x16x32_bf16 a[40:43], a[204:207], a[160:163], a[40:43]
    ds_read_b64_tr_b16 a[196:197], v2 offset:0
    buffer_load_dwordx4 a[248:251], v7, s[20:23], s92 offen sc1
    v_mfma_f32_16x16x32_bf16 a[44:47], a[204:207], a[164:167], a[44:47]
    s_waitcnt lgkmcnt(5)
    ds_read_b64_tr_b16 a[198:199], v2 offset:2048
    v_mfma_f32_16x16x32_bf16 a[48:51], a[208:211], a[160:163], a[48:51]
    s_add_u32 s92, s92, 4096
    ds_read_b64_tr_b16 a[200:201], v3 offset:0
    v_mfma_f32_16x16x32_bf16 a[52:55], a[208:211], a[164:167], a[52:55]
    s_waitcnt lgkmcnt(5)
    ds_read_b64_tr_b16 a[202:203], v3 offset:2048
    buffer_load_dword v16, v12, s[20:23], s51 offen offset:64 sc1
    v_mfma_f32_16x16x32_bf16 a[56:59], a[212:215], a[160:163], a[56:59]
    ds_read_b64_tr_b16 a[204:205], v4 offset:0
    v_mfma_f32_16x16x32_bf16 a[60:63], a[212:215], a[164:167], a[60:63]
    s_waitcnt lgkmcnt(5)
    ds_read_b64_tr_b16 a[206:207], v4 offset:2048
    v_mfma_f32_16x16x32_bf16 v[72:75], a[192:195], a[96:99], v[72:75]
    ds_read_b64_tr_b16 a[208:209], v1 offset:4096
    buffer_load_dword v17, v12, s[20:23], s51 offen offset:192 sc1
    v_mfma_f32_16x16x32_bf16 v[76:79], a[192:195], a[100:103], v[76:79]
    s_waitcnt lgkmcnt(5)
    ds_read_b64_tr_b16 a[210:211], v1 offset:6144
    v_mfma_f32_16x16x32_bf16 v[88:91], a[196:199], a[96:99], v[88:91]
    ds_read_b64_tr_b16 a[212:213], v2 offset:4096
    v_mfma_f32_16x16x32_bf16 v[92:95], a[196:199], a[100:103], v[92:95]
    s_waitcnt lgkmcnt(5)
    ds_read_b64_tr_b16 a[214:215], v2 offset:6144
    buffer_load_dword v18, v12, s[20:23], s51 offen offset:320 sc1
    v_mfma_f32_16x16x32_bf16 v[104:107], a[200:203], a[96:99], v[104:107]
    ds_read_b64_tr_b16 a[192:193], v3 offset:4096
    v_accvgpr_read_b32 v21, a0
    v_accvgpr_read_b32 v22, a1
    v_mfma_f32_16x16x32_bf16 v[108:111], a[200:203], a[100:103], v[108:111]
    s_waitcnt lgkmcnt(5)
    ds_read_b64_tr_b16 a[194:195], v3 offset:6144
    v_accvgpr_read_b32 v23, a2
    v_accvgpr_read_b32 v24, a3
    v_mfma_f32_16x16x32_bf16 v[120:123], a[204:207], a[96:99], v[120:123]
    ds_read_b64_tr_b16 a[196:197], v4 offset:4096
    buffer_load_dword v19, v12, s[20:23], s51 offen offset:448 sc1
    v_cvt_pk_bf16_f32 v48, v21, v22
    v_mfma_f32_16x16x32_bf16 v[124:127], a[204:207], a[100:103], v[124:127]
    s_waitcnt lgkmcnt(5)
    ds_read_b64_tr_b16 a[198:199], v4 offset:6144
    v_cvt_pk_bf16_f32 v49, v23, v24
    v_accvgpr_read_b32 v25, a8
    v_mfma_f32_16x16x32_bf16 v[72:75], a[208:211], a[104:107], v[72:75]
    ds_read_b64_tr_b16 a[200:201], v1 offset:8192
    v_accvgpr_read_b32 v26, a9
    v_accvgpr_read_b32 v27, a10
    v_mfma_f32_16x16x32_bf16 v[76:79], a[208:211], a[108:111], v[76:79]
    s_waitcnt lgkmcnt(5)
    ds_read_b64_tr_b16 a[202:203], v1 offset:10240
    buffer_load_dword v20, v12, s[20:23], s51 offen offset:576 sc1
    v_accvgpr_read_b32 v28, a11
    v_mfma_f32_16x16x32_bf16 v[88:91], a[212:215], a[104:107], v[88:91]
    ds_read_b64_tr_b16 a[204:205], v2 offset:8192
    v_cvt_pk_bf16_f32 v50, v25, v26
    v_cvt_pk_bf16_f32 v51, v27, v28
    v_mfma_f32_16x16x32_bf16 v[92:95], a[212:215], a[108:111], v[92:95]
    s_waitcnt lgkmcnt(5)
    ds_read_b64_tr_b16 a[206:207], v2 offset:10240
    buffer_store_dwordx4 v[48:51], v15, s[20:23], s44 offen offset:0 sc1
    v_accvgpr_read_b32 v21, a4
    v_mfma_f32_16x16x32_bf16 v[104:107], a[192:195], a[104:107], v[104:107]
    ds_read_b64_tr_b16 a[208:209], v3 offset:8192
    buffer_load_dword v13, v12, s[20:23], s51 offen offset:704 sc1
    v_accvgpr_read_b32 v22, a5
    v_mfma_f32_16x16x32_bf16 v[108:111], a[192:195], a[108:111], v[108:111]
    s_waitcnt lgkmcnt(5)
    ds_read_b64_tr_b16 a[210:211], v3 offset:10240
    v_accvgpr_read_b32 v23, a6
    v_accvgpr_read_b32 v24, a7
    v_mfma_f32_16x16x32_bf16 v[120:123], a[196:199], a[104:107], v[120:123]
    ds_read_b64_tr_b16 a[212:213], v4 offset:8192
    v_cvt_pk_bf16_f32 v52, v21, v22
    v_cvt_pk_bf16_f32 v53, v23, v24
    v_mfma_f32_16x16x32_bf16 v[124:127], a[196:199], a[108:111], v[124:127]
    s_waitcnt lgkmcnt(5)
    ds_read_b64_tr_b16 a[214:215], v4 offset:10240
    buffer_load_dword v10, v12, s[20:23], s51 offen offset:0 sc1
    v_accvgpr_read_b32 v25, a12
    v_mfma_f32_16x16x32_bf16 v[72:75], a[200:203], a[112:115], v[72:75]
    ds_read_b64_tr_b16 a[192:193], v1 offset:12288
    v_accvgpr_read_b32 v26, a13
    v_accvgpr_read_b32 v27, a14
    v_mfma_f32_16x16x32_bf16 v[76:79], a[200:203], a[116:119], v[76:79]
    s_waitcnt lgkmcnt(5)
    ds_read_b64_tr_b16 a[194:195], v1 offset:14336
    v_accvgpr_read_b32 v28, a15
    v_cvt_pk_bf16_f32 v54, v25, v26
    v_mfma_f32_16x16x32_bf16 v[88:91], a[204:207], a[112:115], v[88:91]
    ds_read_b64_tr_b16 a[196:197], v2 offset:12288
    v_cvt_pk_bf16_f32 v55, v27, v28
    buffer_store_dwordx4 v[52:55], v15, s[20:23], s45 offen offset:0 sc1
    v_mfma_f32_16x16x32_bf16 v[92:95], a[204:207], a[116:119], v[92:95]
    s_waitcnt lgkmcnt(5)
    ds_read_b64_tr_b16 a[198:199], v2 offset:14336
    v_accvgpr_read_b32 v21, a16
    v_accvgpr_read_b32 v22, a17
    v_mfma_f32_16x16x32_bf16 v[104:107], a[208:211], a[112:115], v[104:107]
    ds_read_b64_tr_b16 a[200:201], v3 offset:12288
    v_accvgpr_read_b32 v23, a18
    v_accvgpr_read_b32 v24, a19
    v_mfma_f32_16x16x32_bf16 v[108:111], a[208:211], a[116:119], v[108:111]
    s_waitcnt lgkmcnt(5)
    ds_read_b64_tr_b16 a[202:203], v3 offset:14336
    v_cvt_pk_bf16_f32 v56, v21, v22
    v_cvt_pk_bf16_f32 v57, v23, v24
    v_mfma_f32_16x16x32_bf16 v[120:123], a[212:215], a[112:115], v[120:123]
    ds_read_b64_tr_b16 a[204:205], v4 offset:12288
    v_accvgpr_read_b32 v25, a24
    v_accvgpr_read_b32 v26, a25
    v_mfma_f32_16x16x32_bf16 v[124:127], a[212:215], a[116:119], v[124:127]
    s_waitcnt lgkmcnt(5)
    ds_read_b64_tr_b16 a[206:207], v4 offset:14336
    v_accvgpr_read_b32 v27, a26
    v_accvgpr_read_b32 v28, a27
    v_mfma_f32_16x16x32_bf16 v[72:75], a[192:195], a[120:123], v[72:75]
    ds_read_b64_tr_b16 a[208:209], v1 offset:16384
    v_cvt_pk_bf16_f32 v58, v25, v26
    v_cvt_pk_bf16_f32 v59, v27, v28
    v_mfma_f32_16x16x32_bf16 v[76:79], a[192:195], a[124:127], v[76:79]
    s_waitcnt lgkmcnt(5)
    ds_read_b64_tr_b16 a[210:211], v1 offset:18432
    buffer_store_dwordx4 v[56:59], v15, s[20:23], s44 offen offset:512 sc1
    v_accvgpr_read_b32 v21, a20
    v_mfma_f32_16x16x32_bf16 v[88:91], a[196:199], a[120:123], v[88:91]
    ds_read_b64_tr_b16 a[212:213], v2 offset:16384
    v_accvgpr_read_b32 v22, a21
    v_accvgpr_read_b32 v23, a22
    v_mfma_f32_16x16x32_bf16 v[92:95], a[196:199], a[124:127], v[92:95]
    s_waitcnt lgkmcnt(5)
    ds_read_b64_tr_b16 a[214:215], v2 offset:18432
    v_accvgpr_read_b32 v24, a23
    v_cvt_pk_bf16_f32 v60, v21, v22
    v_mfma_f32_16x16x32_bf16 v[104:107], a[200:203], a[120:123], v[104:107]
    ds_read_b64_tr_b16 a[192:193], v3 offset:16384
    v_cvt_pk_bf16_f32 v61, v23, v24
    v_mfma_f32_16x16x32_bf16 v[108:111], a[200:203], a[124:127], v[108:111]
    s_waitcnt lgkmcnt(5)
    ds_read_b64_tr_b16 a[194:195], v3 offset:18432
    v_accvgpr_read_b32 v25, a28
    v_mfma_f32_16x16x32_bf16 v[120:123], a[204:207], a[120:123], v[120:123]
    ds_read_b64_tr_b16 a[196:197], v4 offset:16384
    v_accvgpr_read_b32 v26, a29
    v_mfma_f32_16x16x32_bf16 v[124:127], a[204:207], a[124:127], v[124:127]
    s_waitcnt lgkmcnt(5)
    ds_read_b64_tr_b16 a[198:199], v4 offset:18432
    v_accvgpr_read_b32 v27, a30
    v_mfma_f32_16x16x32_bf16 v[72:75], a[208:211], a[128:131], v[72:75]
    ds_read_b64_tr_b16 a[200:201], v1 offset:20480
    v_accvgpr_read_b32 v28, a31
    v_mfma_f32_16x16x32_bf16 v[76:79], a[208:211], a[132:135], v[76:79]
    s_waitcnt lgkmcnt(5)
    ds_read_b64_tr_b16 a[202:203], v1 offset:22528
    s_cmp_lg_u32 s30, 0
    s_cbranch_scc1 Kpi_32
    s_add_u32 s96, s53, 0
    s_mov_b32 s97, 0
    s_atomic_add s97, s[20:21], s96 glc
Kpi_32:
    v_mfma_f32_16x16x32_bf16 v[88:91], a[212:215], a[128:131], v[88:91]
    ds_read_b64_tr_b16 a[204:205], v2 offset:20480
    v_cvt_pk_bf16_f32 v62, v25, v26
    v_mfma_f32_16x16x32_bf16 v[92:95], a[212:215], a[132:135], v[92:95]
    s_waitcnt lgkmcnt(5)
    ds_read_b64_tr_b16 a[206:207], v2 offset:22528
    v_cvt_pk_bf16_f32 v63, v27, v28
    v_mfma_f32_16x16x32_bf16 v[104:107], a[192:195], a[128:131], v[104:107]
    ds_read_b64_tr_b16 a[208:209], v3 offset:20480
    buffer_store_dwordx4 v[60:63], v15, s[20:23], s45 offen offset:512 sc1
    v_mfma_f32_16x16x32_bf16 v[108:111], a[192:195], a[132:135], v[108:111]
    s_waitcnt lgkmcnt(5)
    ds_read_b64_tr_b16 a[210:211], v3 offset:22528
    v_accvgpr_read_b32 v21, a32
    v_mfma_f32_16x16x32_bf16 v[120:123], a[196:199], a[128:131], v[120:123]
    ds_read_b64_tr_b16 a[212:213], v4 offset:20480
    v_accvgpr_read_b32 v22, a33
    v_mfma_f32_16x16x32_bf16 v[124:127], a[196:199], a[132:135], v[124:127]
    s_waitcnt lgkmcnt(5)
    ds_read_b64_tr_b16 a[214:215], v4 offset:22528
    v_accvgpr_read_b32 v23, a34
    v_mfma_f32_16x16x32_bf16 v[72:75], a[200:203], a[136:139], v[72:75]
    ds_read_b64_tr_b16 a[192:193], v1 offset:24576
    v_accvgpr_read_b32 v24, a35
    v_mfma_f32_16x16x32_bf16 v[76:79], a[200:203], a[140:143], v[76:79]
    s_waitcnt lgkmcnt(5)
    ds_read_b64_tr_b16 a[194:195], v1 offset:26624
    v_cvt_pk_bf16_f32 v32, v21, v22
    v_mfma_f32_16x16x32_bf16 v[88:91], a[204:207], a[136:139], v[88:91]
    ds_read_b64_tr_b16 a[196:197], v2 offset:24576
    v_cvt_pk_bf16_f32 v33, v23, v24
    v_mfma_f32_16x16x32_bf16 v[92:95], a[204:207], a[140:143], v[92:95]
    s_waitcnt lgkmcnt(5)
    ds_read_b64_tr_b16 a[198:199], v2 offset:26624
    v_accvgpr_read_b32 v25, a40
    v_mfma_f32_16x16x32_bf16 v[104:107], a[208:211], a[136:139], v[104:107]
    ds_read_b64_tr_b16 a[200:201], v3 offset:24576
    v_accvgpr_read_b32 v26, a41
    v_mfma_f32_16x16x32_bf16 v[108:111], a[208:211], a[140:143], v[108:111]
    s_waitcnt lgkmcnt(5)
    ds_read_b64_tr_b16 a[202:203], v3 offset:26624
    v_accvgpr_read_b32 v27, a42
    v_mfma_f32_16x16x32_bf16 v[120:123], a[212:215], a[136:139], v[120:123]
    ds_read_b64_tr_b16 a[204:205], v4 offset:24576
    v_accvgpr_read_b32 v28, a43
    v_mfma_f32_16x16x32_bf16 v[124:127], a[212:215], a[140:143], v[124:127]
    s_waitcnt lgkmcnt(5)
    ds_read_b64_tr_b16 a[206:207], v4 offset:26624
    v_cvt_pk_bf16_f32 v34, v25, v26
    v_mfma_f32_16x16x32_bf16 v[72:75], a[192:195], a[144:147], v[72:75]
    ds_read_b64_tr_b16 a[208:209], v1 offset:28672
    v_cvt_pk_bf16_f32 v35, v27, v28
    v_mfma_f32_16x16x32_bf16 v[76:79], a[192:195], a[148:151], v[76:79]
    s_waitcnt lgkmcnt(5)
    ds_read_b64_tr_b16 a[210:211], v1 offset:30720
    buffer_store_dwordx4 v[32:35], v15, s[20:23], s44 offen offset:1024 sc1
    v_mfma_f32_16x16x32_bf16 v[88:91], a[196:199], a[144:147], v[88:91]
    ds_read_b64_tr_b16 a[212:213], v2 offset:28672
    v_accvgpr_read_b32 v21, a36
    v_mfma_f32_16x16x32_bf16 v[92:95], a[196:199], a[148:151], v[92:95]
    s_waitcnt lgkmcnt(5)
    ds_read_b64_tr_b16 a[214:215], v2 offset:30720
    v_accvgpr_read_b32 v22, a37
    v_mfma_f32_16x16x32_bf16 v[104:107], a[200:203], a[144:147], v[104:107]
    ds_read_b64_tr_b16 a[192:193], v3 offset:28672
    v_accvgpr_read_b32 v23, a38
    v_mfma_f32_16x16x32_bf16 v[108:111], a[200:203], a[148:151], v[108:111]
    s_waitcnt lgkmcnt(5)
    ds_read_b64_tr_b16 a[194:195], v3 offset:30720
    v_accvgpr_read_b32 v24, a39
    v_mfma_f32_16x16x32_bf16 v[120:123], a[204:207], a[144:147], v[120:123]
    ds_read_b64_tr_b16 a[196:197], v4 offset:28672
    v_cvt_pk_bf16_f32 v36, v21, v22
    v_mfma_f32_16x16x32_bf16 v[124:127], a[204:207], a[148:151], v[124:127]
    s_waitcnt lgkmcnt(5)
    ds_read_b64_tr_b16 a[198:199], v4 offset:30720
    v_cvt_pk_bf16_f32 v37, v23, v24
    v_mfma_f32_16x16x32_bf16 v[72:75], a[208:211], a[152:155], v[72:75]
    ds_read_b64_tr_b16 a[200:201], v1 offset:32768
    v_accvgpr_read_b32 v25, a44
    v_mfma_f32_16x16x32_bf16 v[76:79], a[208:211], a[156:159], v[76:79]
    s_waitcnt lgkmcnt(5)
    ds_read_b64_tr_b16 a[202:203], v1 offset:34816
    v_accvgpr_read_b32 v26, a45
    v_mfma_f32_16x16x32_bf16 v[88:91], a[212:215], a[152:155], v[88:91]
    ds_read_b64_tr_b16 a[204:205], v2 offset:32768
    v_accvgpr_read_b32 v27, a46
    v_mfma_f32_16x16x32_bf16 v[92:95], a[212:215], a[156:159], v[92:95]
    s_waitcnt lgkmcnt(5)
    ds_read_b64_tr_b16 a[206:207], v2 offset:34816
    v_accvgpr_read_b32 v28, a47
    v_mfma_f32_16x16x32_bf16 v[104:107], a[192:195], a[152:155], v[104:107]
    ds_read_b64_tr_b16 a[208:209], v3 offset:32768
    v_cvt_pk_bf16_f32 v38, v25, v26
    v_mfma_f32_16x16x32_bf16 v[108:111], a[192:195], a[156:159], v[108:111]
    s_waitcnt lgkmcnt(5)
    ds_read_b64_tr_b16 a[210:211], v3 offset:34816
    v_cvt_pk_bf16_f32 v39, v27, v28
    v_mfma_f32_16x16x32_bf16 v[120:123], a[196:199], a[152:155], v[120:123]
    ds_read_b64_tr_b16 a[212:213], v4 offset:32768
    buffer_store_dwordx4 v[36:39], v15, s[20:23], s45 offen offset:1024 sc1
    v_mfma_f32_16x16x32_bf16 v[124:127], a[196:199], a[156:159], v[124:127]
    s_waitcnt lgkmcnt(5)
    ds_read_b64_tr_b16 a[214:215], v4 offset:34816
    v_accvgpr_read_b32 v21, a48
    v_add_u32 v1, 36864, v1
    v_add_u32 v2, 36864, v2
    v_add_u32 v3, 36864, v3
    v_add_u32 v4, 36864, v4
    v_mfma_f32_16x16x32_bf16 v[72:75], a[200:203], a[160:163], v[72:75]
    s_waitcnt vmcnt(19)
    s_cmp_eq_u32 s30, 0
    s_cbranch_scc1 Kspin_34
Kok_33:
    s_barrier
    ds_read_b64_tr_b16 a[192:193], v1 offset:0
    v_accvgpr_read_b32 v22, a49
    v_mfma_f32_16x16x32_bf16 v[76:79], a[200:203], a[164:167], v[76:79]
    s_waitcnt lgkmcnt(5)
    ds_read_b64_tr_b16 a[194:195], v1 offset:2048
    v_accvgpr_read_b32 v23, a50
    v_mfma_f32_16x16x32_bf16 v[88:91], a[204:207], a[160:163], v[88:91]
    ds_read_b64_tr_b16 a[196:197], v2 offset:0
    v_accvgpr_read_b32 v24, a51
    v_mfma_f32_16x16x32_bf16 v[92:95], a[204:207], a[164:167], v[92:95]
    s_waitcnt lgkmcnt(5)
    ds_read_b64_tr_b16 a[198:199], v2 offset:2048
    v_cvt_pk_bf16_f32 v40, v21, v22
    v_mfma_f32_16x16x32_bf16 v[104:107], a[208:211], a[160:163], v[104:107]
    ds_read_b64_tr_b16 a[200:201], v3 offset:0
    v_cvt_pk_bf16_f32 v41, v23, v24
    v_mfma_f32_16x16x32_bf16 v[108:111], a[208:211], a[164:167], v[108:111]
    s_waitcnt lgkmcnt(5)
    ds_read_b64_tr_b16 a[202:203], v3 offset:2048
    v_accvgpr_read_b32 v25, a56
    v_mfma_f32_16x16x32_bf16 v[120:123], a[212:215], a[160:163], v[120:123]
    s_add_u32 s94, s88, 4096
    ds_read_b64_tr_b16 a[204:205], v4 offset:0
    v_accvgpr_read_b32 v26, a57
    v_mfma_f32_16x16x32_bf16 v[124:127], a[212:215], a[164:167], v[124:127]
    s_waitcnt lgkmcnt(5)
    ds_read_b64_tr_b16 a[206:207], v4 offset:2048
    v_accvgpr_read_b32 v27, a58
    v_mfma_f32_16x16x32_bf16 v[136:139], a[192:195], a[96:99], v[136:139]
    ds_read_b64_tr_b16 a[208:209], v1 offset:4096
    buffer_load_dwordx4 a[168:171], v31, s[20:23], s94 offen sc1
    v_mfma_f32_16x16x32_bf16 v[140:143], a[192:195], a[100:103], v[140:143]
    s_waitcnt lgkmcnt(5)
    ds_read_b64_tr_b16 a[210:211], v1 offset:6144
    v_accvgpr_read_b32 v28, a59
    v_mfma_f32_16x16x32_bf16 v[152:155], a[196:199], a[96:99], v[152:155]
    ds_read_b64_tr_b16 a[212:213], v2 offset:4096
    v_cvt_pk_bf16_f32 v42, v25, v26
    v_mfma_f32_16x16x32_bf16 v[156:159], a[196:199], a[100:103], v[156:159]
    s_waitcnt lgkmcnt(5)
    ds_read_b64_tr_b16 a[214:215], v2 offset:6144
    v_cvt_pk_bf16_f32 v43, v27, v28
    v_mfma_f32_16x16x32_bf16 v[168:171], a[200:203], a[96:99], v[168:171]
    ds_read_b64_tr_b16 a[192:193], v3 offset:4096
    buffer_store_dwordx4 v[40:43], v15, s[20:23], s44 offen offset:1536 sc1
    v_mfma_f32_16x16x32_bf16 v[172:175], a[200:203], a[100:103], v[172:175]
    s_waitcnt lgkmcnt(5)
    ds_read_b64_tr_b16 a[194:195], v3 offset:6144
    v_accvgpr_read_b32 v21, a52
    v_mfma_f32_16x16x32_bf16 v[184:187], a[204:207], a[96:99], v[184:187]
    ds_read_b64_tr_b16 a[196:197], v4 offset:4096
    v_accvgpr_read_b32 v22, a53
    v_mfma_f32_16x16x32_bf16 v[188:191], a[204:207], a[100:103], v[188:191]
    s_waitcnt lgkmcnt(5)
    ds_read_b64_tr_b16 a[198:199], v4 offset:6144
    v_accvgpr_read_b32 v23, a54
    v_mfma_f32_16x16x32_bf16 v[136:139], a[208:211], a[104:107], v[136:139]
    ds_read_b64_tr_b16 a[200:201], v1 offset:8192
    v_accvgpr_read_b32 v24, a55
    v_mfma_f32_16x16x32_bf16 v[140:143], a[208:211], a[108:111], v[140:143]
    s_waitcnt lgkmcnt(5)
    ds_read_b64_tr_b16 a[202:203], v1 offset:10240
    v_cvt_pk_bf16_f32 v44, v21, v22
    v_mfma_f32_16x16x32_bf16 v[152:155], a[212:215], a[104:107], v[152:155]
    s_add_u32 s94, s88, 40960
    ds_read_b64_tr_b16 a[204:205], v2 offset:8192
    v_cvt_pk_bf16_f32 v45, v23, v24
    v_mfma_f32_16x16x32_bf16 v[156:159], a[212:215], a[108:111], v[156:159]
    s_waitcnt lgkmcnt(5)
    ds_read_b64_tr_b16 a[206:207], v2 offset:10240
    v_accvgpr_read_b32 v25, a60
    v_mfma_f32_16x16x32_bf16 v[168:171], a[192:195], a[104:107], v[168:171]
    ds_read_b64_tr_b16 a[208:209], v3 offset:8192
    buffer_load_dwordx4 a[172:175], v31, s[20:23], s94 offen sc1
    v_mfma_f32_16x16x32_bf16 v[172:175], a[192:195], a[108:111], v[172:175]
    s_waitcnt lgkmcnt(5)
    ds_read_b64_tr_b16 a[210:211], v3 offset:10240
    v_accvgpr_read_b32 v26, a61
    v_mfma_f32_16x16x32_bf16 v[184:187], a[196:199], a[104:107], v[184:187]
    ds_read_b64_tr_b16 a[212:213], v4 offset:8192
    v_accvgpr_read_b32 v27, a62
    v_mfma_f32_16x16x32_bf16 v[188:191], a[196:199], a[108:111], v[188:191]
    s_waitcnt lgkmcnt(5)
    ds_read_b64_tr_b16 a[214:215], v4 offset:10240
    v_accvgpr_read_b32 v28, a63
    v_mfma_f32_16x16x32_bf16 v[136:139], a[200:203], a[112:115], v[136:139]
    ds_read_b64_tr_b16 a[192:193], v1 offset:12288
    v_cvt_pk_bf16_f32 v46, v25, v26
    v_mfma_f32_16x16x32_bf16 v[140:143], a[200:203], a[116:119], v[140:143]
    s_waitcnt lgkmcnt(5)
    ds_read_b64_tr_b16 a[194:195], v1 offset:14336
    v_cvt_pk_bf16_f32 v47, v27, v28
    v_mfma_f32_16x16x32_bf16 v[152:155], a[204:207], a[112:115], v[152:155]
    ds_read_b64_tr_b16 a[196:197], v2 offset:12288
    buffer_store_dwordx4 v[44:47], v15, s[20:23], s45 offen offset:1536 sc1
    v_mfma_f32_16x16x32_bf16 v[156:159], a[204:207], a[116:119], v[156:159]
    s_waitcnt lgkmcnt(5)
    ds_read_b64_tr_b16 a[198:199], v2 offset:14336
    v_cvt_pk_bf16_f32 v48, v72, v73
    v_mfma_f32_16x16x32_bf16 v[168:171], a[208:211], a[112:115], v[168:171]
    ds_read_b64_tr_b16 a[200:201], v3 offset:12288
    v_cvt_pk_bf16_f32 v49, v74, v75
    v_mfma_f32_16x16x32_bf16 v[172:175], a[208:211], a[116:119], v[172:175]
    s_waitcnt lgkmcnt(5)
    ds_read_b64_tr_b16 a[202:203], v3 offset:14336
    v_cvt_pk_bf16_f32 v50, v88, v89
    v_mfma_f32_16x16x32_bf16 v[184:187], a[212:215], a[112:115], v[184:187]
    s_add_u32 s94, s88, 77824
    ds_read_b64_tr_b16 a[204:205], v4 offset:12288
    v_cvt_pk_bf16_f32 v51, v90, v91
    v_mfma_f32_16x16x32_bf16 v[188:191], a[212:215], a[116:119], v[188:191]
    s_waitcnt lgkmcnt(5)
    ds_read_b64_tr_b16 a[206:207], v4 offset:14336
    buffer_store_dwordx4 v[48:51], v15, s[20:23], s44 offen offset:2048 sc1
    v_mfma_f32_16x16x32_bf16 v[136:139], a[192:195], a[120:123], v[136:139]
    ds_read_b64_tr_b16 a[208:209], v1 offset:16384
    buffer_load_dwordx4 a[176:179], v31, s[20:23], s94 offen sc1
    v_mfma_f32_16x16x32_bf16 v[140:143], a[192:195], a[124:127], v[140:143]
    s_waitcnt lgkmcnt(5)
    ds_read_b64_tr_b16 a[210:211], v1 offset:18432
    v_cvt_pk_bf16_f32 v52, v76, v77
    v_mfma_f32_16x16x32_bf16 v[152:155], a[196:199], a[120:123], v[152:155]
    ds_read_b64_tr_b16 a[212:213], v2 offset:16384
    v_cvt_pk_bf16_f32 v53, v78, v79
    v_mfma_f32_16x16x32_bf16 v[156:159], a[196:199], a[124:127], v[156:159]
    s_waitcnt lgkmcnt(5)
    ds_read_b64_tr_b16 a[214:215], v2 offset:18432
    v_cvt_pk_bf16_f32 v54, v92, v93
    v_mfma_f32_16x16x32_bf16 v[168:171], a[200:203], a[120:123], v[168:171]
    ds_read_b64_tr_b16 a[192:193], v3 offset:16384
    v_cvt_pk_bf16_f32 v55, v94, v95
    v_mfma_f32_16x16x32_bf16 v[172:175], a[200:203], a[124:127], v[172:175]
    s_waitcnt lgkmcnt(5)
    ds_read_b64_tr_b16 a[194:195], v3 offset:18432
    buffer_store_dwordx4 v[52:55], v15, s[20:23], s45 offen offset:2048 sc1
    v_mfma_f32_16x16x32_bf16 v[184:187], a[204:207], a[120:123], v[184:187]
    ds_read_b64_tr_b16 a[196:197], v4 offset:16384
    v_cvt_pk_bf16_f32 v56, v104, v105
    v_mfma_f32_16x16x32_bf16 v[188:191], a[204:207], a[124:127], v[188:191]
    s_waitcnt lgkmcnt(5)
    ds_read_b64_tr_b16 a[198:199], v4 offset:18432
    v_cvt_pk_bf16_f32 v57, v106, v107
    v_mfma_f32_16x16x32_bf16 v[136:139], a[208:211], a[128:131], v[136:139]
    ds_read_b64_tr_b16 a[200:201], v1 offset:20480
    v_cvt_pk_bf16_f32 v58, v120, v121
    v_mfma_f32_16x16x32_bf16 v[140:143], a[208:211], a[132:135], v[140:143]
    s_waitcnt lgkmcnt(5)
    ds_read_b64_tr_b16 a[202:203], v1 offset:22528
    v_cvt_pk_bf16_f32 v59, v122, v123
    v_mfma_f32_16x16x32_bf16 v[152:155], a[212:215], a[128:131], v[152:155]
    s_add_u32 s94, s88, 114688
    ds_read_b64_tr_b16 a[204:205], v2 offset:20480
    buffer_store_dwordx4 v[56:59], v15, s[20:23], s44 offen offset:2560 sc1
    v_mfma_f32_16x16x32_bf16 v[156:159], a[212:215], a[132:135], v[156:159]
    s_waitcnt lgkmcnt(5)
    ds_read_b64_tr_b16 a[206:207], v2 offset:22528
    v_cvt_pk_bf16_f32 v60, v108, v109
    v_mfma_f32_16x16x32_bf16 v[168:171], a[192:195], a[128:131], v[168:171]
    ds_read_b64_tr_b16 a[208:209], v3 offset:20480
    buffer_load_dwordx4 a[180:183], v31, s[20:23], s94 offen sc1
    v_mfma_f32_16x16x32_bf16 v[172:175], a[192:195], a[132:135], v[172:175]
    s_waitcnt lgkmcnt(5)
    ds_read_b64_tr_b16 a[210:211], v3 offset:22528
    v_cvt_pk_bf16_f32 v61, v110, v111
    v_mfma_f32_16x16x32_bf16 v[184:187], a[196:199], a[128:131], v[184:187]
    ds_read_b64_tr_b16 a[212:213], v4 offset:20480
    v_cvt_pk_bf16_f32 v62, v124, v125
    v_mfma_f32_16x16x32_bf16 v[188:191], a[196:199], a[132:135], v[188:191]
    s_waitcnt lgkmcnt(5)
    ds_read_b64_tr_b16 a[214:215], v4 offset:22528
    v_cvt_pk_bf16_f32 v63, v126, v127
    v_mfma_f32_16x16x32_bf16 v[136:139], a[200:203], a[136:139], v[136:139]
    ds_read_b64_tr_b16 a[192:193], v1 offset:24576
    buffer_store_dwordx4 v[60:63], v15, s[20:23], s45 offen offset:2560 sc1
    v_mfma_f32_16x16x32_bf16 v[140:143], a[200:203], a[140:143], v[140:143]
    s_waitcnt lgkmcnt(5)
    ds_read_b64_tr_b16 a[194:195], v1 offset:26624
    v_mfma_f32_16x16x32_bf16 v[152:155], a[204:207], a[136:139], v[152:155]
    ds_read_b64_tr_b16 a[196:197], v2 offset:24576
    v_mfma_f32_16x16x32_bf16 v[156:159], a[204:207], a[140:143], v[156:159]
    s_waitcnt lgkmcnt(5)
    ds_read_b64_tr_b16 a[198:199], v2 offset:26624
    v_mfma_f32_16x16x32_bf16 v[168:171], a[208:211], a[136:139], v[168:171]
    ds_read_b64_tr_b16 a[200:201], v3 offset:24576
    v_mfma_f32_16x16x32_bf16 v[172:175], a[208:211], a[140:143], v[172:175]
    s_waitcnt lgkmcnt(5)
    ds_read_b64_tr_b16 a[202:203], v3 offset:26624
    v_mfma_f32_16x16x32_bf16 v[184:187], a[212:215], a[136:139], v[184:187]
    ds_read_b64_tr_b16 a[204:205], v4 offset:24576
    v_mfma_f32_16x16x32_bf16 v[188:191], a[212:215], a[140:143], v[188:191]
    s_waitcnt lgkmcnt(5)
    ds_read_b64_tr_b16 a[206:207], v4 offset:26624
    v_mfma_f32_16x16x32_bf16 v[136:139], a[192:195], a[144:147], v[136:139]
    ds_read_b64_tr_b16 a[208:209], v1 offset:28672
    v_mfma_f32_16x16x32_bf16 v[140:143], a[192:195], a[148:151], v[140:143]
    s_waitcnt lgkmcnt(5)
    ds_read_b64_tr_b16 a[210:211], v1 offset:30720
    v_mfma_f32_16x16x32_bf16 v[152:155], a[196:199], a[144:147], v[152:155]
    ds_read_b64_tr_b16 a[212:213], v2 offset:28672
    v_mfma_f32_16x16x32_bf16 v[156:159], a[196:199], a[148:151], v[156:159]
    s_waitcnt lgkmcnt(5)
    ds_read_b64_tr_b16 a[214:215], v2 offset:30720
    v_mfma_f32_16x16x32_bf16 v[168:171], a[200:203], a[144:147], v[168:171]
    ds_read_b64_tr_b16 a[192:193], v3 offset:28672
    v_mfma_f32_16x16x32_bf16 v[172:175], a[200:203], a[148:151], v[172:175]
    s_waitcnt lgkmcnt(5)
    ds_read_b64_tr_b16 a[194:195], v3 offset:30720
    v_mfma_f32_16x16x32_bf16 v[184:187], a[204:207], a[144:147], v[184:187]
    ds_read_b64_tr_b16 a[196:197], v4 offset:28672
    v_mfma_f32_16x16x32_bf16 v[188:191], a[204:207], a[148:151], v[188:191]
    s_waitcnt lgkmcnt(5)
    ds_read_b64_tr_b16 a[198:199], v4 offset:30720
    v_mfma_f32_16x16x32_bf16 v[136:139], a[208:211], a[152:155], v[136:139]
    ds_read_b64_tr_b16 a[200:201], v1 offset:32768
    v_mfma_f32_16x16x32_bf16 v[140:143], a[208:211], a[156:159], v[140:143]
    s_waitcnt lgkmcnt(5)
    ds_read_b64_tr_b16 a[202:203], v1 offset:34816
    v_mfma_f32_16x16x32_bf16 v[152:155], a[212:215], a[152:155], v[152:155]
    ds_read_b64_tr_b16 a[204:205], v2 offset:32768
    v_mfma_f32_16x16x32_bf16 v[156:159], a[212:215], a[156:159], v[156:159]
    s_waitcnt lgkmcnt(5)
    ds_read_b64_tr_b16 a[206:207], v2 offset:34816
    v_mfma_f32_16x16x32_bf16 v[168:171], a[192:195], a[152:155], v[168:171]
    ds_read_b64_tr_b16 a[208:209], v3 offset:32768
    v_mfma_f32_16x16x32_bf16 v[172:175], a[192:195], a[156:159], v[172:175]
    s_waitcnt lgkmcnt(5)
    ds_read_b64_tr_b16 a[210:211], v3 offset:34816
    v_mfma_f32_16x16x32_bf16 v[184:187], a[196:199], a[152:155], v[184:187]
    ds_read_b64_tr_b16 a[212:213], v4 offset:32768
    v_mfma_f32_16x16x32_bf16 v[188:191], a[196:199], a[156:159], v[188:191]
    s_waitcnt lgkmcnt(5)
    ds_read_b64_tr_b16 a[214:215], v4 offset:34816
    v_mfma_f32_16x16x32_bf16 v[136:139], a[200:203], a[160:163], v[136:139]
    v_mfma_f32_16x16x32_bf16 v[140:143], a[200:203], a[164:167], v[140:143]
    s_waitcnt lgkmcnt(4)
    v_mfma_f32_16x16x32_bf16 v[152:155], a[204:207], a[160:163], v[152:155]
    v_mfma_f32_16x16x32_bf16 v[156:159], a[204:207], a[164:167], v[156:159]
    s_waitcnt lgkmcnt(2)
    v_mfma_f32_16x16x32_bf16 v[168:171], a[208:211], a[160:163], v[168:171]
    v_mfma_f32_16x16x32_bf16 v[172:175], a[208:211], a[164:167], v[172:175]
    s_waitcnt lgkmcnt(0)
    v_mfma_f32_16x16x32_bf16 v[184:187], a[212:215], a[160:163], v[184:187]
    v_mfma_f32_16x16x32_bf16 v[188:191], a[212:215], a[164:167], v[188:191]
    s_mov_b32 s12, s10
    s_mov_b32 s13, s11
    s_mov_b32 s14, 2359296
    s_mov_b32 s15, 0x20000
    v_cvt_pk_bf16_f32 v32, v136, v137
    v_cvt_pk_bf16_f32 v33, v138, v139
    v_cvt_pk_bf16_f32 v34, v152, v153
    v_cvt_pk_bf16_f32 v35, v154, v155
    buffer_store_dwordx4 v[32:35], v15, s[20:23], s44 offen offset:3072 sc1
    v_cvt_pk_bf16_f32 v36, v140, v141
    v_cvt_pk_bf16_f32 v37, v142, v143
    v_cvt_pk_bf16_f32 v38, v156, v157
    v_cvt_pk_bf16_f32 v39, v158, v159
    buffer_store_dwordx4 v[36:39], v15, s[20:23], s45 offen offset:3072 sc1
    v_cvt_pk_bf16_f32 v40, v168, v169
    v_cvt_pk_bf16_f32 v41, v170, v171
    v_cvt_pk_bf16_f32 v42, v184, v185
    v_cvt_pk_bf16_f32 v43, v186, v187
    buffer_store_dwordx4 v[40:43], v15, s[20:23], s44 offen offset:3584 sc1
    v_cvt_pk_bf16_f32 v44, v172, v173
    v_cvt_pk_bf16_f32 v45, v174, v175
    v_cvt_pk_bf16_f32 v46, v188, v189
    v_cvt_pk_bf16_f32 v47, v190, v191
    buffer_store_dwordx4 v[44:47], v15, s[20:23], s45 offen offset:3584 sc1
    s_waitcnt vmcnt(10)
    s_barrier
    s_cmp_lg_u32 s30, 0
    s_cbranch_scc1 Ksg_36
    s_add_u32 s95, s53, 256
    s_mov_b32 s98, 1
    s_atomic_add s98, s[20:21], s95
Ksg_36:
    v_add_f32 v16, v16, v17
    v_add_f32 v18, v18, v19
    v_add_f32 v20, v20, v13
    v_add_f32 v16, v16, v18
    v_add_f32 v16, v16, v20
    v_mov_b32 v18, v10
    v_mul_f32 v16, 0x3ae38e39, v16
    v_add_f32 v16, 0x3727c5ac, v16
    v_rcp_f32 v16, v16
    v_accvgpr_read_b32 v8, a245
    v_accvgpr_read_b32 v9, a246
    v_accvgpr_read_b32 v10, a247
    s_lshl_b32 s93, s34, 6
    s_lshl_b32 s43, s33, 4
    s_add_u32 s93, s93, s43
    s_add_u32 s93, s93, 148480
    v_add_u32 v6, s93, v5
    s_mul_i32 s93, s30, 2304
    s_mul_i32 s43, s29, 9216
    s_add_u32 s43, s43, s93
    s_add_u32 s93, s93, 148480
    v_min_u32 v11, 2288, v8
    v_min_u32 v12, 2288, v9
    v_min_u32 v13, 2288, v10
    v_add_u32 v11, s93, v11
    v_add_u32 v12, s93, v12
    v_add_u32 v13, s93, v13
    s_waitcnt vmcnt(0)
    s_barrier
    s_cmp_lg_u32 s30, 0
    s_cbranch_scc1 Ksg_37
    s_add_u32 s95, s53, 512
    s_mov_b32 s98, 1
    s_atomic_add s98, s[20:21], s95
Ksg_37:
    s_cmp_lg_u32 s30, 0
    s_cbranch_scc1 Kpi_38
    s_add_u32 s96, s53, 256
    s_mov_b32 s97, 0
    s_atomic_add s97, s[20:21], s96 glc
Kpi_38:
    s_cmp_eq_u32 s30, 0
    s_cbranch_scc1 Kspin_40
Kok_39:
    s_barrier
    buffer_load_dwordx4 a[0:3], v14, s[20:23], s88 offen offset:0 sc1
    buffer_load_dwordx4 a[4:7], v14, s[20:23], s89 offen offset:0 sc1
    s_cmp_lg_u32 s30, 0
    s_cbranch_scc1 Kpi_41
    s_add_u32 s96, s53, 512
    s_mov_b32 s97, 0
    s_atomic_add s97, s[20:21], s96 glc
Kpi_41:
    buffer_load_dwordx4 a[8:11], v14, s[20:23], s90 offen offset:0 sc1
    buffer_load_dwordx4 a[12:15], v14, s[20:23], s91 offen offset:0 sc1
    buffer_load_dwordx4 a[16:19], v14, s[20:23], s88 offen offset:1024 sc1
    buffer_load_dwordx4 a[20:23], v14, s[20:23], s89 offen offset:1024 sc1
    buffer_load_dwordx4 a[24:27], v14, s[20:23], s90 offen offset:1024 sc1
    buffer_load_dwordx4 a[28:31], v14, s[20:23], s91 offen offset:1024 sc1
    s_cmp_eq_u32 s30, 0
    s_cbranch_scc1 Kspin_43
Kok_42:
    s_barrier
    buffer_load_dwordx4 a[32:35], v14, s[20:23], s88 offen offset:2048 sc1
    buffer_load_dwordx4 a[36:39], v14, s[20:23], s89 offen offset:2048 sc1
    buffer_load_dwordx4 a[40:43], v14, s[20:23], s90 offen offset:2048 sc1
    buffer_load_dwordx4 a[44:47], v14, s[20:23], s91 offen offset:2048 sc1
    buffer_load_dwordx4 a[48:51], v14, s[20:23], s88 offen offset:3072 sc1
    buffer_load_dwordx4 a[52:55], v14, s[20:23], s89 offen offset:3072 sc1
    buffer_load_dwordx4 a[56:59], v14, s[20:23], s90 offen offset:3072 sc1
    buffer_load_dwordx4 a[60:63], v14, s[20:23], s91 offen offset:3072 sc1
    v_mfma_f32_16x16x32_bf16 v[244:247], a[224:227], a[80:83], 0
    v_mfma_f32_16x16x32_bf16 v[224:227], a[224:227], a[168:171], 0
    v_mfma_f32_16x16x32_bf16 v[224:227], a[224:227], a[172:175], v[224:227]
    v_mfma_f32_16x16x32_bf16 v[224:227], a[224:227], a[176:179], v[224:227]
    v_mfma_f32_16x16x32_bf16 v[224:227], a[224:227], a[180:183], v[224:227]
    v_mfma_f32_16x16x32_bf16 v[228:231], a[224:227], a[64:67], 0
    v_mfma_f32_16x16x32_bf16 v[228:231], a[228:231], a[84:87], v[228:231]
    s_waitcnt vmcnt(12)
    v_mfma_f32_16x16x32_bf16 v[208:211], a[224:227], a[0:3], 0
    v_mfma_f32_16x16x32_bf16 v[208:211], a[224:227], a[4:7], v[208:211]
    v_mfma_f32_16x16x32_bf16 v[208:211], a[228:231], a[8:11], v[208:211]
    v_mfma_f32_16x16x32_bf16 v[208:211], a[228:231], a[12:15], v[208:211]
    v_pk_add_f32 v[244:245], v[244:245], v[18:19] op_sel_hi:[1,0]
    s_nop 0
    v_pk_fma_f32 v[224:225], v[224:225], v[16:17], v[244:245] op_sel_hi:[1,0,1]
    v_pk_add_f32 v[246:247], v[246:247], v[18:19] op_sel_hi:[1,0]
    s_nop 0
    v_pk_fma_f32 v[226:227], v[226:227], v[16:17], v[246:247] op_sel_hi:[1,0,1]
    v_cvt_pk_bf16_f32 v224, v224, v225
    v_cvt_pk_bf16_f32 v225, v226, v227
    s_mov_b32 exec_hi, 0
    ds_write_b64 v6, v[224:225] offset:512
    s_mov_b64 exec, -1
    v_mfma_f32_16x16x32_bf16 v[232:235], a[224:227], a[68:71], 0
    v_mfma_f32_16x16x32_bf16 v[232:235], a[228:231], a[88:91], v[232:235]
    s_waitcnt vmcnt(8)
    v_mfma_f32_16x16x32_bf16 v[212:215], a[224:227], a[16:19], 0
    v_mfma_f32_16x16x32_bf16 v[212:215], a[224:227], a[20:23], v[212:215]
    v_mfma_f32_16x16x32_bf16 v[212:215], a[228:231], a[24:27], v[212:215]
    v_mfma_f32_16x16x32_bf16 v[212:215], a[228:231], a[28:31], v[212:215]
    v_pk_add_f32 v[228:229], v[228:229], v[18:19] op_sel_hi:[1,0]
    s_nop 0
    v_pk_fma_f32 v[208:209], v[208:209], v[16:17], v[228:229] op_sel_hi:[1,0,1]
    v_pk_add_f32 v[230:231], v[230:231], v[18:19] op_sel_hi:[1,0]
    s_nop 0
    v_pk_fma_f32 v[210:211], v[210:211], v[16:17], v[230:231] op_sel_hi:[1,0,1]
    v_cvt_pk_bf16_f32 v208, v208, v209
    v_cvt_pk_bf16_f32 v209, v210, v211
    ds_write_b64 v6, v[208:209] offset:0
    v_pk_add_f32 v[232:233], v[232:233], v[18:19] op_sel_hi:[1,0]
    s_nop 0
    v_pk_fma_f32 v[212:213], v[212:213], v[16:17], v[232:233] op_sel_hi:[1,0,1]
    v_pk_add_f32 v[234:235], v[234:235], v[18:19] op_sel_hi:[1,0]
    s_nop 0
    v_pk_fma_f32 v[214:215], v[214:215], v[16:17], v[234:235] op_sel_hi:[1,0,1]
    v_cvt_pk_bf16_f32 v212, v212, v213
    v_cvt_pk_bf16_f32 v213, v214, v215
    ds_write_b64 v6, v[212:213] offset:128
    s_waitcnt lgkmcnt(0)
    s_barrier
    ds_read_b128 v[32:35], v11
    ds_read_b128 v[36:39], v12
    s_waitcnt lgkmcnt(0)
    buffer_store_dwordx4 v[32:35], v8, s[12:15], s43 offen sc1
    buffer_store_dwordx4 v[36:39], v9, s[12:15], s43 offen sc1
    v_mfma_f32_16x16x32_bf16 v[236:239], a[224:227], a[72:75], 0
    v_mfma_f32_16x16x32_bf16 v[236:239], a[228:231], a[92:95], v[236:239]
    s_waitcnt vmcnt(6)
    v_mfma_f32_16x16x32_bf16 v[216:219], a[224:227], a[32:35], 0
    v_mfma_f32_16x16x32_bf16 v[216:219], a[224:227], a[36:39], v[216:219]
    v_mfma_f32_16x16x32_bf16 v[216:219], a[228:231], a[40:43], v[216:219]
    v_mfma_f32_16x16x32_bf16 v[216:219], a[228:231], a[44:47], v[216:219]
    v_mfma_f32_16x16x32_bf16 v[240:243], a[224:227], a[76:79], 0
    v_mfma_f32_16x16x32_bf16 v[240:243], a[228:231], a[248:251], v[240:243]
    s_waitcnt vmcnt(2)
    v_mfma_f32_16x16x32_bf16 v[220:223], a[224:227], a[48:51], 0
    v_mfma_f32_16x16x32_bf16 v[220:223], a[224:227], a[52:55], v[220:223]
    v_mfma_f32_16x16x32_bf16 v[220:223], a[228:231], a[56:59], v[220:223]
    v_mfma_f32_16x16x32_bf16 v[220:223], a[228:231], a[60:63], v[220:223]
    v_pk_add_f32 v[236:237], v[236:237], v[18:19] op_sel_hi:[1,0]
    s_nop 0
    v_pk_fma_f32 v[216:217], v[216:217], v[16:17], v[236:237] op_sel_hi:[1,0,1]
    v_pk_add_f32 v[238:239], v[238:239], v[18:19] op_sel_hi:[1,0]
    s_nop 0
    v_pk_fma_f32 v[218:219], v[218:219], v[16:17], v[238:239] op_sel_hi:[1,0,1]
    v_cvt_pk_bf16_f32 v216, v216, v217
    v_cvt_pk_bf16_f32 v217, v218, v219
    ds_write_b64 v6, v[216:217] offset:256
    v_pk_add_f32 v[240:241], v[240:241], v[18:19] op_sel_hi:[1,0]
    s_nop 0
    v_pk_fma_f32 v[220:221], v[220:221], v[16:17], v[240:241] op_sel_hi:[1,0,1]
    v_pk_add_f32 v[242:243], v[242:243], v[18:19] op_sel_hi:[1,0]
    s_nop 0
    v_pk_fma_f32 v[222:223], v[222:223], v[16:17], v[242:243] op_sel_hi:[1,0,1]
    v_cvt_pk_bf16_f32 v220, v220, v221
    v_cvt_pk_bf16_f32 v221, v222, v223
    ds_write_b64 v6, v[220:221] offset:384
    s_waitcnt lgkmcnt(0)
    s_barrier
    ds_read_b128 v[40:43], v13
    s_waitcnt lgkmcnt(0)
    buffer_store_dwordx4 v[40:43], v10, s[12:15], s43 offen sc1
    s_endpgm
Kspin_26:
    s_mov_b32 s99, 0
Kspin_26_l:
    s_waitcnt lgkmcnt(0)
    s_cmp_ge_u32 s97, 2
    s_cbranch_scc1 Kok_25
    s_mov_b32 s97, 0
    s_atomic_add s97, s[20:21], s96 glc
    s_add_u32 s99, s99, 1
    s_cmp_lt_u32 s99, 0x100000
    s_cbranch_scc1 Kspin_26_l
    s_waitcnt lgkmcnt(0)
    s_branch Kok_25
Kspin_30:
    s_mov_b32 s99, 0
Kspin_30_l:
    s_waitcnt lgkmcnt(0)
    s_cmp_ge_u32 s97, 2
    s_cbranch_scc1 Kok_29
    s_mov_b32 s97, 0
    s_atomic_add s97, s[20:21], s96 glc
    s_add_u32 s99, s99, 1
    s_cmp_lt_u32 s99, 0x100000
    s_cbranch_scc1 Kspin_30_l
    s_waitcnt lgkmcnt(0)
    s_branch Kok_29
Kspin_34:
    s_mov_b32 s99, 0
Kspin_34_l:
    s_waitcnt lgkmcnt(0)
    s_cmp_ge_u32 s97, 16
    s_cbranch_scc1 Kok_33
    s_mov_b32 s97, 0
    s_atomic_add s97, s[20:21], s96 glc
    s_add_u32 s99, s99, 1
    s_cmp_lt_u32 s99, 0x100000
    s_cbranch_scc1 Kspin_34_l
    s_waitcnt lgkmcnt(0)
    s_branch Kok_33
Kspin_40:
    s_mov_b32 s99, 0
Kspin_40_l:
    s_waitcnt lgkmcnt(0)
    s_cmp_ge_u32 s97, 16
    s_cbranch_scc1 Kok_39
    s_mov_b32 s97, 0
    s_atomic_add s97, s[20:21], s96 glc
    s_add_u32 s99, s99, 1
    s_cmp_lt_u32 s99, 0x100000
    s_cbranch_scc1 Kspin_40_l
    s_waitcnt lgkmcnt(0)
    s_branch Kok_39
Kspin_43:
    s_mov_b32 s99, 0
Kspin_43_l:
    s_waitcnt lgkmcnt(0)
    s_cmp_ge_u32 s97, 16
    s_cbranch_scc1 Kok_42
    s_mov_b32 s97, 0
    s_atomic_add s97, s[20:21], s96 glc
    s_add_u32 s99, s99, 1
    s_cmp_lt_u32 s99, 0x100000
    s_cbranch_scc1 Kspin_43_l
    s_waitcnt lgkmcnt(0)
    s_branch Kok_42
K_end:
    s_endpgm
.p2align 7
.type K_tab,@object
K_tab:
.long 0xb400, 0x17a00, 0xb448, 0x17a48
.long 0xb408, 0x17a08, 0xb478, 0x17a78
.long 0xb410, 0x17a10, 0xb4a8, 0x17aa8
.long 0xb418, 0x17a18, 0xb448, 0x17a48
.long 0xb560, 0x17b60, 0xb5a8, 0x17ba8
.long 0xb568, 0x17b68, 0xb5d8, 0x17bd8
.long 0xb570, 0x17b70, 0xb608, 0x17c08
.long 0xb578, 0x17b78, 0xb5a8, 0x17ba8
.long 0xb6c0, 0x17cc0, 0xb708, 0x17d08
.long 0xb6c8, 0x17cc8, 0xb738, 0x17d38
.long 0xb6d0, 0x17cd0, 0xb768, 0x17d68
.long 0xb6d8, 0x17cd8, 0xb708, 0x17d08
.long 0xb820, 0x17e20, 0xb868, 0x17e68
.long 0xb828, 0x17e28, 0xb898, 0x17e98
.long 0xb830, 0x17e30, 0xb8c8, 0x17ec8
.long 0xb838, 0x17e38, 0xb868, 0x17e68
.long 0xb980, 0x17f80, 0xb9c8, 0x17fc8
.long 0xb988, 0x17f88, 0xb9f8, 0x17ff8
.long 0xb990, 0x17f90, 0xba28, 0x18028
.long 0xb998, 0x17f98, 0xb9c8, 0x17fc8
.long 0xbae0, 0x180e0, 0xbb28, 0x18128
.long 0xbae8, 0x180e8, 0xbb58, 0x18158
.long 0xbaf0, 0x180f0, 0xbb88, 0x18188
.long 0xbaf8, 0x180f8, 0xbb28, 0x18128
.long 0xbc40, 0x18240, 0xbc88, 0x18288
.long 0xbc48, 0x18248, 0xbcb8, 0x182b8
.long 0xbc50, 0x18250, 0xbce8, 0x182e8
.long 0xbc58, 0x18258, 0xbc88, 0x18288
.long 0xbda0, 0x183a0, 0xbde8, 0x183e8
.long 0xbda8, 0x183a8, 0xbe18, 0x18418
.long 0xbdb0, 0x183b0, 0xbe48, 0x18448
.long 0xbdb8, 0x183b8, 0xbde8, 0x183e8
.long 0x11700, 0x1dd00, 0x11748, 0x1dd48
.long 0x11708, 0x1dd08, 0x11778, 0x1dd78
.long 0x11710, 0x1dd10, 0x117a8, 0x1dda8
.long 0x11718, 0x1dd18, 0x11748, 0x1dd48
.long 0x11860, 0x1de60, 0x118a8, 0x1dea8
.long 0x11868, 0x1de68, 0x118d8, 0x1ded8
.long 0x11870, 0x1de70, 0x11908, 0x1df08
.long 0x11878, 0x1de78, 0x118a8, 0x1dea8
.long 0x119c0, 0x1dfc0, 0x11a08, 0x1e008
.long 0x119c8, 0x1dfc8, 0x11a38, 0x1e038
.long 0x119d0, 0x1dfd0, 0x11a68, 0x1e068
.long 0x119d8, 0x1dfd8, 0x11a08, 0x1e008
.long 0x11b20, 0x1e120, 0x11b68, 0x1e168
.long 0x11b28, 0x1e128, 0x11b98, 0x1e198
.long 0x11b30, 0x1e130, 0x11bc8, 0x1e1c8
.long 0x11b38, 0x1e138, 0x11b68, 0x1e168
.long 0x11c80, 0x1e280, 0x11cc8, 0x1e2c8
.long 0x11c88, 0x1e288, 0x11cf8, 0x1e2f8
.long 0x11c90, 0x1e290, 0x11d28, 0x1e328
.long 0x11c98, 0x1e298, 0x11cc8, 0x1e2c8
.long 0x11de0, 0x1e3e0, 0x11e28, 0x1e428
.long 0x11de8, 0x1e3e8, 0x11e58, 0x1e458
.long 0x11df0, 0x1e3f0, 0x11e88, 0x1e488
.long 0x11df8, 0x1e3f8, 0x11e28, 0x1e428
.long 0x11f40, 0x1e540, 0x11f88, 0x1e588
.long 0x11f48, 0x1e548, 0x11fb8, 0x1e5b8
.long 0x11f50, 0x1e550, 0x11fe8, 0x1e5e8
.long 0x11f58, 0x1e558, 0x11f88, 0x1e588
.long 0x120a0, 0x1e6a0, 0x120e8, 0x1e6e8
.long 0x120a8, 0x1e6a8, 0x12118, 0x1e718
.long 0x120b0, 0x1e6b0, 0x12148, 0x1e748
.long 0x120b8, 0x1e6b8, 0x120e8, 0x1e6e8
.long 0x0, 0x48, 0x24000, 0x25980
.long 0x8, 0x48, 0x24008, 0x259e0
.long 0x10, 0x48, 0x24010, 0x25a40
.long 0x18, 0x48, 0x24018, 0x25aa0
.long 0xa0, 0xe8, 0x24080, 0x25c80
.long 0xa8, 0xe8, 0x24088, 0x25ce0
.long 0xb0, 0xe8, 0x24090, 0x25d40
.long 0xb8, 0xe8, 0x24098, 0x25da0
.long 0x140, 0x188, 0x24100, 0x26700
.long 0x148, 0x188, 0x24108, 0x26700
.long 0x150, 0x188, 0x24110, 0x26700
.long 0x158, 0x188, 0x24118, 0x26700
.long 0x1e0, 0x228, 0x24180, 0x26700
.long 0x1e8, 0x228, 0x24188, 0x26700
.long 0x1f0, 0x228, 0x24190, 0x26700
.long 0x1f8, 0x228, 0x24198, 0x26700
.long 0x280, 0x2c8, 0x24200, 0x259b0
.long 0x288, 0x2c8, 0x24208, 0x25a10
.long 0x290, 0x2c8, 0x24210, 0x25a70
.long 0x298, 0x2c8, 0x24218, 0x25ad0
.long 0x320, 0x368, 0x24280, 0x25cb0
.long 0x328, 0x368, 0x24288, 0x25d10
.long 0x330, 0x368, 0x24290, 0x25d70
.long 0x338, 0x368, 0x24298, 0x25dd0
.long 0x3c0, 0x408, 0x24300, 0x26700
.long 0x3c8, 0x408, 0x24308, 0x26700
.long 0x3d0, 0x408, 0x24310, 0x26700
.long 0x3d8, 0x408, 0x24318, 0x26700
.long 0x460, 0x4a8, 0x24380, 0x26700
.long 0x468, 0x4a8, 0x24388, 0x26700
.long 0x470, 0x4a8, 0x24390, 0x26700
.long 0x478, 0x4a8, 0x24398, 0x26700
.long 0x2d00, 0x2d48, 0x24400, 0x26700
.long 0x2d08, 0x2d48, 0x24408, 0x26700
.long 0x2d10, 0x2d48, 0x24410, 0x26700
.long 0x2d18, 0x2d48, 0x24418, 0x26700
.long 0x2da0, 0x2de8, 0x24480, 0x26700
.long 0x2da8, 0x2de8, 0x24488, 0x26700
.long 0x2db0, 0x2de8, 0x24490, 0x26700
.long 0x2db8, 0x2de8, 0x24498, 0x26700
.long 0x2e40, 0x2e88, 0x24500, 0x26100
.long 0x2e48, 0x2e88, 0x24508, 0x26160
.long 0x2e50, 0x2e88, 0x24510, 0x261c0
.long 0x2e58, 0x2e88, 0x24518, 0x26220
.long 0x2ee0, 0x2f28, 0x24580, 0x26400
.long 0x2ee8, 0x2f28, 0x24588, 0x26460
.long 0x2ef0, 0x2f28, 0x24590, 0x264c0
.long 0x2ef8, 0x2f28, 0x24598, 0x26520
.long 0x2f80, 0x2fc8, 0x24600, 0x26700
.long 0x2f88, 0x2fc8, 0x24608, 0x26700
.long 0x2f90, 0x2fc8, 0x24610, 0x26700
.long 0x2f98, 0x2fc8, 0x24618, 0x26700
.long 0x3020, 0x3068, 0x24680, 0x26700
.long 0x3028, 0x3068, 0x24688, 0x26700
.long 0x3030, 0x3068, 0x24690, 0x26700
.long 0x3038, 0x3068, 0x24698, 0x26700
.long 0x30c0, 0x3108, 0x24700, 0x26130
.long 0x30c8, 0x3108, 0x24708, 0x26190
.long 0x30d0, 0x3108, 0x24710, 0x261f0
.long 0x30d8, 0x3108, 0x24718, 0x26250
.long 0x3160, 0x31a8, 0x24780, 0x26430
.long 0x3168, 0x31a8, 0x24788, 0x26490
.long 0x3170, 0x31a8, 0x24790, 0x264f0
.long 0x3178, 0x31a8, 0x24798, 0x26550
.long 0x0, 0x7fffff00, 0x0, 0x60
.long 0x4, 0x7fffff00, 0x90, 0xf0
.long 0x14, 0x7fffff00, 0x120, 0x180
.long 0x18, 0x7fffff00, 0x1b0, 0x210
.long 0x7fffff00, 0x0, 0x240, 0x2a0
.long 0x7fffff00, 0x4, 0x2d0, 0x330
.long 0x7fffff00, 0x14, 0x360, 0x3c0
.long 0x7fffff00, 0x18, 0x3f0, 0x450
.long 0x8, 0x7fffff00, 0x480, 0x4e0
.long 0xc, 0x7fffff00, 0x510, 0x570
.long 0x1c, 0x7fffff00, 0x5a0, 0x600
.long 0x20, 0x7fffff00, 0x630, 0x690
.long 0x7fffff00, 0x8, 0x6c0, 0x720
.long 0x7fffff00, 0xc, 0x750, 0x7b0
.long 0x7fffff00, 0x1c, 0x7e0, 0x840
.long 0x7fffff00, 0x20, 0x870, 0x8d0
.long 0x10, 0x7fffff00, 0x18, 0x68
.long 0x7fffff00, 0x7fffff00, 0xa8, 0xf8
.long 0x20, 0x7fffff00, 0x138, 0x188
.long 0x7fffff00, 0x7fffff00, 0x1c8, 0x218
.long 0x7fffff00, 0x10, 0x258, 0x2a8
.long 0x7fffff00, 0x7fffff00, 0x2e8, 0x338
.long 0x7fffff00, 0x20, 0x378, 0x3c8
.long 0x7fffff00, 0x7fffff00, 0x408, 0x458
.long 0x7fffff00, 0x7fffff00, 0x498, 0x4e8
.long 0x7fffff00, 0x7fffff00, 0x528, 0x578
.long 0x7fffff00, 0x7fffff00, 0x5b8, 0x608
.long 0x7fffff00, 0x7fffff00, 0x648, 0x698
.long 0x7fffff00, 0x7fffff00, 0x6d8, 0x728
.long 0x7fffff00, 0x7fffff00, 0x768, 0x7b8
.long 0x7fffff00, 0x7fffff00, 0x7f8, 0x848
.long 0x7fffff00, 0x7fffff00, 0x888, 0x8d8
.long 0x24, 0x7fffff00, 0x1200, 0x70
.long 0x28, 0x7fffff00, 0x1290, 0x100
.long 0x38, 0x7fffff00, 0x1320, 0x190
.long 0x3c, 0x7fffff00, 0x13b0, 0x220
.long 0x7fffff00, 0x24, 0x1440, 0x2b0
.long 0x7fffff00, 0x28, 0x14d0, 0x340
.long 0x7fffff00, 0x38, 0x1560, 0x3d0
.long 0x7fffff00, 0x3c, 0x15f0, 0x460
.long 0x2c, 0x7fffff00, 0x1680, 0x4f0
.long 0x30, 0x7fffff00, 0x1710, 0x580
.long 0x40, 0x7fffff00, 0x17a0, 0x610
.long 0x44, 0x7fffff00, 0x1830, 0x6a0
.long 0x7fffff00, 0x2c, 0x18c0, 0x730
.long 0x7fffff00, 0x30, 0x1950, 0x7c0
.long 0x7fffff00, 0x40, 0x19e0, 0x850
.long 0x7fffff00, 0x44, 0x1a70, 0x8e0
.long 0x34, 0x7fffff00, 0x1218, 0x78
.long 0x7fffff00, 0x7fffff00, 0x12a8, 0x108
.long 0x44, 0x7fffff00, 0x1338, 0x198
.long 0x7fffff00, 0x7fffff00, 0x13c8, 0x228
.long 0x7fffff00, 0x34, 0x1458, 0x2b8
.long 0x7fffff00, 0x7fffff00, 0x14e8, 0x348
.long 0x7fffff00, 0x44, 0x1578, 0x3d8
.long 0x7fffff00, 0x7fffff00, 0x1608, 0x468
.long 0x7fffff00, 0x7fffff00, 0x1698, 0x4f8
.long 0x7fffff00, 0x7fffff00, 0x1728, 0x588
.long 0x7fffff00, 0x7fffff00, 0x17b8, 0x618
.long 0x7fffff00, 0x7fffff00, 0x1848, 0x6a8
.long 0x7fffff00, 0x7fffff00, 0x18d8, 0x738
.long 0x7fffff00, 0x7fffff00, 0x1968, 0x7c8
.long 0x7fffff00, 0x7fffff00, 0x19f8, 0x858
.long 0x7fffff00, 0x7fffff00, 0x1a88, 0x8e8
.long 0x40000000, 0xb400, 0x17a00, 0xb460
.long 0x40000000, 0xb408, 0x17a08, 0xb468
.long 0x40000000, 0xb410, 0x17a10, 0xb470
.long 0x40000000, 0xb418, 0x17a18, 0xb478
.long 0x40000000, 0xb490, 0x17a90, 0xb4f0
.long 0x40000000, 0xb498, 0x17a98, 0xb4f8
.long 0x40000000, 0xb4a0, 0x17aa0, 0xb500
.long 0x40000000, 0xb4a8, 0x17aa8, 0xb508
.long 0x40000000, 0xb520, 0x17b20, 0xb580
.long 0x40000000, 0xb528, 0x17b28, 0xb588
.long 0x40000000, 0xb530, 0x17b30, 0xb590
.long 0x40000000, 0xb538, 0x17b38, 0xb598
.long 0x40000000, 0xb5b0, 0x17bb0, 0xb610
.long 0x40000000, 0xb5b8, 0x17bb8, 0xb618
.long 0x40000000, 0xb5c0, 0x17bc0, 0xb620
.long 0x40000000, 0xb5c8, 0x17bc8, 0xb628
.long 0x80, 0xb420, 0x17a20, 0xb480
.long 0x110, 0xb428, 0x17a28, 0xb488
.long 0x1a0, 0xb430, 0x17a30, 0xb490
.long 0x230, 0xb438, 0x17a38, 0xb498
.long 0x2c0, 0xb4b0, 0x17ab0, 0xb510
.long 0x350, 0xb4b8, 0x17ab8, 0xb518
.long 0x3e0, 0xb4c0, 0x17ac0, 0xb520
.long 0x470, 0xb4c8, 0x17ac8, 0xb528
.long 0x500, 0xb540, 0x17b40, 0xb5a0
.long 0x590, 0xb548, 0x17b48, 0xb5a8
.long 0x620, 0xb550, 0x17b50, 0xb5b0
.long 0x6b0, 0xb558, 0x17b58, 0xb5b8
.long 0x740, 0xb5d0, 0x17bd0, 0xb630
.long 0x7d0, 0xb5d8, 0x17bd8, 0xb638
.long 0x860, 0xb5e0, 0x17be0, 0xb640
.long 0x8f0, 0xb5e8, 0x17be8, 0xb648
.long 0x1280, 0xb880, 0x17e80, 0xb8e0
.long 0x1310, 0xb888, 0x17e88, 0xb8e8
.long 0x13a0, 0xb890, 0x17e90, 0xb8f0
.long 0x1430, 0xb898, 0x17e98, 0xb8f8
.long 0x14c0, 0xb910, 0x17f10, 0xb970
.long 0x1550, 0xb918, 0x17f18, 0xb978
.long 0x15e0, 0xb920, 0x17f20, 0xb980
.long 0x1670, 0xb928, 0x17f28, 0xb988
.long 0x1700, 0xb9a0, 0x17fa0, 0xba00
.long 0x1790, 0xb9a8, 0x17fa8, 0xba08
.long 0x1820, 0xb9b0, 0x17fb0, 0xba10
.long 0x18b0, 0xb9b8, 0x17fb8, 0xba18
.long 0x1940, 0xba30, 0x18030, 0xba90
.long 0x19d0, 0xba38, 0x18038, 0xba98
.long 0x1a60, 0xba40, 0x18040, 0xbaa0
.long 0x1af0, 0xba48, 0x18048, 0xbaa8
.long 0x40000000, 0xb8a0, 0x17ea0, 0xb900
.long 0x40000000, 0xb8a8, 0x17ea8, 0xb908
.long 0x40000000, 0xb8b0, 0x17eb0, 0xb910
.long 0x40000000, 0xb8b8, 0x17eb8, 0xb918
.long 0x40000000, 0xb930, 0x17f30, 0xb990
.long 0x40000000, 0xb938, 0x17f38, 0xb998
.long 0x40000000, 0xb940, 0x17f40, 0xb9a0
.long 0x40000000, 0xb948, 0x17f48, 0xb9a8
.long 0x40000000, 0xb9c0, 0x17fc0, 0xba20
.long 0x40000000, 0xb9c8, 0x17fc8, 0xba28
.long 0x40000000, 0xb9d0, 0x17fd0, 0xba30
.long 0x40000000, 0xb9d8, 0x17fd8, 0xba38
.long 0x40000000, 0xba50, 0x18050, 0xbab0
.long 0x40000000, 0xba58, 0x18058, 0xbab8
.long 0x40000000, 0xba60, 0x18060, 0xbac0
.long 0x40000000, 0xba68, 0x18068, 0xbac8
.long 0x17a60, 0x0, 0x280, 0x0
.long 0x17a68, 0x10, 0x288, 0x10
.long 0x17a70, 0x20, 0x290, 0x20
.long 0x17a78, 0x30, 0x298, 0x30
.long 0x17af0, 0x40, 0x2a0, 0x40
.long 0x17af8, 0x50, 0x2a8, 0x50
.long 0x17b00, 0x60, 0x2b0, 0x60
.long 0x17b08, 0x70, 0x2b8, 0x70
.long 0x17b80, 0x80, 0x2c0, 0x80
.long 0x17b88, 0x90, 0x2c8, 0x90
.long 0x17b90, 0xa0, 0x2d0, 0xa0
.long 0x17b98, 0xb0, 0x2d8, 0xb0
.long 0x17c10, 0xc0, 0x2e0, 0xc0
.long 0x17c18, 0xd0, 0x2e8, 0xd0
.long 0x17c20, 0xe0, 0x2f0, 0xe0
.long 0x17c28, 0xf0, 0x2f8, 0xf0
.long 0x17a80, 0x100, 0x300, 0x1000
.long 0x17a88, 0x110, 0x308, 0x1010
.long 0x17a90, 0x120, 0x310, 0x1020
.long 0x17a98, 0x130, 0x318, 0x1030
.long 0x17b10, 0x140, 0x320, 0x1040
.long 0x17b18, 0x150, 0x328, 0x1050
.long 0x17b20, 0x160, 0x330, 0x1060
.long 0x17b28, 0x170, 0x338, 0x1070
.long 0x17ba0, 0x180, 0x340, 0x1080
.long 0x17ba8, 0x190, 0x348, 0x1090
.long 0x17bb0, 0x1a0, 0x350, 0x10a0
.long 0x17bb8, 0x1b0, 0x358, 0x10b0
.long 0x17c30, 0x1c0, 0x360, 0x10c0
.long 0x17c38, 0x1d0, 0x368, 0x10d0
.long 0x17c40, 0x1e0, 0x370, 0x10e0
.long 0x17c48, 0x1f0, 0x378, 0x10f0
.long 0x17ee0, 0x140, 0x280, 0x2000
.long 0x17ee8, 0x150, 0x288, 0x2010
.long 0x17ef0, 0x160, 0x290, 0x2020
.long 0x17ef8, 0x170, 0x298, 0x2030
.long 0x17f70, 0x180, 0x2a0, 0x2040
.long 0x17f78, 0x190, 0x2a8, 0x2050
.long 0x17f80, 0x1a0, 0x2b0, 0x2060
.long 0x17f88, 0x1b0, 0x2b8, 0x2070
.long 0x18000, 0x1c0, 0x2c0, 0x2080
.long 0x18008, 0x1d0, 0x2c8, 0x2090
.long 0x18010, 0x1e0, 0x2d0, 0x20a0
.long 0x18018, 0x1f0, 0x2d8, 0x20b0
.long 0x18090, 0x200, 0x2e0, 0x20c0
.long 0x18098, 0x210, 0x2e8, 0x20d0
.long 0x180a0, 0x220, 0x2f0, 0x20e0
.long 0x180a8, 0x230, 0x2f8, 0x20f0
.long 0x17f00, 0x240, 0x300, 0x3000
.long 0x17f08, 0x250, 0x308, 0x3010
.long 0x17f10, 0x260, 0x310, 0x3020
.long 0x17f18, 0x270, 0x318, 0x3030
.long 0x17f90, 0x280, 0x320, 0x3040
.long 0x17f98, 0x290, 0x328, 0x3050
.long 0x17fa0, 0x2a0, 0x330, 0x3060
.long 0x17fa8, 0x2b0, 0x338, 0x3070
.long 0x18020, 0x2c0, 0x340, 0x3080
.long 0x18028, 0x2d0, 0x348, 0x3090
.long 0x18030, 0x2e0, 0x350, 0x30a0
.long 0x18038, 0x2f0, 0x358, 0x30b0
.long 0x180b0, 0x300, 0x360, 0x30c0
.long 0x180b8, 0x310, 0x368, 0x30d0
.long 0x180c0, 0x320, 0x370, 0x30e0
.long 0x180c8, 0x330, 0x378, 0x30f0
.long 0x0, 0x25800, 0x25e00, 0x25800
.long 0x10, 0x25860, 0x25e60, 0x25860
.long 0x20, 0x258c0, 0x25ec0, 0x258c0
.long 0x30, 0x25920, 0x26700, 0x25920
.long 0x40, 0x25b00, 0x25e00, 0x25980
.long 0x50, 0x25b60, 0x25e60, 0x259e0
.long 0x60, 0x25bc0, 0x25ec0, 0x25a40
.long 0x70, 0x25c20, 0x26700, 0x25aa0
.long 0x7fffff00, 0x26700, 0x26700, 0x25b00
.long 0x7fffff00, 0x26700, 0x26700, 0x25b60
.long 0x7fffff00, 0x26700, 0x26700, 0x25bc0
.long 0x7fffff00, 0x26700, 0x26700, 0x25c20
.long 0x7fffff00, 0x26700, 0x26700, 0x25c80
.long 0x7fffff00, 0x26700, 0x26700, 0x25ce0
.long 0x7fffff00, 0x26700, 0x26700, 0x25d40
.long 0x7fffff00, 0x26700, 0x26700, 0x25da0
.long 0x1000, 0x25830, 0x25e30, 0x25810
.long 0x1010, 0x25890, 0x25e90, 0x25870
.long 0x1020, 0x258f0, 0x25ef0, 0x258d0
.long 0x1030, 0x25950, 0x26700, 0x25930
.long 0x1040, 0x25b30, 0x25e30, 0x25990
.long 0x1050, 0x25b90, 0x25e90, 0x259f0
.long 0x1060, 0x25bf0, 0x25ef0, 0x25a50
.long 0x1070, 0x25c50, 0x26700, 0x25ab0
.long 0x7fffff00, 0x26700, 0x26700, 0x25b10
.long 0x7fffff00, 0x26700, 0x26700, 0x25b70
.long 0x7fffff00, 0x26700, 0x26700, 0x25bd0
.long 0x7fffff00, 0x26700, 0x26700, 0x25c30
.long 0x7fffff00, 0x26700, 0x26700, 0x25c90
.long 0x7fffff00, 0x26700, 0x26700, 0x25cf0
.long 0x7fffff00, 0x26700, 0x26700, 0x25d50
.long 0x7fffff00, 0x26700, 0x26700, 0x25db0
.long 0x2000, 0x26700, 0x26700, 0x25e00
.long 0x2010, 0x26700, 0x26700, 0x25e60
.long 0x2020, 0x26700, 0x26700, 0x25ec0
.long 0x2030, 0x26700, 0x26700, 0x40000000
.long 0x2040, 0x26700, 0x26700, 0x25808
.long 0x2050, 0x26700, 0x26700, 0x25868
.long 0x2060, 0x26700, 0x26700, 0x258c8
.long 0x2070, 0x26700, 0x26700, 0x25928
.long 0x7fffff00, 0x25f80, 0x26580, 0x25988
.long 0x7fffff00, 0x25fe0, 0x265e0, 0x259e8
.long 0x7fffff00, 0x26040, 0x26640, 0x25a48
.long 0x7fffff00, 0x260a0, 0x26700, 0x25aa8
.long 0x7fffff00, 0x26280, 0x26580, 0x25b08
.long 0x7fffff00, 0x262e0, 0x265e0, 0x25b68
.long 0x7fffff00, 0x26340, 0x26640, 0x25bc8
.long 0x7fffff00, 0x263a0, 0x26700, 0x25c28
.long 0x3000, 0x26700, 0x26700, 0x25e10
.long 0x3010, 0x26700, 0x26700, 0x25e70
.long 0x3020, 0x26700, 0x26700, 0x25ed0
.long 0x3030, 0x26700, 0x26700, 0x40000000
.long 0x3040, 0x26700, 0x26700, 0x25830
.long 0x3050, 0x26700, 0x26700, 0x25890
.long 0x3060, 0x26700, 0x26700, 0x258f0
.long 0x3070, 0x26700, 0x26700, 0x25950
.long 0x7fffff00, 0x25fb0, 0x265b0, 0x259b0
.long 0x7fffff00, 0x26010, 0x26610, 0x25a10
.long 0x7fffff00, 0x26070, 0x26670, 0x25a70
.long 0x7fffff00, 0x260d0, 0x26700, 0x25ad0
.long 0x7fffff00, 0x262b0, 0x265b0, 0x25b30
.long 0x7fffff00, 0x26310, 0x26610, 0x25b90
.long 0x7fffff00, 0x26370, 0x26670, 0x25bf0
.long 0x7fffff00, 0x263d0, 0x26700, 0x25c50
.long 0x25c88, 0x4000, 0x3f800000, 0x0
.long 0x25ce8, 0x4004, 0x3f800000, 0x0
.long 0x25d48, 0x4008, 0x3f800000, 0x0
.long 0x25da8, 0x400c, 0x3f800000, 0x0
.long 0x25e08, 0x4010, 0x3f800000, 0x0
.long 0x25e68, 0x4014, 0x3f800000, 0x0
.long 0x25ec8, 0x4018, 0x3f800000, 0x0
.long 0x40000000, 0x401c, 0x3f800000, 0x0
.long 0x25838, 0x4020, 0x3f800000, 0x0
.long 0x258f8, 0x4024, 0x3f800000, 0x0
.long 0x259b8, 0x4028, 0x3f800000, 0x0
.long 0x25a78, 0x402c, 0x3f800000, 0x0
.long 0x25b38, 0x4030, 0x3f800000, 0x0
.long 0x25bf8, 0x4034, 0x3f800000, 0x0
.long 0x25cb8, 0x4038, 0x3f800000, 0x0
.long 0x25d78, 0x403c, 0x3f800000, 0x0
.long 0x25cb0, 0x7fffff00, 0x0, 0x0
.long 0x25d10, 0x7fffff00, 0x0, 0x0
.long 0x25d70, 0x7fffff00, 0x0, 0x0
.long 0x25dd0, 0x7fffff00, 0x0, 0x0
.long 0x25e30, 0x7fffff00, 0x0, 0x0
.long 0x25e90, 0x7fffff00, 0x0, 0x0
.long 0x25ef0, 0x7fffff00, 0x0, 0x0
.long 0x40000000, 0x7fffff00, 0x0, 0x0
.long 0x25898, 0x7fffff00, 0x0, 0x0
.long 0x25958, 0x7fffff00, 0x0, 0x0
.long 0x25a18, 0x7fffff00, 0x0, 0x0
.long 0x25ad8, 0x7fffff00, 0x0, 0x0
.long 0x25b98, 0x7fffff00, 0x0, 0x0
.long 0x25c58, 0x7fffff00, 0x0, 0x0
.long 0x25d18, 0x7fffff00, 0x0, 0x0
.long 0x25dd8, 0x7fffff00, 0x0, 0x0
.long 0x25e38, 0x4040, 0x3f800000, 0x0
.long 0x25ef8, 0x4044, 0x3f800000, 0x0
.long 0x40000000, 0x4048, 0x3f800000, 0x0
.long 0x40000000, 0x404c, 0x3f800000, 0x0
.long 0x40000000, 0x4050, 0x3f800000, 0x0
.long 0x40000000, 0x4054, 0x3f800000, 0x0
.long 0x40000000, 0x4058, 0x3f800000, 0x0
.long 0x40000000, 0x405c, 0x3f800000, 0x0
.long 0x40000000, 0x4060, 0x3f800000, 0x0
.long 0x40000000, 0x4064, 0x3f800000, 0x0
.long 0x40000000, 0x4068, 0x3f800000, 0x0
.long 0x40000000, 0x406c, 0x3f800000, 0x0
.long 0x40000000, 0x4070, 0x3f800000, 0x0
.long 0x40000000, 0x4074, 0x3f800000, 0x0
.long 0x40000000, 0x4078, 0x3f800000, 0x0
.long 0x40000000, 0x407c, 0x3f800000, 0x0
.long 0x25e98, 0x7fffff00, 0x0, 0x0
.long 0x40000000, 0x7fffff00, 0x0, 0x0
.long 0x40000000, 0x7fffff00, 0x0, 0x0
.long 0x40000000, 0x7fffff00, 0x0, 0x0
.long 0x40000000, 0x7fffff00, 0x0, 0x0
.long 0x40000000, 0x7fffff00, 0x0, 0x0
.long 0x40000000, 0x7fffff00, 0x0, 0x0
.long 0x40000000, 0x7fffff00, 0x0, 0x0
.long 0x40000000, 0x7fffff00, 0x0, 0x0
.long 0x40000000, 0x7fffff00, 0x0, 0x0
.long 0x40000000, 0x7fffff00, 0x0, 0x0
.long 0x40000000, 0x7fffff00, 0x0, 0x0
.long 0x40000000, 0x7fffff00, 0x0, 0x0
.long 0x40000000, 0x7fffff00, 0x0, 0x0
.long 0x40000000, 0x7fffff00, 0x0, 0x0
.long 0x40000000, 0x7fffff00, 0x0, 0x0
.long 0x800, 0x8b38, 0x0, 0x40
.long 0x810, 0xc100, 0x0, 0x40
.long 0x820, 0xc110, 0x0, 0x40
.long 0x830, 0xc120, 0x0, 0x40
.long 0x838, 0xc130, 0x0, 0x40
.long 0x3e00, 0xc138, 0x0, 0x40
.long 0x3e10, 0x9880, 0x0, 0x40
.long 0x3e20, 0x9890, 0x0, 0x40
.long 0x3e30, 0x98a0, 0x0, 0x40
.long 0x3e38, 0x98b0, 0x0, 0x40
.long 0x1580, 0x98b8, 0x0, 0x40
.long 0x1590, 0xce80, 0x0, 0x40
.long 0x15a0, 0xce90, 0x0, 0x40
.long 0x15b0, 0xcea0, 0x0, 0x40
.long 0x15b8, 0xceb0, 0x0, 0x40
.long 0x4b80, 0xceb8, 0x0, 0x40
.long 0x4b90, 0x400, 0x20, 0x7fffff00
.long 0x4ba0, 0x410, 0x20, 0x7fffff00
.long 0x4bb0, 0x420, 0x20, 0x7fffff00
.long 0x4bb8, 0x430, 0x20, 0x7fffff00
.long 0x2300, 0x438, 0x20, 0x7fffff00
.long 0x2310, 0x3a00, 0x20, 0x7fffff00
.long 0x2320, 0x3a10, 0x20, 0x7fffff00
.long 0x2330, 0x3a20, 0x20, 0x7fffff00
.long 0x2338, 0x3a30, 0x20, 0x7fffff00
.long 0x5900, 0x3a38, 0x20, 0x7fffff00
.long 0x5910, 0x1180, 0x20, 0x7fffff00
.long 0x5920, 0x1190, 0x20, 0x7fffff00
.long 0x5930, 0x11a0, 0x20, 0x7fffff00
.long 0x5938, 0x11b0, 0x20, 0x7fffff00
.long 0x3080, 0x11b8, 0x20, 0x7fffff00
.long 0x3090, 0x4780, 0x20, 0x7fffff00
.long 0x30a0, 0x4790, 0x48, 0x88
.long 0x30b0, 0x47a0, 0x48, 0x88
.long 0x30b8, 0x47b0, 0x48, 0x88
.long 0x6680, 0x47b8, 0x48, 0x88
.long 0x6690, 0x1f00, 0x48, 0x88
.long 0x66a0, 0x1f10, 0x48, 0x88
.long 0x66b0, 0x1f20, 0x48, 0x88
.long 0x66b8, 0x1f30, 0x48, 0x88
.long 0x7400, 0x1f38, 0x48, 0x88
.long 0x7410, 0x5500, 0x48, 0x88
.long 0x7420, 0x5510, 0x48, 0x88
.long 0x7430, 0x5520, 0x48, 0x88
.long 0x7438, 0x5530, 0x48, 0x88
.long 0xaa00, 0x5538, 0x48, 0x88
.long 0xaa10, 0x2c80, 0x48, 0x88
.long 0xaa20, 0x2c90, 0x48, 0x88
.long 0xaa30, 0x2ca0, 0x68, 0x7fffff00
.long 0xaa38, 0x2cb0, 0x68, 0x7fffff00
.long 0x8180, 0x2cb8, 0x68, 0x7fffff00
.long 0x8190, 0x6280, 0x68, 0x7fffff00
.long 0x81a0, 0x6290, 0x68, 0x7fffff00
.long 0x81b0, 0x62a0, 0x68, 0x7fffff00
.long 0x81b8, 0x62b0, 0x68, 0x7fffff00
.long 0xb780, 0x62b8, 0x68, 0x7fffff00
.long 0xb790, 0x7000, 0x68, 0x7fffff00
.long 0xb7a0, 0x7010, 0x68, 0x7fffff00
.long 0xb7b0, 0x7020, 0x68, 0x7fffff00
.long 0xb7b8, 0x7030, 0x68, 0x7fffff00
.long 0x8f00, 0x7038, 0x68, 0x7fffff00
.long 0x8f10, 0xa600, 0x68, 0x7fffff00
.long 0x8f20, 0xa610, 0x68, 0x7fffff00
.long 0x8f30, 0xa620, 0x68, 0x7fffff00
.long 0x1ac0, 0x2da0, 0x800, 0xaac0
.long 0x1ad0, 0x2db0, 0x810, 0xaad0
.long 0x1ae0, 0x2d80, 0x820, 0xaae0
.long 0x1af0, 0x2d90, 0x830, 0xaaf0
.long 0x1b00, 0x31a0, 0x840, 0xab00
.long 0x1b10, 0x31b0, 0x850, 0xab10
.long 0x1b20, 0x3180, 0x860, 0xab20
.long 0x1b30, 0x3190, 0x870, 0xab30
.long 0x1f00, 0x31e0, 0x880, 0xf700
.long 0x1f10, 0x31f0, 0x890, 0xf710
.long 0x1f20, 0x31c0, 0x8a0, 0xf720
.long 0x1f30, 0x31d0, 0x8b0, 0xf730
.long 0x1f40, 0x3220, 0xc80, 0xf740
.long 0x1f50, 0x3230, 0xc90, 0xf750
.long 0x1f60, 0x3200, 0xca0, 0xf760
.long 0x1f70, 0x3210, 0xcb0, 0xf770
.long 0x1f80, 0x3620, 0xcc0, 0xf780
.long 0x1f90, 0x3630, 0xcd0, 0xf790
.long 0x1fa0, 0x3600, 0xce0, 0xf7a0
.long 0x1fb0, 0x3610, 0xcf0, 0xf7b0
.long 0x2380, 0x3660, 0xd00, 0xfb80
.long 0x2390, 0x3670, 0xd10, 0xfb90
.long 0x23a0, 0x3640, 0xd20, 0xfba0
.long 0x23b0, 0x3650, 0xd30, 0xfbb0
.long 0x23c0, 0x36a0, 0x5900, 0xfbc0
.long 0x23d0, 0x36b0, 0x5910, 0xfbd0
.long 0x23e0, 0x3680, 0x5920, 0xfbe0
.long 0x23f0, 0x3690, 0x5930, 0xfbf0
.long 0x2400, 0x3aa0, 0x5940, 0xfc00
.long 0x2410, 0x3ab0, 0x5950, 0xfc10
.long 0x2420, 0x3a80, 0x5960, 0xfc20
.long 0x2430, 0x3a90, 0x5970, 0xfc30
.long 0x2820, 0x3ae0, 0x5980, 0x14820
.long 0x2830, 0x3af0, 0x5990, 0x14830
.long 0x2800, 0x3ac0, 0x59a0, 0x14800
.long 0x2810, 0x3ad0, 0x59b0, 0x14810
.long 0x2860, 0x3b20, 0x5d80, 0x14860
.long 0x2870, 0x3b30, 0x5d90, 0x14870
.long 0x2840, 0x3b00, 0x5da0, 0x14840
.long 0x2850, 0x3b10, 0x5db0, 0x14850
.long 0x28a0, 0x3f20, 0x5dc0, 0x148a0
.long 0x28b0, 0x3f30, 0x5dd0, 0x148b0
.long 0x2880, 0x3f00, 0x5de0, 0x14880
.long 0x2890, 0x3f10, 0x5df0, 0x14890
.long 0x2ca0, 0x3f60, 0x5e00, 0x14ca0
.long 0x2cb0, 0x3f70, 0x5e10, 0x14cb0
.long 0x2c80, 0x3f40, 0x5e20, 0x14c80
.long 0x2c90, 0x3f50, 0x5e30, 0x14c90
.long 0x2ce0, 0x3fa0, 0xaa00, 0x14ce0
.long 0x2cf0, 0x3fb0, 0xaa10, 0x14cf0
.long 0x2cc0, 0x3f80, 0xaa20, 0x14cc0
.long 0x2cd0, 0x3f90, 0xaa30, 0x14cd0
.long 0x2d20, 0x43a0, 0xaa40, 0x14d20
.long 0x2d30, 0x43b0, 0xaa50, 0x14d30
.long 0x2d00, 0x4380, 0xaa60, 0x14d00
.long 0x2d10, 0x4390, 0xaa70, 0x14d10
.long 0x3120, 0x43e0, 0xaa80, 0x19920
.long 0x3130, 0x43f0, 0xaa90, 0x19930
.long 0x3100, 0x43c0, 0xaaa0, 0x19900
.long 0x3110, 0x43d0, 0xaab0, 0x19910
.long 0x3160, 0x4420, 0xae80, 0x19960
.long 0x3170, 0x4430, 0xae90, 0x19970
.long 0x3140, 0x4400, 0xaea0, 0x19940
.long 0x3150, 0x4410, 0xaeb0, 0x19950
.long 0x800, 0x195a0, 0x9000, 0x9000
.long 0x810, 0x195b0, 0x9008, 0x9008
.long 0x820, 0x19580, 0x9010, 0x9010
.long 0x830, 0x19590, 0x9018, 0x9018
.long 0x840, 0x199a0, 0x90c0, 0x90c0
.long 0x850, 0x199b0, 0x90c8, 0x90c8
.long 0x860, 0x19980, 0x90d0, 0x90d0
.long 0x870, 0x19990, 0x90d8, 0x90d8
.long 0x880, 0x199e0, 0x9180, 0x9180
.long 0x890, 0x199f0, 0x9188, 0x9188
.long 0x8a0, 0x199c0, 0x9190, 0x9190
.long 0x8b0, 0x199d0, 0x9198, 0x9198
.long 0xc80, 0x19a20, 0x9240, 0x9240
.long 0xc90, 0x19a30, 0x9248, 0x9248
.long 0xca0, 0x19a00, 0x9250, 0x9250
.long 0xcb0, 0x19a10, 0x9258, 0x9258
.long 0xcc0, 0x1e620, 0x9620, 0x95e0
.long 0xcd0, 0x1e630, 0x9628, 0x95e8
.long 0xce0, 0x1e600, 0x9630, 0x95f0
.long 0xcf0, 0x1e610, 0x9638, 0x95f8
.long 0xd00, 0x1e660, 0x96e0, 0x96a0
.long 0xd10, 0x1e670, 0x96e8, 0x96a8
.long 0xd20, 0x1e640, 0x96f0, 0x96b0
.long 0xd30, 0x1e650, 0x96f8, 0x96b8
.long 0x1100, 0x1e6a0, 0x97a0, 0x9760
.long 0x1110, 0x1e6b0, 0x97a8, 0x9768
.long 0x1120, 0x1e680, 0x97b0, 0x9770
.long 0x1130, 0x1e690, 0x97b8, 0x9778
.long 0x1140, 0x1eaa0, 0x9860, 0x9820
.long 0x1150, 0x1eab0, 0x9868, 0x9828
.long 0x1160, 0x1ea80, 0x9870, 0x9830
.long 0x1170, 0x1ea90, 0x9878, 0x9838
.long 0x1180, 0x1eae0, 0x9c00, 0x9c00
.long 0x1190, 0x1eaf0, 0x9c08, 0x9c08
.long 0x11a0, 0x1eac0, 0x9c10, 0x9c10
.long 0x11b0, 0x1ead0, 0x9c18, 0x9c18
.long 0x1580, 0x1eb20, 0x9cc0, 0x9cc0
.long 0x1590, 0x1eb30, 0x9cc8, 0x9cc8
.long 0x15a0, 0x1eb00, 0x9cd0, 0x9cd0
.long 0x15b0, 0x1eb10, 0x9cd8, 0x9cd8
.long 0x15c0, 0x23720, 0x9d80, 0x9d80
.long 0x15d0, 0x23730, 0x9d88, 0x9d88
.long 0x15e0, 0x23700, 0x9d90, 0x9d90
.long 0x15f0, 0x23710, 0x9d98, 0x9d98
.long 0x1600, 0x23760, 0x9e40, 0x9e40
.long 0x1610, 0x23770, 0x9e48, 0x9e48
.long 0x1620, 0x23740, 0x9e50, 0x9e50
.long 0x1630, 0x23750, 0x9e58, 0x9e58
.long 0x1a00, 0x237a0, 0xa220, 0xa1e0
.long 0x1a10, 0x237b0, 0xa228, 0xa1e8
.long 0x1a20, 0x23780, 0xa230, 0xa1f0
.long 0x1a30, 0x23790, 0xa238, 0xa1f8
.long 0x1a40, 0x23ba0, 0xa2e0, 0xa2a0
.long 0x1a50, 0x23bb0, 0xa2e8, 0xa2a8
.long 0x1a60, 0x23b80, 0xa2f0, 0xa2b0
.long 0x1a70, 0x23b90, 0xa2f8, 0xa2b8
.long 0x1a80, 0x23be0, 0xa3a0, 0xa360
.long 0x1a90, 0x23bf0, 0xa3a8, 0xa368
.long 0x1aa0, 0x23bc0, 0xa3b0, 0xa370
.long 0x1ab0, 0x23bd0, 0xa3b8, 0xa378
.long 0x1e80, 0x23c20, 0xa460, 0xa420
.long 0x1e90, 0x23c30, 0xa468, 0xa428
.long 0x1ea0, 0x23c00, 0xa470, 0xa430
.long 0x1eb0, 0x23c10, 0xa478, 0xa438
.long 0x16800, 0x16800, 0x0, 0x0
.long 0x16808, 0x16808, 0x480, 0x4
.long 0x16810, 0x16810, 0x900, 0x8
.long 0x16818, 0x16818, 0xd80, 0xc
.long 0x168c0, 0x168c0, 0x1200, 0x10
.long 0x168c8, 0x168c8, 0x1680, 0x14
.long 0x168d0, 0x168d0, 0x1b00, 0x18
.long 0x168d8, 0x168d8, 0x1f80, 0x1c
.long 0x16980, 0x16980, 0x2400, 0x20
.long 0x16988, 0x16988, 0x2880, 0x24
.long 0x16990, 0x16990, 0x2d00, 0x28
.long 0x16998, 0x16998, 0x3180, 0x2c
.long 0x16a40, 0x16a40, 0x3600, 0x30
.long 0x16a48, 0x16a48, 0x3a80, 0x34
.long 0x16a50, 0x16a50, 0x3f00, 0x38
.long 0x16a58, 0x16a58, 0x4380, 0x3c
.long 0x16e20, 0x16de0, 0x8, 0x100
.long 0x16e28, 0x16de8, 0x488, 0x104
.long 0x16e30, 0x16df0, 0x908, 0x108
.long 0x16e38, 0x16df8, 0xd88, 0x10c
.long 0x16ee0, 0x16ea0, 0x1208, 0x110
.long 0x16ee8, 0x16ea8, 0x1688, 0x114
.long 0x16ef0, 0x16eb0, 0x1b08, 0x118
.long 0x16ef8, 0x16eb8, 0x1f88, 0x11c
.long 0x16fa0, 0x16f60, 0x2408, 0x120
.long 0x16fa8, 0x16f68, 0x2888, 0x124
.long 0x16fb0, 0x16f70, 0x2d08, 0x128
.long 0x16fb8, 0x16f78, 0x3188, 0x12c
.long 0x17060, 0x17020, 0x3608, 0x130
.long 0x17068, 0x17028, 0x3a88, 0x134
.long 0x17070, 0x17030, 0x3f08, 0x138
.long 0x17078, 0x17038, 0x4388, 0x13c
.long 0x17400, 0x17400, 0x10, 0x200
.long 0x17408, 0x17408, 0x490, 0x204
.long 0x17410, 0x17410, 0x910, 0x208
.long 0x17418, 0x17418, 0xd90, 0x20c
.long 0x174c0, 0x174c0, 0x1210, 0x210
.long 0x174c8, 0x174c8, 0x1690, 0x214
.long 0x174d0, 0x174d0, 0x1b10, 0x218
.long 0x174d8, 0x174d8, 0x1f90, 0x21c
.long 0x17580, 0x17580, 0x2410, 0x220
.long 0x17588, 0x17588, 0x2890, 0x224
.long 0x17590, 0x17590, 0x2d10, 0x228
.long 0x17598, 0x17598, 0x3190, 0x22c
.long 0x17640, 0x17640, 0x3610, 0x230
.long 0x17648, 0x17648, 0x3a90, 0x234
.long 0x17650, 0x17650, 0x3f10, 0x238
.long 0x17658, 0x17658, 0x4390, 0x23c
.long 0x17a20, 0x179e0, 0x18, 0x300
.long 0x17a28, 0x179e8, 0x498, 0x304
.long 0x17a30, 0x179f0, 0x918, 0x308
.long 0x17a38, 0x179f8, 0xd98, 0x30c
.long 0x17ae0, 0x17aa0, 0x1218, 0x310
.long 0x17ae8, 0x17aa8, 0x1698, 0x314
.long 0x17af0, 0x17ab0, 0x1b18, 0x318
.long 0x17af8, 0x17ab8, 0x1f98, 0x31c
.long 0x17ba0, 0x17b60, 0x2418, 0x320
.long 0x17ba8, 0x17b68, 0x2898, 0x324
.long 0x17bb0, 0x17b70, 0x2d18, 0x328
.long 0x17bb8, 0x17b78, 0x3198, 0x32c
.long 0x17c60, 0x17c20, 0x3618, 0x330
.long 0x17c68, 0x17c28, 0x3a98, 0x334
.long 0x17c70, 0x17c30, 0x3f18, 0x338
.long 0x17c78, 0x17c38, 0x4398, 0x33c
.long 0x3f80, 0x0, 0x0, 0x0
.long 0x3f800000, 0x0, 0x0, 0x0
.long 0x0, 0x3f80, 0x0, 0x0
.long 0x0, 0x3f800000, 0x0, 0x0
.long 0x0, 0x0, 0x3f80, 0x0
.long 0x0, 0x0, 0x3f800000, 0x0
.long 0x0, 0x0, 0x0, 0x3f80
.long 0x0, 0x0, 0x0, 0x3f800000
.long 0x0, 0x0, 0x0, 0x0
.long 0x0, 0x0, 0x0, 0x0
.long 0x0, 0x0, 0x0, 0x0
.long 0x0, 0x0, 0x0, 0x0
.long 0x0, 0x0, 0x0, 0x0
.long 0x0, 0x0, 0x0, 0x0
.long 0x0, 0x0, 0x0, 0x0
.long 0x0, 0x0, 0x0, 0x0
.long 0x3f80, 0x0, 0x0, 0x0
.long 0x3f800000, 0x0, 0x0, 0x0
.long 0x0, 0x3f80, 0x0, 0x0
.long 0x0, 0x3f800000, 0x0, 0x0
.long 0x0, 0x0, 0x3f80, 0x0
.long 0x0, 0x0, 0x3f800000, 0x0
.long 0x0, 0x0, 0x0, 0x3f80
.long 0x0, 0x0, 0x0, 0x3f800000
.long 0x0, 0x0, 0x0, 0x0
.long 0x0, 0x0, 0x0, 0x0
.long 0x0, 0x0, 0x0, 0x0
.long 0x0, 0x0, 0x0, 0x0
.long 0x0, 0x0, 0x0, 0x0
.long 0x0, 0x0, 0x0, 0x0
.long 0x0, 0x0, 0x0, 0x0
.long 0x0, 0x0, 0x0, 0x0
.long 0x3f80, 0x0, 0x0, 0x0
.long 0x3f800000, 0x0, 0x0, 0x0
.long 0x0, 0x3f80, 0x0, 0x0
.long 0x0, 0x3f800000, 0x0, 0x0
.long 0x0, 0x0, 0x3f80, 0x0
.long 0x0, 0x0, 0x3f800000, 0x0
.long 0x0, 0x0, 0x0, 0x3f80
.long 0x0, 0x0, 0x0, 0x3f800000
.long 0x0, 0x0, 0x0, 0x0
.long 0x0, 0x0, 0x0, 0x0
.long 0x0, 0x0, 0x0, 0x0
.long 0x0, 0x0, 0x0, 0x0
.long 0x0, 0x0, 0x0, 0x0
.long 0x0, 0x0, 0x0, 0x0
.long 0x0, 0x0, 0x0, 0x0
.long 0x0, 0x0, 0x0, 0x0
.long 0x3f80, 0x0, 0x0, 0x0
.long 0x3f800000, 0x0, 0x0, 0x0
.long 0x0, 0x3f80, 0x0, 0x0
.long 0x0, 0x3f800000, 0x0, 0x0
.long 0x0, 0x0, 0x3f80, 0x0
.long 0x0, 0x0, 0x3f800000, 0x0
.long 0x0, 0x0, 0x0, 0x3f80
.long 0x0, 0x0, 0x0, 0x3f800000
.long 0x0, 0x0, 0x0, 0x0
.long 0x0, 0x0, 0x0, 0x0
.long 0x0, 0x0, 0x0, 0x0
.long 0x0, 0x0, 0x0, 0x0
.long 0x0, 0x0, 0x0, 0x0
.long 0x0, 0x0, 0x0, 0x0
.long 0x0, 0x0, 0x0, 0x0
.long 0x0, 0x0, 0x0, 0x0
.long 0x0, 0x0, 0x0, 0x0
.long 0x0, 0x0, 0x0, 0x0
.long 0x0, 0x0, 0x0, 0x0
.long 0x0, 0x0, 0x0, 0x0
.long 0x0, 0x0, 0x0, 0x0
.long 0x0, 0x0, 0x0, 0x0
.long 0x0, 0x0, 0x0, 0x0
.long 0x0, 0x0, 0x0, 0x0
.long 0x3f80, 0x0, 0x0, 0x0
.long 0x3f800000, 0x0, 0x0, 0x0
.long 0x0, 0x3f80, 0x0, 0x0
.long 0x0, 0x3f800000, 0x0, 0x0
.long 0x0, 0x0, 0x3f80, 0x0
.long 0x0, 0x0, 0x3f800000, 0x0
.long 0x0, 0x0, 0x0, 0x3f80
.long 0x0, 0x0, 0x0, 0x3f800000
.long 0x0, 0x0, 0x0, 0x0
.long 0x0, 0x0, 0x0, 0x0
.long 0x0, 0x0, 0x0, 0x0
.long 0x0, 0x0, 0x0, 0x0
.long 0x0, 0x0, 0x0, 0x0
.long 0x0, 0x0, 0x0, 0x0
.long 0x0, 0x0, 0x0, 0x0
.long 0x0, 0x0, 0x0, 0x0
.long 0x3f80, 0x0, 0x0, 0x0
.long 0x3f800000, 0x0, 0x0, 0x0
.long 0x0, 0x3f80, 0x0, 0x0
.long 0x0, 0x3f800000, 0x0, 0x0
.long 0x0, 0x0, 0x3f80, 0x0
.long 0x0, 0x0, 0x3f800000, 0x0
.long 0x0, 0x0, 0x0, 0x3f80
.long 0x0, 0x0, 0x0, 0x3f800000
.long 0x0, 0x0, 0x0, 0x0
.long 0x0, 0x0, 0x0, 0x0
.long 0x0, 0x0, 0x0, 0x0
.long 0x0, 0x0, 0x0, 0x0
.long 0x0, 0x0, 0x0, 0x0
.long 0x0, 0x0, 0x0, 0x0
.long 0x0, 0x0, 0x0, 0x0
.long 0x0, 0x0, 0x0, 0x0
.long 0x3f80, 0x0, 0x0, 0x0
.long 0x3f800000, 0x0, 0x0, 0x0
.long 0x0, 0x3f80, 0x0, 0x0
.long 0x0, 0x3f800000, 0x0, 0x0
.long 0x0, 0x0, 0x3f80, 0x0
.long 0x0, 0x0, 0x3f800000, 0x0
.long 0x0, 0x0, 0x0, 0x3f80
.long 0x0, 0x0, 0x0, 0x3f800000
.long 0x0, 0x0, 0x0, 0x0
.long 0x0, 0x0, 0x0, 0x0
.long 0x0, 0x0, 0x0, 0x0
.long 0x0, 0x0, 0x0, 0x0
.long 0x0, 0x0, 0x0, 0x0
.long 0x0, 0x0, 0x0, 0x0
.long 0x0, 0x0, 0x0, 0x0
.long 0x0, 0x0, 0x0, 0x0
.long 0x3f80, 0x0, 0x0, 0x0
.long 0x3f800000, 0x0, 0x0, 0x0
.long 0x0, 0x3f80, 0x0, 0x0
.long 0x0, 0x3f800000, 0x0, 0x0
.long 0x0, 0x0, 0x3f80, 0x0
.long 0x0, 0x0, 0x3f800000, 0x0
.long 0x0, 0x0, 0x0, 0x3f80
.long 0x0, 0x0, 0x0, 0x3f800000
.long 0xc00, 0x2dc0, 0x7140, 0xb4e0
.long 0xc10, 0x2dd0, 0x7150, 0xb4f0
.long 0xc20, 0x2de0, 0x7160, 0xb4c0
.long 0xc30, 0x2df0, 0x7170, 0xb4d0
.long 0xc40, 0x2e00, 0x7180, 0xb520
.long 0xc50, 0x2e10, 0x7190, 0xb530
.long 0xc60, 0x2e20, 0x71a0, 0xb500
.long 0xc70, 0x2e30, 0x71b0, 0xb510
.long 0xc80, 0x5000, 0x71c0, 0xb560
.long 0xc90, 0x5010, 0x71d0, 0xb570
.long 0xca0, 0x5020, 0x71e0, 0xb540
.long 0xcb0, 0x5030, 0x71f0, 0xb550
.long 0xcc0, 0x5040, 0x7200, 0xb5a0
.long 0xcd0, 0x5050, 0x7210, 0xb5b0
.long 0xce0, 0x5060, 0x7220, 0xb580
.long 0xcf0, 0x5070, 0x7230, 0xb590
.long 0xd00, 0x5080, 0x9420, 0xb5e0
.long 0xd10, 0x5090, 0x9430, 0xb5f0
.long 0xd20, 0x50a0, 0x9400, 0xb5c0
.long 0xd30, 0x50b0, 0x9410, 0xb5d0
.long 0xd40, 0x50c0, 0x9460, 0xb620
.long 0xd50, 0x50d0, 0x9470, 0xb630
.long 0xd60, 0x50e0, 0x9440, 0xb600
.long 0xd70, 0x50f0, 0x9450, 0xb610
.long 0xd80, 0x5100, 0x94a0, 0xd820
.long 0xd90, 0x5110, 0x94b0, 0xd830
.long 0xda0, 0x5120, 0x9480, 0xd800
.long 0xdb0, 0x5130, 0x9490, 0xd810
.long 0xdc0, 0x5140, 0x94e0, 0xd860
.long 0xdd0, 0x5150, 0x94f0, 0xd870
.long 0xde0, 0x5160, 0x94c0, 0xd840
.long 0xdf0, 0x5170, 0x94d0, 0xd850
.long 0xe00, 0x5180, 0x9520, 0xd8a0
.long 0xe10, 0x5190, 0x9530, 0xd8b0
.long 0xe20, 0x51a0, 0x9500, 0xd880
.long 0xe30, 0x51b0, 0x9510, 0xd890
.long 0x3000, 0x51c0, 0x9560, 0xd8e0
.long 0x3010, 0x51d0, 0x9570, 0xd8f0
.long 0x3020, 0x51e0, 0x9540, 0xd8c0
.long 0x3030, 0x51f0, 0x9550, 0xd8d0
.long 0x3040, 0x5200, 0x95a0, 0xd920
.long 0x3050, 0x5210, 0x95b0, 0xd930
.long 0x3060, 0x5220, 0x9580, 0xd900
.long 0x3070, 0x5230, 0x9590, 0xd910
.long 0x3080, 0x7400, 0x95e0, 0xd960
.long 0x3090, 0x7410, 0x95f0, 0xd970
.long 0x30a0, 0x7420, 0x95c0, 0xd940
.long 0x30b0, 0x7430, 0x95d0, 0xd950
.long 0x30c0, 0x7440, 0x9620, 0xd9a0
.long 0x30d0, 0x7450, 0x9630, 0xd9b0
.long 0x30e0, 0x7460, 0x9600, 0xd980
.long 0x30f0, 0x7470, 0x9610, 0xd990
.long 0x3100, 0x7480, 0xb820, 0xd9e0
.long 0x3110, 0x7490, 0xb830, 0xd9f0
.long 0x3120, 0x74a0, 0xb800, 0xd9c0
.long 0x3130, 0x74b0, 0xb810, 0xd9d0
.long 0x3140, 0x74c0, 0xb860, 0xda20
.long 0x3150, 0x74d0, 0xb870, 0xda30
.long 0x3160, 0x74e0, 0xb840, 0xda00
.long 0x3170, 0x74f0, 0xb850, 0xda10
.long 0x3180, 0x7500, 0xb8a0, 0xfc20
.long 0x3190, 0x7510, 0xb8b0, 0xfc30
.long 0x31a0, 0x7520, 0xb880, 0xfc00
.long 0x31b0, 0x7530, 0xb890, 0xfc10
.long 0x10860, 0x12a00, 0x16d80, 0x1b120
.long 0x10870, 0x12a10, 0x16d90, 0x1b130
.long 0x10840, 0x12a20, 0x16da0, 0x1b100
.long 0x10850, 0x12a30, 0x16db0, 0x1b110
.long 0x108a0, 0x14c00, 0x16dc0, 0x1b160
.long 0x108b0, 0x14c10, 0x16dd0, 0x1b170
.long 0x10880, 0x14c20, 0x16de0, 0x1b140
.long 0x10890, 0x14c30, 0x16df0, 0x1b150
.long 0x108e0, 0x14c40, 0x16e00, 0x1b1a0
.long 0x108f0, 0x14c50, 0x16e10, 0x1b1b0
.long 0x108c0, 0x14c60, 0x16e20, 0x1b180
.long 0x108d0, 0x14c70, 0x16e30, 0x1b190
.long 0x10920, 0x14c80, 0x19000, 0x1b1e0
.long 0x10930, 0x14c90, 0x19010, 0x1b1f0
.long 0x10900, 0x14ca0, 0x19020, 0x1b1c0
.long 0x10910, 0x14cb0, 0x19030, 0x1b1d0
.long 0x10960, 0x14cc0, 0x19040, 0x1b220
.long 0x10970, 0x14cd0, 0x19050, 0x1b230
.long 0x10940, 0x14ce0, 0x19060, 0x1b200
.long 0x10950, 0x14cf0, 0x19070, 0x1b210
.long 0x109a0, 0x14d00, 0x19080, 0x1d420
.long 0x109b0, 0x14d10, 0x19090, 0x1d430
.long 0x10980, 0x14d20, 0x190a0, 0x1d400
.long 0x10990, 0x14d30, 0x190b0, 0x1d410
.long 0x109e0, 0x14d40, 0x190c0, 0x1d460
.long 0x109f0, 0x14d50, 0x190d0, 0x1d470
.long 0x109c0, 0x14d60, 0x190e0, 0x1d440
.long 0x109d0, 0x14d70, 0x190f0, 0x1d450
.long 0x10a20, 0x14d80, 0x19100, 0x1d4a0
.long 0x10a30, 0x14d90, 0x19110, 0x1d4b0
.long 0x10a00, 0x14da0, 0x19120, 0x1d480
.long 0x10a10, 0x14db0, 0x19130, 0x1d490
.long 0x12c00, 0x14dc0, 0x19140, 0x1d4e0
.long 0x12c10, 0x14dd0, 0x19150, 0x1d4f0
.long 0x12c20, 0x14de0, 0x19160, 0x1d4c0
.long 0x12c30, 0x14df0, 0x19170, 0x1d4d0
.long 0x12c40, 0x14e00, 0x19180, 0x1d520
.long 0x12c50, 0x14e10, 0x19190, 0x1d530
.long 0x12c60, 0x14e20, 0x191a0, 0x1d500
.long 0x12c70, 0x14e30, 0x191b0, 0x1d510
.long 0x12c80, 0x17000, 0x191c0, 0x1d560
.long 0x12c90, 0x17010, 0x191d0, 0x1d570
.long 0x12ca0, 0x17020, 0x191e0, 0x1d540
.long 0x12cb0, 0x17030, 0x191f0, 0x1d550
.long 0x12cc0, 0x17040, 0x19200, 0x1d5a0
.long 0x12cd0, 0x17050, 0x19210, 0x1d5b0
.long 0x12ce0, 0x17060, 0x19220, 0x1d580
.long 0x12cf0, 0x17070, 0x19230, 0x1d590
.long 0x12d00, 0x17080, 0x1b420, 0x1d5e0
.long 0x12d10, 0x17090, 0x1b430, 0x1d5f0
.long 0x12d20, 0x170a0, 0x1b400, 0x1d5c0
.long 0x12d30, 0x170b0, 0x1b410, 0x1d5d0
.long 0x12d40, 0x170c0, 0x1b460, 0x1d620
.long 0x12d50, 0x170d0, 0x1b470, 0x1d630
.long 0x12d60, 0x170e0, 0x1b440, 0x1d600
.long 0x12d70, 0x170f0, 0x1b450, 0x1d610
.long 0x12d80, 0x17100, 0x1b4a0, 0x1f820
.long 0x12d90, 0x17110, 0x1b4b0, 0x1f830
.long 0x12da0, 0x17120, 0x1b480, 0x1f800
.long 0x12db0, 0x17130, 0x1b490, 0x1f810
.long 0x12dc0, 0x17140, 0x1b4e0, 0x1f860
.long 0x12dd0, 0x17150, 0x1b4f0, 0x1f870
.long 0x12de0, 0x17160, 0x1b4c0, 0x1f840
.long 0x12df0, 0x17170, 0x1b4d0, 0x1f850
.long 0x204a0, 0x0, 0xd800, 0x1b000
.long 0x204b0, 0x8, 0xd808, 0x1b008
.long 0x20480, 0x10, 0xd810, 0x1b010
.long 0x20490, 0x18, 0xd818, 0x1b018
.long 0x204e0, 0x240, 0xda40, 0x1b240
.long 0x204f0, 0x248, 0xda48, 0x1b248
.long 0x204c0, 0x250, 0xda50, 0x1b250
.long 0x204d0, 0x258, 0xda58, 0x1b258
.long 0x20520, 0x480, 0xdc80, 0x1b480
.long 0x20530, 0x488, 0xdc88, 0x1b488
.long 0x20500, 0x490, 0xdc90, 0x1b490
.long 0x20510, 0x498, 0xdc98, 0x1b498
.long 0x20560, 0x6c0, 0xdec0, 0x1b6c0
.long 0x20570, 0x6c8, 0xdec8, 0x1b6c8
.long 0x20540, 0x6d0, 0xded0, 0x1b6d0
.long 0x20550, 0x6d8, 0xded8, 0x1b6d8
.long 0x205a0, 0x920, 0xe120, 0x1b920
.long 0x205b0, 0x928, 0xe128, 0x1b928
.long 0x20580, 0x930, 0xe130, 0x1b930
.long 0x20590, 0x938, 0xe138, 0x1b938
.long 0x205e0, 0xb60, 0xe360, 0x1bb60
.long 0x205f0, 0xb68, 0xe368, 0x1bb68
.long 0x205c0, 0xb70, 0xe370, 0x1bb70
.long 0x205d0, 0xb78, 0xe378, 0x1bb78
.long 0x20620, 0xda0, 0xe5a0, 0x1bda0
.long 0x20630, 0xda8, 0xe5a8, 0x1bda8
.long 0x20600, 0xdb0, 0xe5b0, 0x1bdb0
.long 0x20610, 0xdb8, 0xe5b8, 0x1bdb8
.long 0x22820, 0xfe0, 0xe7e0, 0x1bfe0
.long 0x22830, 0xfe8, 0xe7e8, 0x1bfe8
.long 0x22800, 0xff0, 0xe7f0, 0x1bff0
.long 0x22810, 0xff8, 0xe7f8, 0x1bff8
.long 0x22860, 0x1200, 0xea00, 0x1c200
.long 0x22870, 0x1208, 0xea08, 0x1c208
.long 0x22840, 0x1210, 0xea10, 0x1c210
.long 0x22850, 0x1218, 0xea18, 0x1c218
.long 0x228a0, 0x1440, 0xec40, 0x1c440
.long 0x228b0, 0x1448, 0xec48, 0x1c448
.long 0x22880, 0x1450, 0xec50, 0x1c450
.long 0x22890, 0x1458, 0xec58, 0x1c458
.long 0x228e0, 0x1680, 0xee80, 0x1c680
.long 0x228f0, 0x1688, 0xee88, 0x1c688
.long 0x228c0, 0x1690, 0xee90, 0x1c690
.long 0x228d0, 0x1698, 0xee98, 0x1c698
.long 0x22920, 0x18c0, 0xf0c0, 0x1c8c0
.long 0x22930, 0x18c8, 0xf0c8, 0x1c8c8
.long 0x22900, 0x18d0, 0xf0d0, 0x1c8d0
.long 0x22910, 0x18d8, 0xf0d8, 0x1c8d8
.long 0x22960, 0x1b20, 0xf320, 0x1cb20
.long 0x22970, 0x1b28, 0xf328, 0x1cb28
.long 0x22940, 0x1b30, 0xf330, 0x1cb30
.long 0x22950, 0x1b38, 0xf338, 0x1cb38
.long 0x229a0, 0x1d60, 0xf560, 0x1cd60
.long 0x229b0, 0x1d68, 0xf568, 0x1cd68
.long 0x22980, 0x1d70, 0xf570, 0x1cd70
.long 0x22990, 0x1d78, 0xf578, 0x1cd78
.long 0x229e0, 0x1fa0, 0xf7a0, 0x1cfa0
.long 0x229f0, 0x1fa8, 0xf7a8, 0x1cfa8
.long 0x229c0, 0x1fb0, 0xf7b0, 0x1cfb0
.long 0x229d0, 0x1fb8, 0xf7b8, 0x1cfb8
.long 0x22a20, 0x21e0, 0xf9e0, 0x1d1e0
.long 0x22a30, 0x21e8, 0xf9e8, 0x1d1e8
.long 0x22a00, 0x21f0, 0xf9f0, 0x1d1f0
.long 0x22a10, 0x21f8, 0xf9f8, 0x1d1f8
.long 0x0, 0xd800, 0x1b000, 0x0
.long 0x8, 0xd808, 0x1b008, 0x0
.long 0x10, 0xd810, 0x1b010, 0x0
.long 0x18, 0xd818, 0x1b018, 0x0
.long 0x240, 0xda40, 0x1b240, 0x0
.long 0x248, 0xda48, 0x1b248, 0x0
.long 0x250, 0xda50, 0x1b250, 0x0
.long 0x258, 0xda58, 0x1b258, 0x0
.long 0x480, 0xdc80, 0x1b480, 0x0
.long 0x488, 0xdc88, 0x1b488, 0x0
.long 0x490, 0xdc90, 0x1b490, 0x0
.long 0x498, 0xdc98, 0x1b498, 0x0
.long 0x6c0, 0xdec0, 0x1b6c0, 0x0
.long 0x6c8, 0xdec8, 0x1b6c8, 0x0
.long 0x6d0, 0xded0, 0x1b6d0, 0x0
.long 0x6d8, 0xded8, 0x1b6d8, 0x0
.long 0x8e0, 0xe0e0, 0x1b8e0, 0x0
.long 0x8e8, 0xe0e8, 0x1b8e8, 0x0
.long 0x8f0, 0xe0f0, 0x1b8f0, 0x0
.long 0x8f8, 0xe0f8, 0x1b8f8, 0x0
.long 0xb20, 0xe320, 0x1bb20, 0x0
.long 0xb28, 0xe328, 0x1bb28, 0x0
.long 0xb30, 0xe330, 0x1bb30, 0x0
.long 0xb38, 0xe338, 0x1bb38, 0x0
.long 0xd60, 0xe560, 0x1bd60, 0x0
.long 0xd68, 0xe568, 0x1bd68, 0x0
.long 0xd70, 0xe570, 0x1bd70, 0x0
.long 0xd78, 0xe578, 0x1bd78, 0x0
.long 0xfa0, 0xe7a0, 0x1bfa0, 0x0
.long 0xfa8, 0xe7a8, 0x1bfa8, 0x0
.long 0xfb0, 0xe7b0, 0x1bfb0, 0x0
.long 0xfb8, 0xe7b8, 0x1bfb8, 0x0
.long 0x1200, 0xea00, 0x1c200, 0x0
.long 0x1208, 0xea08, 0x1c208, 0x0
.long 0x1210, 0xea10, 0x1c210, 0x0
.long 0x1218, 0xea18, 0x1c218, 0x0
.long 0x1440, 0xec40, 0x1c440, 0x0
.long 0x1448, 0xec48, 0x1c448, 0x0
.long 0x1450, 0xec50, 0x1c450, 0x0
.long 0x1458, 0xec58, 0x1c458, 0x0
.long 0x1680, 0xee80, 0x1c680, 0x0
.long 0x1688, 0xee88, 0x1c688, 0x0
.long 0x1690, 0xee90, 0x1c690, 0x0
.long 0x1698, 0xee98, 0x1c698, 0x0
.long 0x18c0, 0xf0c0, 0x1c8c0, 0x0
.long 0x18c8, 0xf0c8, 0x1c8c8, 0x0
.long 0x18d0, 0xf0d0, 0x1c8d0, 0x0
.long 0x18d8, 0xf0d8, 0x1c8d8, 0x0
.long 0x1ae0, 0xf2e0, 0x1cae0, 0x0
.long 0x1ae8, 0xf2e8, 0x1cae8, 0x0
.long 0x1af0, 0xf2f0, 0x1caf0, 0x0
.long 0x1af8, 0xf2f8, 0x1caf8, 0x0
.long 0x1d20, 0xf520, 0x1cd20, 0x0
.long 0x1d28, 0xf528, 0x1cd28, 0x0
.long 0x1d30, 0xf530, 0x1cd30, 0x0
.long 0x1d38, 0xf538, 0x1cd38, 0x0
.long 0x1f60, 0xf760, 0x1cf60, 0x0
.long 0x1f68, 0xf768, 0x1cf68, 0x0
.long 0x1f70, 0xf770, 0x1cf70, 0x0
.long 0x1f78, 0xf778, 0x1cf78, 0x0
.long 0x21a0, 0xf9a0, 0x1d1a0, 0x0
.long 0x21a8, 0xf9a8, 0x1d1a8, 0x0
.long 0x21b0, 0xf9b0, 0x1d1b0, 0x0
.long 0x21b8, 0xf9b8, 0x1d1b8, 0x0
.long 0x0, 0x0, 0x0, 0x0
.long 0x80, 0x80, 0x4, 0x0
.long 0x100, 0x100, 0x8, 0x0
.long 0x180, 0x180, 0xc, 0x0
.long 0x200, 0x200, 0x10, 0x0
.long 0x280, 0x280, 0x14, 0x0
.long 0x300, 0x300, 0x18, 0x0
.long 0x380, 0x380, 0x1c, 0x0
.long 0x400, 0x400, 0x20, 0x0
.long 0x2400, 0x480, 0x24, 0x0
.long 0x2480, 0x500, 0x28, 0x0
.long 0x2500, 0x7fffff00, 0x2c, 0x0
.long 0x2580, 0x7fffff00, 0x30, 0x0
.long 0x2600, 0x7fffff00, 0x34, 0x0
.long 0x2680, 0x7fffff00, 0x38, 0x0
.long 0x2700, 0x7fffff00, 0x3c, 0x0
.long 0x2780, 0x7fffff00, 0x40, 0x0
.long 0x2800, 0x7fffff00, 0x44, 0x0
.long 0x7fffff00, 0x7fffff00, 0x48, 0x0
.long 0x7fffff00, 0x7fffff00, 0x4c, 0x0
.long 0x7fffff00, 0x7fffff00, 0x50, 0x0
.long 0x7fffff00, 0x7fffff00, 0x54, 0x0
.long 0x7fffff00, 0x7fffff00, 0x58, 0x0
.long 0x7fffff00, 0x7fffff00, 0x5c, 0x0
.long 0x7fffff00, 0x7fffff00, 0x60, 0x0
.long 0x7fffff00, 0x7fffff00, 0x64, 0x0
.long 0x7fffff00, 0x7fffff00, 0x68, 0x0
.long 0x7fffff00, 0x7fffff00, 0x6c, 0x0
.long 0x7fffff00, 0x7fffff00, 0x70, 0x0
.long 0x7fffff00, 0x7fffff00, 0x74, 0x0
.long 0x7fffff00, 0x7fffff00, 0x78, 0x0
.long 0x7fffff00, 0x7fffff00, 0x7c, 0x0
.long 0x7fffff00, 0x7fffff00, 0x300, 0x0
.long 0x7fffff00, 0x7fffff00, 0x304, 0x0
.long 0x7fffff00, 0x7fffff00, 0x308, 0x0
.long 0x7fffff00, 0x7fffff00, 0x30c, 0x0
.long 0x7fffff00, 0x7fffff00, 0x310, 0x0
.long 0x7fffff00, 0x7fffff00, 0x314, 0x0
.long 0x7fffff00, 0x7fffff00, 0x318, 0x0
.long 0x7fffff00, 0x7fffff00, 0x31c, 0x0
.long 0x7fffff00, 0x7fffff00, 0x320, 0x0
.long 0x7fffff00, 0x7fffff00, 0x324, 0x0
.long 0x7fffff00, 0x7fffff00, 0x328, 0x0
.long 0x7fffff00, 0x7fffff00, 0x32c, 0x0
.long 0x7fffff00, 0x7fffff00, 0x330, 0x0
.long 0x7fffff00, 0x7fffff00, 0x334, 0x0
.long 0x7fffff00, 0x7fffff00, 0x338, 0x0
.long 0x7fffff00, 0x7fffff00, 0x33c, 0x0
.long 0x7fffff00, 0x7fffff00, 0x340, 0x0
.long 0x7fffff00, 0x7fffff00, 0x344, 0x0
.long 0x7fffff00, 0x7fffff00, 0x348, 0x0
.long 0x7fffff00, 0x7fffff00, 0x34c, 0x0
.long 0x7fffff00, 0x7fffff00, 0x350, 0x0
.long 0x7fffff00, 0x7fffff00, 0x354, 0x0
.long 0x7fffff00, 0x7fffff00, 0x358, 0x0
.long 0x7fffff00, 0x7fffff00, 0x35c, 0x0
.long 0x7fffff00, 0x7fffff00, 0x360, 0x0
.long 0x7fffff00, 0x7fffff00, 0x364, 0x0
.long 0x7fffff00, 0x7fffff00, 0x368, 0x0
.long 0x7fffff00, 0x7fffff00, 0x36c, 0x0
.long 0x7fffff00, 0x7fffff00, 0x370, 0x0
.long 0x7fffff00, 0x7fffff00, 0x374, 0x0
.long 0x7fffff00, 0x7fffff00, 0x378, 0x0
.long 0x7fffff00, 0x7fffff00, 0x37c, 0x0
.long 0x0, 0x12000, 0x12020, 0x12040
.long 0x10, 0x12008, 0x12028, 0x12048
.long 0x20, 0x12010, 0x12030, 0x12050
.long 0x30, 0x12018, 0x12038, 0x12058
.long 0x40, 0x12080, 0x120a0, 0x120c0
.long 0x50, 0x12088, 0x120a8, 0x120c8
.long 0x60, 0x12090, 0x120b0, 0x120d0
.long 0x70, 0x12098, 0x120b8, 0x120d8
.long 0x480, 0x12120, 0x12100, 0x12160
.long 0x490, 0x12128, 0x12108, 0x12168
.long 0x4a0, 0x12130, 0x12110, 0x12170
.long 0x4b0, 0x12138, 0x12118, 0x12178
.long 0x4c0, 0x121a0, 0x12180, 0x121e0
.long 0x4d0, 0x121a8, 0x12188, 0x121e8
.long 0x4e0, 0x121b0, 0x12190, 0x121f0
.long 0x4f0, 0x121b8, 0x12198, 0x121f8
.long 0x920, 0x12240, 0x12260, 0x12200
.long 0x930, 0x12248, 0x12268, 0x12208
.long 0x900, 0x12250, 0x12270, 0x12210
.long 0x910, 0x12258, 0x12278, 0x12218
.long 0x960, 0x122c0, 0x122e0, 0x12280
.long 0x970, 0x122c8, 0x122e8, 0x12288
.long 0x940, 0x122d0, 0x122f0, 0x12290
.long 0x950, 0x122d8, 0x122f8, 0x12298
.long 0xda0, 0x12360, 0x12340, 0x12320
.long 0xdb0, 0x12368, 0x12348, 0x12328
.long 0xd80, 0x12370, 0x12350, 0x12330
.long 0xd90, 0x12378, 0x12358, 0x12338
.long 0xde0, 0x123e0, 0x123c0, 0x123a0
.long 0xdf0, 0x123e8, 0x123c8, 0x123a8
.long 0xdc0, 0x123f0, 0x123d0, 0x123b0
.long 0xdd0, 0x123f8, 0x123d8, 0x123b8
.long 0x1240, 0x12400, 0x12420, 0x12440
.long 0x1250, 0x12408, 0x12428, 0x12448
.long 0x1260, 0x12410, 0x12430, 0x12450
.long 0x1270, 0x12418, 0x12438, 0x12458
.long 0x1200, 0x12480, 0x124a0, 0x124c0
.long 0x1210, 0x12488, 0x124a8, 0x124c8
.long 0x1220, 0x12490, 0x124b0, 0x124d0
.long 0x1230, 0x12498, 0x124b8, 0x124d8
.long 0x16c0, 0x12520, 0x12500, 0x12560
.long 0x16d0, 0x12528, 0x12508, 0x12568
.long 0x16e0, 0x12530, 0x12510, 0x12570
.long 0x16f0, 0x12538, 0x12518, 0x12578
.long 0x1680, 0x125a0, 0x12580, 0x125e0
.long 0x1690, 0x125a8, 0x12588, 0x125e8
.long 0x16a0, 0x125b0, 0x12590, 0x125f0
.long 0x16b0, 0x125b8, 0x12598, 0x125f8
.long 0x1b60, 0x12640, 0x12660, 0x12600
.long 0x1b70, 0x12648, 0x12668, 0x12608
.long 0x1b40, 0x12650, 0x12670, 0x12610
.long 0x1b50, 0x12658, 0x12678, 0x12618
.long 0x1b20, 0x126c0, 0x126e0, 0x12680
.long 0x1b30, 0x126c8, 0x126e8, 0x12688
.long 0x1b00, 0x126d0, 0x126f0, 0x12690
.long 0x1b10, 0x126d8, 0x126f8, 0x12698
.long 0x1fe0, 0x12760, 0x12740, 0x12720
.long 0x1ff0, 0x12768, 0x12748, 0x12728
.long 0x1fc0, 0x12770, 0x12750, 0x12730
.long 0x1fd0, 0x12778, 0x12758, 0x12738
.long 0x1fa0, 0x127e0, 0x127c0, 0x127a0
.long 0x1fb0, 0x127e8, 0x127c8, 0x127a8
.long 0x1f80, 0x127f0, 0x127d0, 0x127b0
.long 0x1f90, 0x127f8, 0x127d8, 0x127b8
.long 0x12060, 0x0, 0x0, 0x0
.long 0x12068, 0x480, 0x10, 0x10
.long 0x12070, 0x900, 0x20, 0x20
.long 0x12078, 0xd80, 0x30, 0x30
.long 0x120e0, 0x1200, 0x40, 0x40
.long 0x120e8, 0x1680, 0x50, 0x50
.long 0x120f0, 0x1b00, 0x60, 0x60
.long 0x120f8, 0x1f80, 0x70, 0x70
.long 0x12140, 0x8, 0x100, 0x80
.long 0x12148, 0x488, 0x110, 0x90
.long 0x12150, 0x908, 0x120, 0xa0
.long 0x12158, 0xd88, 0x130, 0xb0
.long 0x121c0, 0x1208, 0x140, 0xc0
.long 0x121c8, 0x1688, 0x150, 0xd0
.long 0x121d0, 0x1b08, 0x160, 0xe0
.long 0x121d8, 0x1f88, 0x170, 0xf0
.long 0x12220, 0x20, 0x7fffff00, 0x2400
.long 0x12228, 0x4a0, 0x7fffff00, 0x2410
.long 0x12230, 0x920, 0x7fffff00, 0x2420
.long 0x12238, 0xda0, 0x7fffff00, 0x2430
.long 0x122a0, 0x1220, 0x7fffff00, 0x2440
.long 0x122a8, 0x16a0, 0x7fffff00, 0x2450
.long 0x122b0, 0x1b20, 0x7fffff00, 0x2460
.long 0x122b8, 0x1fa0, 0x7fffff00, 0x2470
.long 0x12300, 0x28, 0x7fffff00, 0x2480
.long 0x12308, 0x4a8, 0x7fffff00, 0x2490
.long 0x12310, 0x928, 0x7fffff00, 0x24a0
.long 0x12318, 0xda8, 0x7fffff00, 0x24b0
.long 0x12380, 0x1228, 0x7fffff00, 0x24c0
.long 0x12388, 0x16a8, 0x7fffff00, 0x24d0
.long 0x12390, 0x1b28, 0x7fffff00, 0x24e0
.long 0x12398, 0x1fa8, 0x7fffff00, 0x24f0
.long 0x12460, 0x280, 0x7fffff00, 0x4800
.long 0x12468, 0x700, 0x7fffff00, 0x4810
.long 0x12470, 0xb80, 0x7fffff00, 0x4820
.long 0x12478, 0x1000, 0x7fffff00, 0x4830
.long 0x124e0, 0x1480, 0x7fffff00, 0x4840
.long 0x124e8, 0x1900, 0x7fffff00, 0x4850
.long 0x124f0, 0x1d80, 0x7fffff00, 0x4860
.long 0x124f8, 0x2200, 0x7fffff00, 0x4870
.long 0x12540, 0x288, 0x7fffff00, 0x4880
.long 0x12548, 0x708, 0x7fffff00, 0x4890
.long 0x12550, 0xb88, 0x7fffff00, 0x48a0
.long 0x12558, 0x1008, 0x7fffff00, 0x48b0
.long 0x125c0, 0x1488, 0x7fffff00, 0x48c0
.long 0x125c8, 0x1908, 0x7fffff00, 0x48d0
.long 0x125d0, 0x1d88, 0x7fffff00, 0x48e0
.long 0x125d8, 0x2208, 0x7fffff00, 0x48f0
.long 0x12620, 0x2a0, 0x7fffff00, 0x6c00
.long 0x12628, 0x720, 0x7fffff00, 0x6c10
.long 0x12630, 0xba0, 0x7fffff00, 0x6c20
.long 0x12638, 0x1020, 0x7fffff00, 0x6c30
.long 0x126a0, 0x14a0, 0x7fffff00, 0x6c40
.long 0x126a8, 0x1920, 0x7fffff00, 0x6c50
.long 0x126b0, 0x1da0, 0x7fffff00, 0x6c60
.long 0x126b8, 0x2220, 0x7fffff00, 0x6c70
.long 0x12700, 0x2a8, 0x7fffff00, 0x6c80
.long 0x12708, 0x728, 0x7fffff00, 0x6c90
.long 0x12710, 0xba8, 0x7fffff00, 0x6ca0
.long 0x12718, 0x1028, 0x7fffff00, 0x6cb0
.long 0x12780, 0x14a8, 0x7fffff00, 0x6cc0
.long 0x12788, 0x1928, 0x7fffff00, 0x6cd0
.long 0x12790, 0x1da8, 0x7fffff00, 0x6ce0
.long 0x12798, 0x2228, 0x7fffff00, 0x6cf0
.long 0x0, 0x0, 0x700, 0x100
.long 0x10, 0x10, 0x710, 0x110
.long 0x20, 0x20, 0x720, 0x120
.long 0x30, 0x30, 0x730, 0x130
.long 0x40, 0x40, 0x740, 0x140
.long 0x50, 0x50, 0x750, 0x150
.long 0x60, 0x60, 0x760, 0x160
.long 0x70, 0x70, 0x770, 0x170
.long 0x24000, 0x80, 0x780, 0x180
.long 0x24010, 0x90, 0x790, 0x190
.long 0x24020, 0xa0, 0x7a0, 0x1a0
.long 0x24030, 0xb0, 0x7b0, 0x1b0
.long 0x24040, 0xc0, 0x7c0, 0x1c0
.long 0x24050, 0xd0, 0x7d0, 0x1d0
.long 0x24060, 0xe0, 0x7e0, 0x1e0
.long 0x24070, 0xf0, 0x7f0, 0x1f0
.long 0x80, 0x200, 0x7fffff00, 0x380
.long 0x90, 0x210, 0x7fffff00, 0x390
.long 0xa0, 0x220, 0x7fffff00, 0x3a0
.long 0xb0, 0x230, 0x7fffff00, 0x3b0
.long 0xc0, 0x240, 0x7fffff00, 0x3c0
.long 0xd0, 0x250, 0x7fffff00, 0x3d0
.long 0xe0, 0x260, 0x7fffff00, 0x3e0
.long 0xf0, 0x270, 0x7fffff00, 0x3f0
.long 0x24080, 0x280, 0x7fffff00, 0x400
.long 0x24090, 0x290, 0x7fffff00, 0x410
.long 0x240a0, 0x2a0, 0x7fffff00, 0x420
.long 0x240b0, 0x2b0, 0x7fffff00, 0x430
.long 0x240c0, 0x2c0, 0x7fffff00, 0x440
.long 0x240d0, 0x2d0, 0x7fffff00, 0x450
.long 0x240e0, 0x2e0, 0x7fffff00, 0x460
.long 0x240f0, 0x2f0, 0x7fffff00, 0x470
.long 0x100, 0x300, 0x7fffff00, 0x580
.long 0x110, 0x310, 0x7fffff00, 0x590
.long 0x120, 0x320, 0x7fffff00, 0x5a0
.long 0x130, 0x330, 0x7fffff00, 0x5b0
.long 0x140, 0x340, 0x7fffff00, 0x5c0
.long 0x150, 0x350, 0x7fffff00, 0x5d0
.long 0x160, 0x360, 0x7fffff00, 0x5e0
.long 0x170, 0x370, 0x7fffff00, 0x5f0
.long 0x24100, 0x480, 0x7fffff00, 0x600
.long 0x24110, 0x490, 0x7fffff00, 0x610
.long 0x24120, 0x4a0, 0x7fffff00, 0x620
.long 0x24130, 0x4b0, 0x7fffff00, 0x630
.long 0x24140, 0x4c0, 0x7fffff00, 0x640
.long 0x24150, 0x4d0, 0x7fffff00, 0x650
.long 0x24160, 0x4e0, 0x7fffff00, 0x660
.long 0x24170, 0x4f0, 0x7fffff00, 0x670
.long 0x180, 0x500, 0x7fffff00, 0x800
.long 0x190, 0x510, 0x7fffff00, 0x810
.long 0x1a0, 0x520, 0x7fffff00, 0x820
.long 0x1b0, 0x530, 0x7fffff00, 0x830
.long 0x1c0, 0x540, 0x7fffff00, 0x840
.long 0x1d0, 0x550, 0x7fffff00, 0x850
.long 0x1e0, 0x560, 0x7fffff00, 0x860
.long 0x1f0, 0x570, 0x7fffff00, 0x870
.long 0x24180, 0x680, 0x7fffff00, 0x880
.long 0x24190, 0x690, 0x7fffff00, 0x890
.long 0x241a0, 0x6a0, 0x7fffff00, 0x8a0
.long 0x241b0, 0x6b0, 0x7fffff00, 0x8b0
.long 0x241c0, 0x6c0, 0x7fffff00, 0x8c0
.long 0x241d0, 0x6d0, 0x7fffff00, 0x8d0
.long 0x241e0, 0x6e0, 0x7fffff00, 0x8e0
.long 0x241f0, 0x6f0, 0x7fffff00, 0x8f0
K_tab_end:
.size K_tab, K_tab_end-K_tab
.section .rodata,"a"
.p2align 6
.amdhsa_kernel sequential_preLN__linear_kernel_hedgehog__glu_gated_reglu__prompt_kernel
  .amdhsa_next_free_vgpr 512
  .amdhsa_next_free_sgpr 102
  .amdhsa_accum_offset 256
  .amdhsa_group_segment_fixed_size 0
  .amdhsa_kernarg_size 88
  .amdhsa_user_sgpr_count 2
  .amdhsa_user_sgpr_kernarg_segment_ptr 1
  .amdhsa_system_sgpr_workgroup_id_x 1
  .amdhsa_float_denorm_mode_32 3
.end_amdhsa_kernel
```
